```python
import torch

def _softmax(x, axis=-1):
    return torch.softmax(x, dim=axis)
def _gelu(x):
    return torch.nn.functional.gelu(x, approximate="tanh")
def _silu(x):
    return torch.nn.functional.silu(x)
def _sigmoid(x):
    return torch.sigmoid(x)
def _layernorm(x, axis=-1, eps=1e-5):
    m = x.mean(dim=axis, keepdim=True)
    v = x.var(dim=axis, keepdim=True, unbiased=False)
    return (x - m) / torch.sqrt(v + eps)
def _scatter_add(tgt, idx, src, axis=0):
    return tgt.clone().index_add_(axis, idx, src)
def _segment_sum(src, seg, n):
    out = torch.zeros((n,) + src.shape[1:], dtype=src.dtype)
    return out.index_add_(0, seg, src)
def _pad(x, pw):
    flat = tuple(v for pair in reversed(pw) for v in pair)
    return torch.nn.functional.pad(x, flat)

kernel_name = 'concat_heads__mha_block_cached__mha_block_cached__near_ridge'

def setup_inputs():

    _w = (lambda a: (lambda t: t.to(torch.bfloat16) if t.is_floating_point() else t)(torch.as_tensor(a)))
    def _A_setup():
        B, Sq, D = 16, 160, 448
        H, Sk, Dh = 16, 512, 256
        return {
            "x": _w((lambda *s: torch.randn(*s, dtype=torch.bfloat16) * 0.8)(B, Sq, D)),
            "k_cache": _w((lambda *s: torch.randn(*s, dtype=torch.bfloat16) * 0.8)(B, H, Sk, Dh)),
            "v_cache": _w((lambda *s: torch.randn(*s, dtype=torch.bfloat16) * 0.05)(B, H, Sk, Dh)),
            "wq": _w((lambda *s: torch.randn(*s, dtype=torch.bfloat16) * 0.8)(D, H * Dh) * (D ** -0.5)),
            "wo": _w((lambda *s: torch.randn(*s, dtype=torch.bfloat16) * 0.05)(H * Dh, D) * ((H * Dh) ** -0.5)),
        }
    _A_in = _A_setup()

    def _B_setup():
        B, Sq, D = 16, 160, 448
        H, Sk, Dh = 16, 512, 256
        return {
            "x": _w((lambda *s: torch.randn(*s, dtype=torch.bfloat16) * 0.8)(B, Sq, D)),
            "k_cache": _w((lambda *s: torch.randn(*s, dtype=torch.bfloat16) * 0.8)(B, H, Sk, Dh)),
            "v_cache": _w((lambda *s: torch.randn(*s, dtype=torch.bfloat16) * 0.05)(B, H, Sk, Dh)),
            "wq": _w((lambda *s: torch.randn(*s, dtype=torch.bfloat16) * 0.8)(D, H * Dh) * (D ** -0.5)),
            "wo": _w((lambda *s: torch.randn(*s, dtype=torch.bfloat16) * 0.05)(H * Dh, D) * ((H * Dh) ** -0.5)),
        }
    _B_in = _B_setup()

    return {
        "A_x": _A_in["x"],
        "A_k_cache": _A_in["k_cache"],
        "A_v_cache": _A_in["v_cache"],
        "A_wq": _A_in["wq"],
        "A_wo": _A_in["wo"],
        "B_x": _B_in["x"],
        "B_k_cache": _B_in["k_cache"],
        "B_v_cache": _B_in["v_cache"],
        "B_wq": _B_in["wq"],
        "B_wo": _B_in["wo"],
    }

def reference(A_x, A_k_cache, A_v_cache, A_wq, A_wo, B_x, B_k_cache, B_v_cache, B_wq, B_wo):
    def _A_ref(x, k_cache, v_cache, wq, wo):
        B, Sq, D = x.shape
        H, Dh = 16, 256
        q = (lambda x, *d: x.permute(*d))((x @ wq).reshape(B, Sq, H, Dh), 0, 2, 1, 3)
        scores = torch.einsum("bhqd,bhkd->bhqk", q, k_cache) * (Dh ** -0.5)
        p = _softmax(scores, axis=-1)
        o = torch.einsum("bhqk,bhkd->bhqd", p, v_cache)
        return (lambda x, *d: x.permute(*d))(o, 0, 2, 1, 3).reshape(B, Sq, H * Dh) @ wo

    def _B_ref(x, k_cache, v_cache, wq, wo):
        B, Sq, D = x.shape
        H, Dh = 16, 256
        q = (lambda x, *d: x.permute(*d))((x @ wq).reshape(B, Sq, H, Dh), 0, 2, 1, 3)
        scores = torch.einsum("bhqd,bhkd->bhqk", q, k_cache) * (Dh ** -0.5)
        p = _softmax(scores, axis=-1)
        o = torch.einsum("bhqk,bhkd->bhqd", p, v_cache)
        return (lambda x, *d: x.permute(*d))(o, 0, 2, 1, 3).reshape(B, Sq, H * Dh) @ wo

    a = _A_ref(A_x, A_k_cache, A_v_cache, A_wq, A_wo)
    b = _B_ref(B_x, B_k_cache, B_v_cache, B_wq, B_wo)
    return torch.concatenate([a, b], axis=-1)
```

```asm
; @launch grid=(256,1,1) block=(256,1,1) lds=163840
.amdgcn_target "amdgcn-amd-amdhsa--gfx950"
.text
.globl concat_heads__mha_block_cached__mha_block_cached__near_ridge_kernel
.p2align 8
.type concat_heads__mha_block_cached__mha_block_cached__near_ridge_kernel,@function
concat_heads__mha_block_cached__mha_block_cached__near_ridge_kernel:
s_cmp_ge_u32 s2, 256
s_cbranch_scc0 L_main_go
s_endpgm
L_main_go:
s_memrealtime s[62:63]
s_load_dwordx16 s[76:91], s[0:1], 0
s_load_dwordx8 s[92:99], s[0:1], 64
s_load_dwordx2 s[100:101], s[0:1], 96
v_lshrrev_b32 v2, 6, v0
v_and_b32 v0, 63, v0
v_readfirstlane_b32 s32, v2
v_lshlrev_b32 v1, 4, v0
v_add_u32 v2, 0xa000, v1
v_and_b32 v52, 15, v0
v_lshrrev_b32 v53, 4, v0
s_lshr_b32 s72, s2, 2
s_and_b32 s72, s72, 1
s_and_b32 s73, s2, 3
s_lshl_b32 s73, s73, 1
s_lshr_b32 s35, s2, 3
s_and_b32 s52, s35, 2
s_and_b32 s35, s35, 1
s_add_u32 s73, s73, s35
s_lshr_b32 s54, s2, 4
s_lshl_b32 s33, s32, 14
s_add_u32 s33, s33, 0x14000
s_lshl_b32 s53, s32, 10
s_add_u32 s49, s53, 0x25000
s_mul_i32 s56, s32, 0x2800
s_mov_b32 s34, 0
s_mov_b32 s48, 0
s_mov_b32 s37, 0
s_mov_b32 s28, 0x3db8aa3b
s_mov_b32 s29, 0x3db8aa3b
s_mov_b32 s57, 0xfc00
s_mov_b32 s58, 0x1f800
s_mov_b32 s59, 0x2f400
s_mov_b32 s44, 0x80200
s_mov_b32 s45, 0xc0200
s_mov_b32 s46, 0x200
s_mov_b32 s47, 0x40200
v_lshrrev_b32 v54, 3, v0
v_and_b32 v55, 7, v0
s_and_b32 s75, s32, 1
s_lshl_b32 s36, s75, 2
v_lshrrev_b32 v48, 1, v54
v_xor_b32 v48, v48, v55
v_xor_b32 v49, s36, v48
v_lshlrev_b32 v49, 4, v49
v_mul_u32_u24 v50, 0x380, v54
v_add_u32 v49, v49, v50
s_mul_i32 s3, s32, 0x1c00
v_add_u32 v22, s3, v49
v_and_b32 v49, 2, v54
v_lshlrev_b32 v49, 1, v49
v_xor_b32 v49, v49, v55
v_lshlrev_b32 v49, 4, v49
v_lshl_add_u32 v49, v54, 13, v49
s_lshl_b32 s3, s32, 7
v_add_u32 v18, s3, v49
v_mov_b32 v12, v18
v_add_u32 v13, s57, v18
v_add_u32 v14, s58, v18
v_add_u32 v15, s59, v18
s_waitcnt lgkmcnt(0)
s_mov_b32 s31, s62
s_cmp_eq_u32 s72, 0
s_cselect_b32 s4, s76, s86
s_cselect_b32 s5, s77, s87
s_cselect_b32 s12, s78, s88
s_cselect_b32 s13, s79, s89
s_cselect_b32 s16, s80, s90
s_cselect_b32 s17, s81, s91
s_cselect_b32 s8, s82, s92
s_cselect_b32 s9, s83, s93
s_cselect_b32 s20, s84, s94
s_cselect_b32 s21, s85, s95
s_mul_i32 s3, s54, 0x23000
s_add_u32 s4, s4, s3
s_addc_u32 s5, s5, 0
s_and_b32 s5, s5, 0xffff
s_mov_b32 s6, 0x23000
s_mov_b32 s7, 0x20000
s_lshl_b32 s3, s73, 10
s_add_u32 s8, s8, s3
s_addc_u32 s9, s9, 0
s_and_b32 s9, s9, 0xffff
s_mov_b32 s10, 0x37e400
s_mov_b32 s11, 0x20000
s_add_u32 s24, s100, 0
s_addc_u32 s25, s101, 0
s_and_b32 s25, s25, 0xffff
s_mov_b32 s26, 0x11260000
s_mov_b32 s27, 0x20000
s_add_u32 m0, s33, 0x2000
s_add_u32 s35, s37, 0
buffer_load_dwordx4 v12, s[8:11], s35 offen nt lds
buffer_load_dwordx4 v13, s[8:11], s35 offen offset:1024 nt lds
buffer_load_dwordx4 v14, s[8:11], s35 offen offset:2048 nt lds
buffer_load_dwordx4 v15, s[8:11], s35 offen offset:3072 nt lds
s_add_u32 m0, s53, 0
s_mov_b32 s36, 0
buffer_load_dwordx4 v22, s[4:7], s36 offen lds
s_add_u32 m0, s53, 0x1000
s_mov_b32 s36, 0x7000
buffer_load_dwordx4 v22, s[4:7], s36 offen lds
s_add_u32 m0, s53, 0x2000
s_mov_b32 s36, 0xe000
buffer_load_dwordx4 v22, s[4:7], s36 offen lds
s_add_u32 m0, s53, 0x3000
s_mov_b32 s36, 0x15000
buffer_load_dwordx4 v22, s[4:7], s36 offen lds
s_add_u32 m0, s53, 0x4000
s_mov_b32 s36, 0x1c000
buffer_load_dwordx4 v22, s[4:7], s36 offen lds
s_add_u32 m0, s33, 0x3000
s_add_u32 s35, s37, 0x40000
buffer_load_dwordx4 v12, s[8:11], s35 offen nt lds
buffer_load_dwordx4 v13, s[8:11], s35 offen offset:1024 nt lds
buffer_load_dwordx4 v14, s[8:11], s35 offen offset:2048 nt lds
buffer_load_dwordx4 v15, s[8:11], s35 offen offset:3072 nt lds
v_lshrrev_b32 v58, 9, v1
v_lshlrev_b32 v58, 13, v58
v_and_b32 v59, 0x1f0, v1
v_add_u32 v58, v58, v59
s_lshl_b32 s38, s54, 2
s_add_u32 s38, s38, s32
s_add_u32 s38, s38, 32
s_lshl_b32 s38, s38, 14
s_mov_b32 m0, s49
s_nop 0
buffer_load_dwordx4 v58, s[8:11], s38 offen lds
s_add_u32 s38, s38, 0x100000
buffer_load_dwordx4 v58, s[8:11], s38 offen lds
s_add_u32 s38, s38, 0x100000
buffer_load_dwordx4 v58, s[8:11], s38 offen lds
s_add_u32 s38, s38, 0x100000
s_add_u32 s64, s96, 0
s_addc_u32 s65, s97, 0
s_and_b32 s65, s65, 0xffff
s_mov_b32 s66, 0x460000
s_mov_b32 s67, 0x20000
s_add_u32 s68, s98, 0
s_addc_u32 s69, s99, 0
s_and_b32 s69, s69, 0xffff
s_mov_b32 s70, 0x100
s_mov_b32 s71, 0x20000
s_or_b32 s30, s31, 1
s_lshl_b32 s95, s72, 4
s_add_u32 s95, s95, s54
s_lshl_b32 s95, s95, 2
s_or_b32 s36, s73, s32
s_cmp_eq_u32 s36, 0
s_cselect_b32 s36, s95, 0x7f000000
v_mov_b32 v50, s30
v_lshlrev_b32 v49, 8, v0
buffer_store_dword v50, v49, s[68:71], s36 offen sc1
s_lshl_b32 s3, s54, 3
s_add_u32 s3, s3, s73
s_lshl_b32 s3, s3, 19
s_add_u32 s12, s12, s3
s_addc_u32 s13, s13, 0
s_and_b32 s13, s13, 0xffff
s_mov_b32 s14, 0x80000
s_mov_b32 s15, 0x20000
s_add_u32 s16, s16, s3
s_addc_u32 s17, s17, 0
s_and_b32 s17, s17, 0xffff
s_mov_b32 s18, 0x80000
s_mov_b32 s19, 0x20000
s_mul_i32 s3, s73, 0x70000
s_add_u32 s20, s20, s3
s_addc_u32 s21, s21, 0
s_and_b32 s21, s21, 0xffff
s_mov_b32 s22, 0x70000
s_mov_b32 s23, 0x20000
v_lshlrev_b32 v49, 4, v48
v_lshl_add_u32 v49, v54, 9, v49
s_lshl_b32 s3, s32, 14
v_add_u32 v16, s3, v49
v_and_b32 v49, 6, v54
v_xor_b32 v49, v49, v55
v_lshlrev_b32 v49, 4, v49
v_lshl_add_u32 v49, v54, 9, v49
s_lshl_b32 s3, s32, 7
v_add_u32 v17, s3, v49
v_lshrrev_b32 v48, 1, v52
v_xor_b32 v48, v48, v53
v_lshlrev_b32 v48, 4, v48
v_lshl_add_u32 v48, v52, 7, v48
v_add_u32 v3, s33, v48
v_xor_b32 v4, 64, v3
v_lshrrev_b32 v56, 2, v52
v_and_b32 v57, 3, v0
v_and_b32 v49, 2, v56
v_lshlrev_b32 v49, 1, v49
v_xor_b32 v49, v49, v57
v_lshlrev_b32 v49, 4, v49
v_lshl_add_u32 v49, v56, 7, v49
v_lshl_add_u32 v49, v53, 10, v49
v_add_u32 v23, s33, v49
v_and_b32 v49, 1, v53
v_lshl_add_u32 v49, v49, 2, v56
v_lshrrev_b32 v50, 1, v49
v_lshlrev_b32 v50, 5, v50
v_lshl_add_u32 v50, v49, 7, v50
v_lshl_add_u32 v50, v57, 3, v50
v_lshrrev_b32 v51, 1, v53
v_lshl_add_u32 v50, v51, 10, v50
v_add_u32 v8, s33, v50
v_xor_b32 v9, 32, v8
v_xor_b32 v10, 64, v8
v_xor_b32 v11, 0x60, v8
s_mul_i32 s3, s75, 0x5000
v_add_u32 v5, s3, v1
s_sub_u32 s3, 0x5000, s3
v_add_u32 v6, s3, v1
s_xor_b32 s3, s32, s52
s_mul_i32 s55, s3, 0x5000
v_add_u32 v7, s56, v1
s_xor_b32 s40, s75, 0
s_xor_b32 s40, s40, s52
s_lshl_b32 s40, s40, 7
s_xor_b32 s41, s75, 1
s_xor_b32 s41, s41, s52
s_lshl_b32 s41, s41, 7
s_xor_b32 s42, s75, 2
s_xor_b32 s42, s42, s52
s_lshl_b32 s42, s42, 7
s_xor_b32 s43, s75, 3
s_xor_b32 s43, s43, s52
s_lshl_b32 s43, s43, 7
v_mul_u32_u24 v21, 48, v52
v_add_u32 v21, 0x24000, v21
v_and_b32 v49, 1, v53
v_lshlrev_b32 v49, 3, v49
v_lshrrev_b32 v50, 1, v53
v_lshl_add_u32 v49, v50, 2, v49
v_add_u32 v20, v49, v21
v_subrev_u32 v36, s33, v3
v_subrev_u32 v37, s33, v4
v_add_u32 v38, 0x25000, v36
v_add_u32 v39, 0x25000, v37
v_xor_b32 v40, 64, v23
v_add_u32 v41, s55, v1
s_mov_b32 s96, 0x30000
s_lshl_b32 s3, s32, 12
s_add_u32 s101, s3, 0xf000
s_add_u32 s100, s3, 0x25000
s_cmp_eq_u32 s32, 3
s_cselect_b32 s100, 0x13000, s100
s_getpc_b64 s[98:99]
L_pc:
s_sub_u32 s98, s98, L_pc-concat_heads__mha_block_cached__mha_block_cached__near_ridge_kernel
s_subb_u32 s99, s99, 0
s_lshr_b32 s3, s2, 3
s_lshl_b32 s3, s3, 2
s_add_u32 s3, s3, s32
s_lshl_b32 s3, s3, 10
s_min_u32 s3, s3, (L_code_end-concat_heads__mha_block_cached__mha_block_cached__near_ridge_kernel-1024)&~15
s_add_u32 s98, s98, s3
s_addc_u32 s99, s99, 0
v_mov_b32 v49, s99
v_add_co_u32 v48, vcc, s98, v1
s_nop 1
v_addc_co_u32 v49, vcc, 0, v49, vcc
s_mov_b32 m0, s101
s_nop 0
global_load_lds_dwordx4 v[48:49], off
s_mov_b32 s92, s33
s_mov_b32 s93, s53
s_mul_i32 s75, s54, 0x46000
s_mul_i32 s3, s72, 0x380
s_add_u32 s75, s75, s3
s_lshl_b32 s3, s72, 4
s_add_u32 s3, s3, s54
s_lshl_b32 s74, s3, 8
s_add_u32 s74, s74, 0x2300000
s_mul_i32 s72, s3, 0x118000
s_mul_i32 s51, s73, 0x23000
s_add_u32 s51, s51, s72
s_lshl_b32 s73, s73, 2
s_add_u32 s73, s73, s32
s_nop 7
L_head:
s_waitcnt vmcnt(9)
ds_read_b64_tr_b16 a[192:193], v23 offset:8192
ds_read_b64_tr_b16 a[194:195], v23 offset:8704
ds_read_b64_tr_b16 a[196:197], v23 offset:8200
ds_read_b64_tr_b16 a[198:199], v23 offset:8712
ds_read_b64_tr_b16 a[200:201], v40 offset:8192
ds_read_b64_tr_b16 a[202:203], v40 offset:8704
ds_read_b64_tr_b16 a[204:205], v40 offset:8200
ds_read_b64_tr_b16 a[206:207], v40 offset:8712
s_waitcnt vmcnt(9)
s_barrier
ds_read_b128 a[240:243], v36
ds_read_b128 a[244:247], v36 offset:2048
ds_read_b128 a[248:251], v36 offset:4096
s_add_u32 m0, s92, 0
s_add_u32 s35, s37, 0x80000
buffer_load_dwordx4 v12, s[8:11], s35 offen nt lds
buffer_load_dwordx4 v13, s[8:11], s35 offen offset:1024 nt lds
buffer_load_dwordx4 v14, s[8:11], s35 offen offset:2048 nt lds
buffer_load_dwordx4 v15, s[8:11], s35 offen offset:3072 nt lds
v_accvgpr_write_b32 a112, v48
v_accvgpr_write_b32 a113, v49
v_accvgpr_write_b32 a114, v50
v_accvgpr_write_b32 a115, v51
v_accvgpr_write_b32 a152, v56
v_accvgpr_write_b32 a153, v57
v_accvgpr_write_b32 a154, v58
v_accvgpr_write_b32 a155, v59
s_add_u32 m0, s33, 0x2000
s_add_u32 s35, s37, 0x100000
s_waitcnt lgkmcnt(3)
buffer_load_dwordx4 v12, s[8:11], s35 offen nt lds
buffer_load_dwordx4 v13, s[8:11], s35 offen offset:1024 nt lds
buffer_load_dwordx4 v14, s[8:11], s35 offen offset:2048 nt lds
buffer_load_dwordx4 v15, s[8:11], s35 offen offset:3072 nt lds
s_waitcnt lgkmcnt(2)
v_mfma_f32_16x16x32_bf16 v[52:55], a[196:199], a[240:243], 0
ds_read_b128 a[252:255], v36 offset:6144
v_mfma_f32_16x16x32_bf16 v[60:63], a[204:207], a[240:243], 0
s_waitcnt vmcnt(13)
ds_read_b64_tr_b16 a[208:209], v23 offset:12288
v_accvgpr_write_b32 a116, v64
v_accvgpr_write_b32 a117, v65
v_mfma_f32_16x16x32_bf16 v[48:51], a[192:195], a[240:243], 0
ds_read_b64_tr_b16 a[210:211], v23 offset:12800
v_accvgpr_write_b32 a118, v66
v_accvgpr_write_b32 a119, v67
v_mfma_f32_16x16x32_bf16 v[56:59], a[200:203], a[240:243], 0
s_waitcnt lgkmcnt(4)
s_add_u32 m0, s93, 0x5000
s_mov_b32 s36, 0x80
buffer_load_dwordx4 v22, s[4:7], s36 offen lds
v_accvgpr_write_b32 a156, v72
v_accvgpr_write_b32 a157, v73
v_mfma_f32_16x16x32_bf16 v[68:71], a[196:199], a[244:247], 0
ds_read_b128 a[240:243], v36 offset:8192
v_accvgpr_write_b32 a158, v74
v_accvgpr_write_b32 a159, v75
v_mfma_f32_16x16x32_bf16 v[76:79], a[204:207], a[244:247], 0
ds_read_b64_tr_b16 a[212:213], v23 offset:12296
v_accvgpr_write_b32 a120, v80
v_accvgpr_write_b32 a121, v81
v_mfma_f32_16x16x32_bf16 v[64:67], a[192:195], a[244:247], 0
ds_read_b64_tr_b16 a[214:215], v23 offset:12808
v_accvgpr_write_b32 a122, v82
v_accvgpr_write_b32 a123, v83
v_mfma_f32_16x16x32_bf16 v[72:75], a[200:203], a[244:247], 0
s_waitcnt lgkmcnt(6)
s_add_u32 m0, s93, 0x6000
s_mov_b32 s36, 0x7080
buffer_load_dwordx4 v22, s[4:7], s36 offen lds
v_accvgpr_write_b32 a160, v88
v_accvgpr_write_b32 a161, v89
v_mfma_f32_16x16x32_bf16 v[84:87], a[196:199], a[248:251], 0
ds_read_b128 a[244:247], v36 offset:10240
v_accvgpr_write_b32 a162, v90
v_accvgpr_write_b32 a163, v91
v_mfma_f32_16x16x32_bf16 v[92:95], a[204:207], a[248:251], 0
ds_read_b64_tr_b16 a[216:217], v40 offset:12288
v_accvgpr_write_b32 a124, v96
v_accvgpr_write_b32 a125, v97
v_mfma_f32_16x16x32_bf16 v[80:83], a[192:195], a[248:251], 0
ds_read_b64_tr_b16 a[218:219], v40 offset:12800
v_accvgpr_write_b32 a126, v98
v_accvgpr_write_b32 a127, v99
v_mfma_f32_16x16x32_bf16 v[88:91], a[200:203], a[248:251], 0
s_waitcnt lgkmcnt(8)
s_add_u32 m0, s93, 0x7000
s_mov_b32 s36, 0xe080
buffer_load_dwordx4 v22, s[4:7], s36 offen lds
v_accvgpr_write_b32 a164, v104
v_accvgpr_write_b32 a165, v105
v_mfma_f32_16x16x32_bf16 v[100:103], a[196:199], a[252:255], 0
ds_read_b128 a[248:251], v36 offset:12288
v_accvgpr_write_b32 a166, v106
v_accvgpr_write_b32 a167, v107
v_mfma_f32_16x16x32_bf16 v[108:111], a[204:207], a[252:255], 0
ds_read_b64_tr_b16 a[220:221], v40 offset:12296
v_accvgpr_write_b32 a128, v112
v_accvgpr_write_b32 a129, v113
v_mfma_f32_16x16x32_bf16 v[96:99], a[192:195], a[252:255], 0
ds_read_b64_tr_b16 a[222:223], v40 offset:12808
v_accvgpr_write_b32 a130, v114
v_accvgpr_write_b32 a131, v115
v_mfma_f32_16x16x32_bf16 v[104:107], a[200:203], a[252:255], 0
s_waitcnt lgkmcnt(8)
s_add_u32 m0, s93, 0x8000
s_mov_b32 s36, 0x15080
buffer_load_dwordx4 v22, s[4:7], s36 offen lds
v_accvgpr_write_b32 a168, v120
v_accvgpr_write_b32 a169, v121
v_mfma_f32_16x16x32_bf16 v[116:119], a[196:199], a[240:243], 0
ds_read_b128 a[252:255], v36 offset:14336
v_accvgpr_write_b32 a170, v122
v_accvgpr_write_b32 a171, v123
v_mfma_f32_16x16x32_bf16 v[124:127], a[204:207], a[240:243], 0
v_accvgpr_write_b32 a132, v132
v_accvgpr_write_b32 a133, v133
v_accvgpr_write_b32 a134, v134
v_mfma_f32_16x16x32_bf16 v[112:115], a[192:195], a[240:243], 0
v_accvgpr_write_b32 a135, v135
v_accvgpr_write_b32 a172, v128
v_mfma_f32_16x16x32_bf16 v[120:123], a[200:203], a[240:243], 0
s_waitcnt lgkmcnt(6)
s_add_u32 m0, s93, 0x9000
s_mov_b32 s36, 0x1c080
buffer_load_dwordx4 v22, s[4:7], s36 offen lds
v_accvgpr_write_b32 a173, v129
v_mfma_f32_16x16x32_bf16 v[140:143], a[196:199], a[244:247], 0
ds_read_b128 a[240:243], v36 offset:16384
v_accvgpr_write_b32 a174, v130
v_accvgpr_write_b32 a175, v131
v_mfma_f32_16x16x32_bf16 v[136:139], a[204:207], a[244:247], 0
s_add_u32 m0, s33, 0x3000
s_add_u32 s35, s37, 0x140000
v_accvgpr_write_b32 a136, v148
v_accvgpr_write_b32 a137, v149
v_mfma_f32_16x16x32_bf16 v[132:135], a[192:195], a[244:247], 0
s_waitcnt lgkmcnt(2)
buffer_load_dwordx4 v12, s[8:11], s35 offen nt lds
v_accvgpr_write_b32 a138, v150
v_accvgpr_write_b32 a139, v151
v_mfma_f32_16x16x32_bf16 v[128:131], a[200:203], a[244:247], 0
v_accvgpr_write_b32 a176, v144
v_accvgpr_write_b32 a177, v145
v_mfma_f32_16x16x32_bf16 v[156:159], a[196:199], a[248:251], 0
ds_read_b128 a[244:247], v36 offset:18432
v_accvgpr_write_b32 a178, v146
v_accvgpr_write_b32 a179, v147
v_mfma_f32_16x16x32_bf16 v[152:155], a[204:207], a[248:251], 0
buffer_load_dwordx4 v13, s[8:11], s35 offen offset:1024 nt lds
v_accvgpr_write_b32 a140, v164
v_accvgpr_write_b32 a141, v165
v_mfma_f32_16x16x32_bf16 v[148:151], a[192:195], a[248:251], 0
v_accvgpr_write_b32 a142, v166
v_accvgpr_write_b32 a143, v167
v_mfma_f32_16x16x32_bf16 v[144:147], a[200:203], a[248:251], 0
s_waitcnt lgkmcnt(2)
v_accvgpr_write_b32 a180, v160
v_accvgpr_write_b32 a181, v161
v_accvgpr_write_b32 a182, v162
v_mfma_f32_16x16x32_bf16 v[172:175], a[196:199], a[252:255], 0
ds_read_b128 a[248:251], v37
v_accvgpr_write_b32 a183, v163
v_mfma_f32_16x16x32_bf16 v[168:171], a[204:207], a[252:255], 0
buffer_load_dwordx4 v14, s[8:11], s35 offen offset:2048 nt lds
v_accvgpr_write_b32 a144, v180
v_accvgpr_write_b32 a145, v181
v_mfma_f32_16x16x32_bf16 v[164:167], a[192:195], a[252:255], 0
v_accvgpr_write_b32 a146, v182
v_accvgpr_write_b32 a147, v183
v_mfma_f32_16x16x32_bf16 v[160:163], a[200:203], a[252:255], 0
s_waitcnt lgkmcnt(2)
v_accvgpr_write_b32 a184, v176
v_accvgpr_write_b32 a185, v177
v_accvgpr_write_b32 a186, v178
v_mfma_f32_16x16x32_bf16 v[188:191], a[196:199], a[240:243], 0
ds_read_b128 a[252:255], v37 offset:2048
v_accvgpr_write_b32 a187, v179
v_mfma_f32_16x16x32_bf16 v[184:187], a[204:207], a[240:243], 0
buffer_load_dwordx4 v15, s[8:11], s35 offen offset:3072 nt lds
v_accvgpr_write_b32 a148, v196
v_accvgpr_write_b32 a149, v197
v_mfma_f32_16x16x32_bf16 v[180:183], a[192:195], a[240:243], 0
s_add_u32 m0, s92, 0x1000
s_add_u32 s35, s37, 0xc0000
v_accvgpr_write_b32 a150, v198
v_accvgpr_write_b32 a151, v199
v_mfma_f32_16x16x32_bf16 v[176:179], a[200:203], a[240:243], 0
s_waitcnt lgkmcnt(2)
buffer_load_dwordx4 v12, s[8:11], s35 offen nt lds
v_accvgpr_write_b32 a188, v192
v_accvgpr_write_b32 a189, v193
v_mfma_f32_16x16x32_bf16 v[204:207], a[196:199], a[244:247], 0
ds_read_b128 a[240:243], v37 offset:4096
v_accvgpr_write_b32 a190, v194
v_accvgpr_write_b32 a191, v195
v_mfma_f32_16x16x32_bf16 v[200:203], a[204:207], a[244:247], 0
buffer_load_dwordx4 v13, s[8:11], s35 offen offset:1024 nt lds
v_mfma_f32_16x16x32_bf16 v[196:199], a[192:195], a[244:247], 0
buffer_load_dwordx4 v14, s[8:11], s35 offen offset:2048 nt lds
v_mfma_f32_16x16x32_bf16 v[192:195], a[200:203], a[244:247], 0
s_waitcnt lgkmcnt(2)
buffer_load_dwordx4 v15, s[8:11], s35 offen offset:3072 nt lds
v_mfma_f32_16x16x32_bf16 v[52:55], a[212:215], a[248:251], v[52:55]
ds_read_b128 a[244:247], v37 offset:6144
v_mfma_f32_16x16x32_bf16 v[60:63], a[220:223], a[248:251], v[60:63]
s_waitcnt vmcnt(17)
ds_read_b64_tr_b16 a[192:193], v23
v_mfma_f32_16x16x32_bf16 v[48:51], a[208:211], a[248:251], v[48:51]
ds_read_b64_tr_b16 a[194:195], v23 offset:512
v_mfma_f32_16x16x32_bf16 v[56:59], a[216:219], a[248:251], v[56:59]
s_waitcnt lgkmcnt(4)
s_add_u32 m0, s53, 0xa000
s_mov_b32 s36, 0x100
buffer_load_dwordx4 v22, s[4:7], s36 offen lds
v_mfma_f32_16x16x32_bf16 v[68:71], a[212:215], a[252:255], v[68:71]
ds_read_b128 a[248:251], v37 offset:8192
v_mfma_f32_16x16x32_bf16 v[76:79], a[220:223], a[252:255], v[76:79]
ds_read_b64_tr_b16 a[196:197], v23 offset:8
v_mfma_f32_16x16x32_bf16 v[64:67], a[208:211], a[252:255], v[64:67]
ds_read_b64_tr_b16 a[198:199], v23 offset:520
v_mfma_f32_16x16x32_bf16 v[72:75], a[216:219], a[252:255], v[72:75]
s_waitcnt lgkmcnt(6)
s_add_u32 m0, s53, 0xb000
s_mov_b32 s36, 0x7100
buffer_load_dwordx4 v22, s[4:7], s36 offen lds
v_mfma_f32_16x16x32_bf16 v[84:87], a[212:215], a[240:243], v[84:87]
ds_read_b128 a[252:255], v37 offset:10240
v_mfma_f32_16x16x32_bf16 v[92:95], a[220:223], a[240:243], v[92:95]
ds_read_b64_tr_b16 a[200:201], v40
v_mfma_f32_16x16x32_bf16 v[80:83], a[208:211], a[240:243], v[80:83]
ds_read_b64_tr_b16 a[202:203], v40 offset:512
v_mfma_f32_16x16x32_bf16 v[88:91], a[216:219], a[240:243], v[88:91]
s_waitcnt lgkmcnt(8)
s_add_u32 m0, s53, 0xc000
s_mov_b32 s36, 0xe100
buffer_load_dwordx4 v22, s[4:7], s36 offen lds
v_mfma_f32_16x16x32_bf16 v[100:103], a[212:215], a[244:247], v[100:103]
ds_read_b128 a[240:243], v37 offset:12288
v_mfma_f32_16x16x32_bf16 v[108:111], a[220:223], a[244:247], v[108:111]
ds_read_b64_tr_b16 a[204:205], v40 offset:8
v_mfma_f32_16x16x32_bf16 v[96:99], a[208:211], a[244:247], v[96:99]
ds_read_b64_tr_b16 a[206:207], v40 offset:520
v_mfma_f32_16x16x32_bf16 v[104:107], a[216:219], a[244:247], v[104:107]
s_waitcnt lgkmcnt(8)
s_add_u32 m0, s53, 0xd000
s_mov_b32 s36, 0x15100
buffer_load_dwordx4 v22, s[4:7], s36 offen lds
v_mfma_f32_16x16x32_bf16 v[116:119], a[212:215], a[248:251], v[116:119]
ds_read_b128 a[244:247], v37 offset:14336
v_mfma_f32_16x16x32_bf16 v[124:127], a[220:223], a[248:251], v[124:127]
v_mfma_f32_16x16x32_bf16 v[112:115], a[208:211], a[248:251], v[112:115]
v_mfma_f32_16x16x32_bf16 v[120:123], a[216:219], a[248:251], v[120:123]
s_waitcnt lgkmcnt(6)
s_add_u32 m0, s53, 0xe000
s_mov_b32 s36, 0x1c100
buffer_load_dwordx4 v22, s[4:7], s36 offen lds
v_mfma_f32_16x16x32_bf16 v[140:143], a[212:215], a[252:255], v[140:143]
ds_read_b128 a[248:251], v37 offset:16384
v_mfma_f32_16x16x32_bf16 v[136:139], a[220:223], a[252:255], v[136:139]
s_add_u32 m0, s33, 0
s_add_u32 s35, s37, 0x180000
v_mfma_f32_16x16x32_bf16 v[132:135], a[208:211], a[252:255], v[132:135]
s_waitcnt lgkmcnt(2)
buffer_load_dwordx4 v12, s[8:11], s35 offen nt lds
v_mfma_f32_16x16x32_bf16 v[128:131], a[216:219], a[252:255], v[128:131]
v_mfma_f32_16x16x32_bf16 v[156:159], a[212:215], a[240:243], v[156:159]
ds_read_b128 a[252:255], v37 offset:18432
v_mfma_f32_16x16x32_bf16 v[152:155], a[220:223], a[240:243], v[152:155]
buffer_load_dwordx4 v13, s[8:11], s35 offen offset:1024 nt lds
v_mfma_f32_16x16x32_bf16 v[148:151], a[208:211], a[240:243], v[148:151]
v_mfma_f32_16x16x32_bf16 v[144:147], a[216:219], a[240:243], v[144:147]
s_waitcnt lgkmcnt(2)
v_mfma_f32_16x16x32_bf16 v[172:175], a[212:215], a[244:247], v[172:175]
s_waitcnt vmcnt(15)
s_waitcnt lgkmcnt(0)
s_barrier
ds_read_b128 a[240:243], v36 offset:20480
v_mfma_f32_16x16x32_bf16 v[168:171], a[220:223], a[244:247], v[168:171]
buffer_load_dwordx4 v14, s[8:11], s35 offen offset:2048 nt lds
v_mfma_f32_16x16x32_bf16 v[164:167], a[208:211], a[244:247], v[164:167]
v_mfma_f32_16x16x32_bf16 v[160:163], a[216:219], a[244:247], v[160:163]
v_mfma_f32_16x16x32_bf16 v[188:191], a[212:215], a[248:251], v[188:191]
ds_read_b128 a[244:247], v36 offset:22528
v_mfma_f32_16x16x32_bf16 v[184:187], a[220:223], a[248:251], v[184:187]
buffer_load_dwordx4 v15, s[8:11], s35 offen offset:3072 nt lds
v_mfma_f32_16x16x32_bf16 v[180:183], a[208:211], a[248:251], v[180:183]
v_mfma_f32_16x16x32_bf16 v[176:179], a[216:219], a[248:251], v[176:179]
v_mfma_f32_16x16x32_bf16 v[204:207], a[212:215], a[252:255], v[204:207]
ds_read_b128 a[248:251], v36 offset:24576
v_mfma_f32_16x16x32_bf16 v[200:203], a[220:223], a[252:255], v[200:203]
v_mfma_f32_16x16x32_bf16 v[196:199], a[208:211], a[252:255], v[196:199]
v_mfma_f32_16x16x32_bf16 v[192:195], a[216:219], a[252:255], v[192:195]
s_waitcnt lgkmcnt(2)
v_mfma_f32_16x16x32_bf16 v[52:55], a[196:199], a[240:243], v[52:55]
ds_read_b128 a[252:255], v36 offset:26624
v_mfma_f32_16x16x32_bf16 v[60:63], a[204:207], a[240:243], v[60:63]
s_waitcnt vmcnt(9)
ds_read_b64_tr_b16 a[208:209], v23 offset:4096
v_mfma_f32_16x16x32_bf16 v[48:51], a[192:195], a[240:243], v[48:51]
ds_read_b64_tr_b16 a[210:211], v23 offset:4608
v_mfma_f32_16x16x32_bf16 v[56:59], a[200:203], a[240:243], v[56:59]
s_waitcnt lgkmcnt(4)
s_add_u32 m0, s53, 0
s_mov_b32 s36, 0x180
buffer_load_dwordx4 v22, s[4:7], s36 offen lds
v_mfma_f32_16x16x32_bf16 v[68:71], a[196:199], a[244:247], v[68:71]
ds_read_b128 a[240:243], v36 offset:28672
v_mfma_f32_16x16x32_bf16 v[76:79], a[204:207], a[244:247], v[76:79]
ds_read_b64_tr_b16 a[212:213], v23 offset:4104
v_mfma_f32_16x16x32_bf16 v[64:67], a[192:195], a[244:247], v[64:67]
ds_read_b64_tr_b16 a[214:215], v23 offset:4616
v_mfma_f32_16x16x32_bf16 v[72:75], a[200:203], a[244:247], v[72:75]
s_waitcnt lgkmcnt(6)
s_add_u32 m0, s53, 0x1000
s_mov_b32 s36, 0x7180
buffer_load_dwordx4 v22, s[4:7], s36 offen lds
v_mfma_f32_16x16x32_bf16 v[84:87], a[196:199], a[248:251], v[84:87]
ds_read_b128 a[244:247], v36 offset:30720
v_mfma_f32_16x16x32_bf16 v[92:95], a[204:207], a[248:251], v[92:95]
ds_read_b64_tr_b16 a[216:217], v40 offset:4096
v_mfma_f32_16x16x32_bf16 v[80:83], a[192:195], a[248:251], v[80:83]
ds_read_b64_tr_b16 a[218:219], v40 offset:4608
v_mfma_f32_16x16x32_bf16 v[88:91], a[200:203], a[248:251], v[88:91]
s_waitcnt lgkmcnt(8)
s_add_u32 m0, s53, 0x2000
s_mov_b32 s36, 0xe180
buffer_load_dwordx4 v22, s[4:7], s36 offen lds
v_mfma_f32_16x16x32_bf16 v[100:103], a[196:199], a[252:255], v[100:103]
ds_read_b128 a[248:251], v36 offset:32768
v_mfma_f32_16x16x32_bf16 v[108:111], a[204:207], a[252:255], v[108:111]
ds_read_b64_tr_b16 a[220:221], v40 offset:4104
v_mfma_f32_16x16x32_bf16 v[96:99], a[192:195], a[252:255], v[96:99]
ds_read_b64_tr_b16 a[222:223], v40 offset:4616
v_mfma_f32_16x16x32_bf16 v[104:107], a[200:203], a[252:255], v[104:107]
s_waitcnt lgkmcnt(8)
s_add_u32 m0, s53, 0x3000
s_mov_b32 s36, 0x15180
buffer_load_dwordx4 v22, s[4:7], s36 offen lds
v_mfma_f32_16x16x32_bf16 v[116:119], a[196:199], a[240:243], v[116:119]
ds_read_b128 a[252:255], v36 offset:34816
v_mfma_f32_16x16x32_bf16 v[124:127], a[204:207], a[240:243], v[124:127]
v_mfma_f32_16x16x32_bf16 v[112:115], a[192:195], a[240:243], v[112:115]
v_mfma_f32_16x16x32_bf16 v[120:123], a[200:203], a[240:243], v[120:123]
s_waitcnt lgkmcnt(6)
s_add_u32 m0, s53, 0x4000
s_mov_b32 s36, 0x1c180
buffer_load_dwordx4 v22, s[4:7], s36 offen lds
v_mfma_f32_16x16x32_bf16 v[140:143], a[196:199], a[244:247], v[140:143]
ds_read_b128 a[240:243], v36 offset:36864
v_mfma_f32_16x16x32_bf16 v[136:139], a[204:207], a[244:247], v[136:139]
s_add_u32 m0, s33, 0x1000
s_add_u32 s35, s37, 0x1c0000
v_mfma_f32_16x16x32_bf16 v[132:135], a[192:195], a[244:247], v[132:135]
s_waitcnt lgkmcnt(2)
buffer_load_dwordx4 v12, s[8:11], s35 offen nt lds
v_mfma_f32_16x16x32_bf16 v[128:131], a[200:203], a[244:247], v[128:131]
v_mfma_f32_16x16x32_bf16 v[156:159], a[196:199], a[248:251], v[156:159]
ds_read_b128 a[244:247], v36 offset:38912
v_mfma_f32_16x16x32_bf16 v[152:155], a[204:207], a[248:251], v[152:155]
buffer_load_dwordx4 v13, s[8:11], s35 offen offset:1024 nt lds
v_mfma_f32_16x16x32_bf16 v[148:151], a[192:195], a[248:251], v[148:151]
v_mfma_f32_16x16x32_bf16 v[144:147], a[200:203], a[248:251], v[144:147]
s_waitcnt lgkmcnt(2)
v_mfma_f32_16x16x32_bf16 v[172:175], a[196:199], a[252:255], v[172:175]
ds_read_b128 a[248:251], v37 offset:20480
v_mfma_f32_16x16x32_bf16 v[168:171], a[204:207], a[252:255], v[168:171]
buffer_load_dwordx4 v14, s[8:11], s35 offen offset:2048 nt lds
v_mfma_f32_16x16x32_bf16 v[164:167], a[192:195], a[252:255], v[164:167]
v_mfma_f32_16x16x32_bf16 v[160:163], a[200:203], a[252:255], v[160:163]
s_waitcnt lgkmcnt(2)
v_mfma_f32_16x16x32_bf16 v[188:191], a[196:199], a[240:243], v[188:191]
ds_read_b128 a[252:255], v37 offset:22528
v_mfma_f32_16x16x32_bf16 v[184:187], a[204:207], a[240:243], v[184:187]
buffer_load_dwordx4 v15, s[8:11], s35 offen offset:3072 nt lds
v_mfma_f32_16x16x32_bf16 v[180:183], a[192:195], a[240:243], v[180:183]
v_mfma_f32_16x16x32_bf16 v[176:179], a[200:203], a[240:243], v[176:179]
s_waitcnt lgkmcnt(2)
v_mfma_f32_16x16x32_bf16 v[204:207], a[196:199], a[244:247], v[204:207]
ds_read_b128 a[240:243], v37 offset:24576
v_mfma_f32_16x16x32_bf16 v[200:203], a[204:207], a[244:247], v[200:203]
v_mfma_f32_16x16x32_bf16 v[196:199], a[192:195], a[244:247], v[196:199]
v_mfma_f32_16x16x32_bf16 v[192:195], a[200:203], a[244:247], v[192:195]
s_waitcnt lgkmcnt(2)
v_mfma_f32_16x16x32_bf16 v[52:55], a[212:215], a[248:251], v[52:55]
ds_read_b128 a[244:247], v37 offset:26624
v_mfma_f32_16x16x32_bf16 v[60:63], a[220:223], a[248:251], v[60:63]
ds_read_b64_tr_b16 a[192:193], v23 offset:8192
v_mfma_f32_16x16x32_bf16 v[48:51], a[208:211], a[248:251], v[48:51]
ds_read_b64_tr_b16 a[194:195], v23 offset:8704
v_mfma_f32_16x16x32_bf16 v[56:59], a[216:219], a[248:251], v[56:59]
s_waitcnt lgkmcnt(4)
v_mfma_f32_16x16x32_bf16 v[68:71], a[212:215], a[252:255], v[68:71]
ds_read_b128 a[248:251], v37 offset:28672
v_mfma_f32_16x16x32_bf16 v[76:79], a[220:223], a[252:255], v[76:79]
ds_read_b64_tr_b16 a[196:197], v23 offset:8200
v_mfma_f32_16x16x32_bf16 v[64:67], a[208:211], a[252:255], v[64:67]
ds_read_b64_tr_b16 a[198:199], v23 offset:8712
v_mfma_f32_16x16x32_bf16 v[72:75], a[216:219], a[252:255], v[72:75]
s_waitcnt lgkmcnt(6)
v_mfma_f32_16x16x32_bf16 v[84:87], a[212:215], a[240:243], v[84:87]
ds_read_b128 a[252:255], v37 offset:30720
v_mfma_f32_16x16x32_bf16 v[92:95], a[220:223], a[240:243], v[92:95]
ds_read_b64_tr_b16 a[200:201], v40 offset:8192
v_mfma_f32_16x16x32_bf16 v[80:83], a[208:211], a[240:243], v[80:83]
ds_read_b64_tr_b16 a[202:203], v40 offset:8704
v_mfma_f32_16x16x32_bf16 v[88:91], a[216:219], a[240:243], v[88:91]
s_waitcnt lgkmcnt(8)
v_mfma_f32_16x16x32_bf16 v[100:103], a[212:215], a[244:247], v[100:103]
ds_read_b128 a[240:243], v37 offset:32768
v_mfma_f32_16x16x32_bf16 v[108:111], a[220:223], a[244:247], v[108:111]
ds_read_b64_tr_b16 a[204:205], v40 offset:8200
v_mfma_f32_16x16x32_bf16 v[96:99], a[208:211], a[244:247], v[96:99]
ds_read_b64_tr_b16 a[206:207], v40 offset:8712
v_mfma_f32_16x16x32_bf16 v[104:107], a[216:219], a[244:247], v[104:107]
s_waitcnt lgkmcnt(8)
v_mfma_f32_16x16x32_bf16 v[116:119], a[212:215], a[248:251], v[116:119]
ds_read_b128 a[244:247], v37 offset:34816
v_mfma_f32_16x16x32_bf16 v[124:127], a[220:223], a[248:251], v[124:127]
v_mfma_f32_16x16x32_bf16 v[112:115], a[208:211], a[248:251], v[112:115]
v_mfma_f32_16x16x32_bf16 v[120:123], a[216:219], a[248:251], v[120:123]
s_waitcnt lgkmcnt(6)
v_mfma_f32_16x16x32_bf16 v[140:143], a[212:215], a[252:255], v[140:143]
ds_read_b128 a[248:251], v37 offset:36864
v_mfma_f32_16x16x32_bf16 v[136:139], a[220:223], a[252:255], v[136:139]
s_add_u32 m0, s33, 0x2000
s_add_u32 s35, s37, 0x200000
v_mfma_f32_16x16x32_bf16 v[132:135], a[208:211], a[252:255], v[132:135]
s_waitcnt lgkmcnt(2)
buffer_load_dwordx4 v12, s[8:11], s35 offen nt lds
v_mfma_f32_16x16x32_bf16 v[128:131], a[216:219], a[252:255], v[128:131]
v_mfma_f32_16x16x32_bf16 v[156:159], a[212:215], a[240:243], v[156:159]
ds_read_b128 a[252:255], v37 offset:38912
v_mfma_f32_16x16x32_bf16 v[152:155], a[220:223], a[240:243], v[152:155]
buffer_load_dwordx4 v13, s[8:11], s35 offen offset:1024 nt lds
v_mfma_f32_16x16x32_bf16 v[148:151], a[208:211], a[240:243], v[148:151]
v_mfma_f32_16x16x32_bf16 v[144:147], a[216:219], a[240:243], v[144:147]
s_waitcnt lgkmcnt(2)
v_mfma_f32_16x16x32_bf16 v[172:175], a[212:215], a[244:247], v[172:175]
s_waitcnt vmcnt(15)
s_waitcnt lgkmcnt(0)
s_barrier
ds_read_b128 a[240:243], v36 offset:40960
v_mfma_f32_16x16x32_bf16 v[168:171], a[220:223], a[244:247], v[168:171]
buffer_load_dwordx4 v14, s[8:11], s35 offen offset:2048 nt lds
v_mfma_f32_16x16x32_bf16 v[164:167], a[208:211], a[244:247], v[164:167]
v_mfma_f32_16x16x32_bf16 v[160:163], a[216:219], a[244:247], v[160:163]
v_mfma_f32_16x16x32_bf16 v[188:191], a[212:215], a[248:251], v[188:191]
ds_read_b128 a[244:247], v36 offset:43008
v_mfma_f32_16x16x32_bf16 v[184:187], a[220:223], a[248:251], v[184:187]
buffer_load_dwordx4 v15, s[8:11], s35 offen offset:3072 nt lds
v_mfma_f32_16x16x32_bf16 v[180:183], a[208:211], a[248:251], v[180:183]
v_mfma_f32_16x16x32_bf16 v[176:179], a[216:219], a[248:251], v[176:179]
v_mfma_f32_16x16x32_bf16 v[204:207], a[212:215], a[252:255], v[204:207]
ds_read_b128 a[248:251], v36 offset:45056
v_mfma_f32_16x16x32_bf16 v[200:203], a[220:223], a[252:255], v[200:203]
v_mfma_f32_16x16x32_bf16 v[196:199], a[208:211], a[252:255], v[196:199]
v_mfma_f32_16x16x32_bf16 v[192:195], a[216:219], a[252:255], v[192:195]
s_waitcnt lgkmcnt(2)
v_mfma_f32_16x16x32_bf16 v[52:55], a[196:199], a[240:243], v[52:55]
ds_read_b128 a[252:255], v36 offset:47104
v_mfma_f32_16x16x32_bf16 v[60:63], a[204:207], a[240:243], v[60:63]
ds_read_b64_tr_b16 a[208:209], v23 offset:12288
v_mfma_f32_16x16x32_bf16 v[48:51], a[192:195], a[240:243], v[48:51]
ds_read_b64_tr_b16 a[210:211], v23 offset:12800
v_mfma_f32_16x16x32_bf16 v[56:59], a[200:203], a[240:243], v[56:59]
s_waitcnt lgkmcnt(4)
s_add_u32 m0, s53, 0x5000
s_mov_b32 s36, 0x200
buffer_load_dwordx4 v22, s[4:7], s36 offen lds
v_mfma_f32_16x16x32_bf16 v[68:71], a[196:199], a[244:247], v[68:71]
ds_read_b128 a[240:243], v36 offset:49152
v_mfma_f32_16x16x32_bf16 v[76:79], a[204:207], a[244:247], v[76:79]
ds_read_b64_tr_b16 a[212:213], v23 offset:12296
v_mfma_f32_16x16x32_bf16 v[64:67], a[192:195], a[244:247], v[64:67]
ds_read_b64_tr_b16 a[214:215], v23 offset:12808
v_mfma_f32_16x16x32_bf16 v[72:75], a[200:203], a[244:247], v[72:75]
s_waitcnt lgkmcnt(6)
s_add_u32 m0, s53, 0x6000
s_mov_b32 s36, 0x7200
buffer_load_dwordx4 v22, s[4:7], s36 offen lds
v_mfma_f32_16x16x32_bf16 v[84:87], a[196:199], a[248:251], v[84:87]
ds_read_b128 a[244:247], v36 offset:51200
v_mfma_f32_16x16x32_bf16 v[92:95], a[204:207], a[248:251], v[92:95]
ds_read_b64_tr_b16 a[216:217], v40 offset:12288
v_mfma_f32_16x16x32_bf16 v[80:83], a[192:195], a[248:251], v[80:83]
ds_read_b64_tr_b16 a[218:219], v40 offset:12800
v_mfma_f32_16x16x32_bf16 v[88:91], a[200:203], a[248:251], v[88:91]
s_waitcnt lgkmcnt(8)
s_add_u32 m0, s53, 0x7000
s_mov_b32 s36, 0xe200
buffer_load_dwordx4 v22, s[4:7], s36 offen lds
v_mfma_f32_16x16x32_bf16 v[100:103], a[196:199], a[252:255], v[100:103]
ds_read_b128 a[248:251], v36 offset:53248
v_mfma_f32_16x16x32_bf16 v[108:111], a[204:207], a[252:255], v[108:111]
ds_read_b64_tr_b16 a[220:221], v40 offset:12296
v_mfma_f32_16x16x32_bf16 v[96:99], a[192:195], a[252:255], v[96:99]
ds_read_b64_tr_b16 a[222:223], v40 offset:12808
v_mfma_f32_16x16x32_bf16 v[104:107], a[200:203], a[252:255], v[104:107]
s_waitcnt lgkmcnt(8)
s_add_u32 m0, s53, 0x8000
s_mov_b32 s36, 0x15200
buffer_load_dwordx4 v22, s[4:7], s36 offen lds
v_mfma_f32_16x16x32_bf16 v[116:119], a[196:199], a[240:243], v[116:119]
ds_read_b128 a[252:255], v36 offset:55296
v_mfma_f32_16x16x32_bf16 v[124:127], a[204:207], a[240:243], v[124:127]
v_mfma_f32_16x16x32_bf16 v[112:115], a[192:195], a[240:243], v[112:115]
v_mfma_f32_16x16x32_bf16 v[120:123], a[200:203], a[240:243], v[120:123]
s_waitcnt lgkmcnt(6)
s_add_u32 m0, s53, 0x9000
s_mov_b32 s36, 0x1c200
buffer_load_dwordx4 v22, s[4:7], s36 offen lds
v_mfma_f32_16x16x32_bf16 v[140:143], a[196:199], a[244:247], v[140:143]
ds_read_b128 a[240:243], v36 offset:57344
v_mfma_f32_16x16x32_bf16 v[136:139], a[204:207], a[244:247], v[136:139]
s_add_u32 m0, s33, 0x3000
s_add_u32 s35, s37, 0x240000
v_mfma_f32_16x16x32_bf16 v[132:135], a[192:195], a[244:247], v[132:135]
s_waitcnt lgkmcnt(2)
buffer_load_dwordx4 v12, s[8:11], s35 offen nt lds
v_mfma_f32_16x16x32_bf16 v[128:131], a[200:203], a[244:247], v[128:131]
v_mfma_f32_16x16x32_bf16 v[156:159], a[196:199], a[248:251], v[156:159]
ds_read_b128 a[244:247], v36 offset:59392
v_mfma_f32_16x16x32_bf16 v[152:155], a[204:207], a[248:251], v[152:155]
buffer_load_dwordx4 v13, s[8:11], s35 offen offset:1024 nt lds
v_mfma_f32_16x16x32_bf16 v[148:151], a[192:195], a[248:251], v[148:151]
v_mfma_f32_16x16x32_bf16 v[144:147], a[200:203], a[248:251], v[144:147]
s_waitcnt lgkmcnt(2)
v_mfma_f32_16x16x32_bf16 v[172:175], a[196:199], a[252:255], v[172:175]
ds_read_b128 a[248:251], v37 offset:40960
v_mfma_f32_16x16x32_bf16 v[168:171], a[204:207], a[252:255], v[168:171]
buffer_load_dwordx4 v14, s[8:11], s35 offen offset:2048 nt lds
v_mfma_f32_16x16x32_bf16 v[164:167], a[192:195], a[252:255], v[164:167]
v_mfma_f32_16x16x32_bf16 v[160:163], a[200:203], a[252:255], v[160:163]
s_waitcnt lgkmcnt(2)
v_mfma_f32_16x16x32_bf16 v[188:191], a[196:199], a[240:243], v[188:191]
ds_read_b128 a[252:255], v37 offset:43008
v_mfma_f32_16x16x32_bf16 v[184:187], a[204:207], a[240:243], v[184:187]
buffer_load_dwordx4 v15, s[8:11], s35 offen offset:3072 nt lds
v_mfma_f32_16x16x32_bf16 v[180:183], a[192:195], a[240:243], v[180:183]
v_mfma_f32_16x16x32_bf16 v[176:179], a[200:203], a[240:243], v[176:179]
s_waitcnt lgkmcnt(2)
v_mfma_f32_16x16x32_bf16 v[204:207], a[196:199], a[244:247], v[204:207]
ds_read_b128 a[240:243], v37 offset:45056
v_mfma_f32_16x16x32_bf16 v[200:203], a[204:207], a[244:247], v[200:203]
v_mfma_f32_16x16x32_bf16 v[196:199], a[192:195], a[244:247], v[196:199]
v_mfma_f32_16x16x32_bf16 v[192:195], a[200:203], a[244:247], v[192:195]
s_waitcnt lgkmcnt(2)
v_mfma_f32_16x16x32_bf16 v[52:55], a[212:215], a[248:251], v[52:55]
ds_read_b128 a[244:247], v37 offset:47104
v_mfma_f32_16x16x32_bf16 v[60:63], a[220:223], a[248:251], v[60:63]
s_waitcnt vmcnt(22)
ds_read_b64_tr_b16 a[192:193], v23
v_mfma_f32_16x16x32_bf16 v[48:51], a[208:211], a[248:251], v[48:51]
ds_read_b64_tr_b16 a[194:195], v23 offset:512
v_mfma_f32_16x16x32_bf16 v[56:59], a[216:219], a[248:251], v[56:59]
s_waitcnt lgkmcnt(4)
v_mfma_f32_16x16x32_bf16 v[68:71], a[212:215], a[252:255], v[68:71]
ds_read_b128 a[248:251], v37 offset:49152
v_mfma_f32_16x16x32_bf16 v[76:79], a[220:223], a[252:255], v[76:79]
ds_read_b64_tr_b16 a[196:197], v23 offset:8
v_mfma_f32_16x16x32_bf16 v[64:67], a[208:211], a[252:255], v[64:67]
ds_read_b64_tr_b16 a[198:199], v23 offset:520
v_mfma_f32_16x16x32_bf16 v[72:75], a[216:219], a[252:255], v[72:75]
s_waitcnt lgkmcnt(6)
v_mfma_f32_16x16x32_bf16 v[84:87], a[212:215], a[240:243], v[84:87]
ds_read_b128 a[252:255], v37 offset:51200
v_mfma_f32_16x16x32_bf16 v[92:95], a[220:223], a[240:243], v[92:95]
ds_read_b64_tr_b16 a[200:201], v40
v_mfma_f32_16x16x32_bf16 v[80:83], a[208:211], a[240:243], v[80:83]
ds_read_b64_tr_b16 a[202:203], v40 offset:512
v_mfma_f32_16x16x32_bf16 v[88:91], a[216:219], a[240:243], v[88:91]
s_waitcnt lgkmcnt(8)
v_mfma_f32_16x16x32_bf16 v[100:103], a[212:215], a[244:247], v[100:103]
ds_read_b128 a[240:243], v37 offset:53248
v_mfma_f32_16x16x32_bf16 v[108:111], a[220:223], a[244:247], v[108:111]
ds_read_b64_tr_b16 a[204:205], v40 offset:8
v_mfma_f32_16x16x32_bf16 v[96:99], a[208:211], a[244:247], v[96:99]
ds_read_b64_tr_b16 a[206:207], v40 offset:520
v_mfma_f32_16x16x32_bf16 v[104:107], a[216:219], a[244:247], v[104:107]
s_waitcnt lgkmcnt(8)
v_mfma_f32_16x16x32_bf16 v[116:119], a[212:215], a[248:251], v[116:119]
ds_read_b128 a[244:247], v37 offset:55296
v_mfma_f32_16x16x32_bf16 v[124:127], a[220:223], a[248:251], v[124:127]
v_mfma_f32_16x16x32_bf16 v[112:115], a[208:211], a[248:251], v[112:115]
v_mfma_f32_16x16x32_bf16 v[120:123], a[216:219], a[248:251], v[120:123]
s_waitcnt lgkmcnt(6)
v_mfma_f32_16x16x32_bf16 v[140:143], a[212:215], a[252:255], v[140:143]
ds_read_b128 a[248:251], v37 offset:57344
v_mfma_f32_16x16x32_bf16 v[136:139], a[220:223], a[252:255], v[136:139]
s_add_u32 m0, s33, 0
s_add_u32 s35, s37, 0x280000
v_mfma_f32_16x16x32_bf16 v[132:135], a[208:211], a[252:255], v[132:135]
s_waitcnt lgkmcnt(2)
buffer_load_dwordx4 v12, s[8:11], s35 offen nt lds
v_mfma_f32_16x16x32_bf16 v[128:131], a[216:219], a[252:255], v[128:131]
v_mfma_f32_16x16x32_bf16 v[156:159], a[212:215], a[240:243], v[156:159]
ds_read_b128 a[252:255], v37 offset:59392
v_mfma_f32_16x16x32_bf16 v[152:155], a[220:223], a[240:243], v[152:155]
buffer_load_dwordx4 v13, s[8:11], s35 offen offset:1024 nt lds
v_mfma_f32_16x16x32_bf16 v[148:151], a[208:211], a[240:243], v[148:151]
v_mfma_f32_16x16x32_bf16 v[144:147], a[216:219], a[240:243], v[144:147]
s_waitcnt lgkmcnt(2)
v_mfma_f32_16x16x32_bf16 v[172:175], a[212:215], a[244:247], v[172:175]
s_waitcnt vmcnt(19)
s_waitcnt lgkmcnt(0)
s_barrier
ds_read_b128 a[240:243], v36
v_mfma_f32_16x16x32_bf16 v[168:171], a[220:223], a[244:247], v[168:171]
buffer_load_dwordx4 v14, s[8:11], s35 offen offset:2048 nt lds
v_mfma_f32_16x16x32_bf16 v[164:167], a[208:211], a[244:247], v[164:167]
v_mfma_f32_16x16x32_bf16 v[160:163], a[216:219], a[244:247], v[160:163]
v_mfma_f32_16x16x32_bf16 v[188:191], a[212:215], a[248:251], v[188:191]
ds_read_b128 a[244:247], v36 offset:2048
v_mfma_f32_16x16x32_bf16 v[184:187], a[220:223], a[248:251], v[184:187]
buffer_load_dwordx4 v15, s[8:11], s35 offen offset:3072 nt lds
v_mfma_f32_16x16x32_bf16 v[180:183], a[208:211], a[248:251], v[180:183]
v_mfma_f32_16x16x32_bf16 v[176:179], a[216:219], a[248:251], v[176:179]
v_mfma_f32_16x16x32_bf16 v[204:207], a[212:215], a[252:255], v[204:207]
ds_read_b128 a[248:251], v36 offset:4096
v_mfma_f32_16x16x32_bf16 v[200:203], a[220:223], a[252:255], v[200:203]
v_mfma_f32_16x16x32_bf16 v[196:199], a[208:211], a[252:255], v[196:199]
v_mfma_f32_16x16x32_bf16 v[192:195], a[216:219], a[252:255], v[192:195]
s_waitcnt lgkmcnt(2)
v_mfma_f32_16x16x32_bf16 v[52:55], a[196:199], a[240:243], v[52:55]
ds_read_b128 a[252:255], v36 offset:6144
v_mfma_f32_16x16x32_bf16 v[60:63], a[204:207], a[240:243], v[60:63]
s_waitcnt vmcnt(17)
ds_read_b64_tr_b16 a[208:209], v23 offset:4096
v_mfma_f32_16x16x32_bf16 v[48:51], a[192:195], a[240:243], v[48:51]
ds_read_b64_tr_b16 a[210:211], v23 offset:4608
v_mfma_f32_16x16x32_bf16 v[56:59], a[200:203], a[240:243], v[56:59]
s_waitcnt lgkmcnt(4)
s_add_u32 m0, s53, 0xa000
s_mov_b32 s36, 0x280
buffer_load_dwordx4 v22, s[4:7], s36 offen lds
v_mfma_f32_16x16x32_bf16 v[68:71], a[196:199], a[244:247], v[68:71]
ds_read_b128 a[240:243], v36 offset:8192
v_mfma_f32_16x16x32_bf16 v[76:79], a[204:207], a[244:247], v[76:79]
ds_read_b64_tr_b16 a[212:213], v23 offset:4104
v_mfma_f32_16x16x32_bf16 v[64:67], a[192:195], a[244:247], v[64:67]
ds_read_b64_tr_b16 a[214:215], v23 offset:4616
v_mfma_f32_16x16x32_bf16 v[72:75], a[200:203], a[244:247], v[72:75]
s_waitcnt lgkmcnt(6)
s_add_u32 m0, s53, 0xb000
s_mov_b32 s36, 0x7280
buffer_load_dwordx4 v22, s[4:7], s36 offen lds
v_mfma_f32_16x16x32_bf16 v[84:87], a[196:199], a[248:251], v[84:87]
ds_read_b128 a[244:247], v36 offset:10240
v_mfma_f32_16x16x32_bf16 v[92:95], a[204:207], a[248:251], v[92:95]
ds_read_b64_tr_b16 a[216:217], v40 offset:4096
v_mfma_f32_16x16x32_bf16 v[80:83], a[192:195], a[248:251], v[80:83]
ds_read_b64_tr_b16 a[218:219], v40 offset:4608
v_mfma_f32_16x16x32_bf16 v[88:91], a[200:203], a[248:251], v[88:91]
s_waitcnt lgkmcnt(8)
s_add_u32 m0, s53, 0xc000
s_mov_b32 s36, 0xe280
buffer_load_dwordx4 v22, s[4:7], s36 offen lds
v_mfma_f32_16x16x32_bf16 v[100:103], a[196:199], a[252:255], v[100:103]
ds_read_b128 a[248:251], v36 offset:12288
v_mfma_f32_16x16x32_bf16 v[108:111], a[204:207], a[252:255], v[108:111]
ds_read_b64_tr_b16 a[220:221], v40 offset:4104
v_mfma_f32_16x16x32_bf16 v[96:99], a[192:195], a[252:255], v[96:99]
ds_read_b64_tr_b16 a[222:223], v40 offset:4616
v_mfma_f32_16x16x32_bf16 v[104:107], a[200:203], a[252:255], v[104:107]
s_waitcnt lgkmcnt(8)
s_add_u32 m0, s53, 0xd000
s_mov_b32 s36, 0x15280
buffer_load_dwordx4 v22, s[4:7], s36 offen lds
v_mfma_f32_16x16x32_bf16 v[116:119], a[196:199], a[240:243], v[116:119]
ds_read_b128 a[252:255], v36 offset:14336
v_mfma_f32_16x16x32_bf16 v[124:127], a[204:207], a[240:243], v[124:127]
v_mfma_f32_16x16x32_bf16 v[112:115], a[192:195], a[240:243], v[112:115]
v_mfma_f32_16x16x32_bf16 v[120:123], a[200:203], a[240:243], v[120:123]
s_waitcnt lgkmcnt(6)
s_add_u32 m0, s53, 0xe000
s_mov_b32 s36, 0x1c280
buffer_load_dwordx4 v22, s[4:7], s36 offen lds
v_mfma_f32_16x16x32_bf16 v[140:143], a[196:199], a[244:247], v[140:143]
ds_read_b128 a[240:243], v36 offset:16384
v_mfma_f32_16x16x32_bf16 v[136:139], a[204:207], a[244:247], v[136:139]
s_add_u32 m0, s33, 0x1000
s_add_u32 s35, s37, 0x2c0000
v_mfma_f32_16x16x32_bf16 v[132:135], a[192:195], a[244:247], v[132:135]
s_waitcnt lgkmcnt(2)
buffer_load_dwordx4 v12, s[8:11], s35 offen nt lds
v_mfma_f32_16x16x32_bf16 v[128:131], a[200:203], a[244:247], v[128:131]
v_mfma_f32_16x16x32_bf16 v[156:159], a[196:199], a[248:251], v[156:159]
ds_read_b128 a[244:247], v36 offset:18432
v_mfma_f32_16x16x32_bf16 v[152:155], a[204:207], a[248:251], v[152:155]
buffer_load_dwordx4 v13, s[8:11], s35 offen offset:1024 nt lds
v_mfma_f32_16x16x32_bf16 v[148:151], a[192:195], a[248:251], v[148:151]
v_mfma_f32_16x16x32_bf16 v[144:147], a[200:203], a[248:251], v[144:147]
s_waitcnt lgkmcnt(2)
v_mfma_f32_16x16x32_bf16 v[172:175], a[196:199], a[252:255], v[172:175]
ds_read_b128 a[248:251], v37
v_mfma_f32_16x16x32_bf16 v[168:171], a[204:207], a[252:255], v[168:171]
buffer_load_dwordx4 v14, s[8:11], s35 offen offset:2048 nt lds
v_mfma_f32_16x16x32_bf16 v[164:167], a[192:195], a[252:255], v[164:167]
v_mfma_f32_16x16x32_bf16 v[160:163], a[200:203], a[252:255], v[160:163]
s_waitcnt lgkmcnt(2)
v_mfma_f32_16x16x32_bf16 v[188:191], a[196:199], a[240:243], v[188:191]
ds_read_b128 a[252:255], v37 offset:2048
v_mfma_f32_16x16x32_bf16 v[184:187], a[204:207], a[240:243], v[184:187]
buffer_load_dwordx4 v15, s[8:11], s35 offen offset:3072 nt lds
v_mfma_f32_16x16x32_bf16 v[180:183], a[192:195], a[240:243], v[180:183]
v_mfma_f32_16x16x32_bf16 v[176:179], a[200:203], a[240:243], v[176:179]
s_waitcnt lgkmcnt(2)
v_mfma_f32_16x16x32_bf16 v[204:207], a[196:199], a[244:247], v[204:207]
ds_read_b128 a[240:243], v37 offset:4096
v_mfma_f32_16x16x32_bf16 v[200:203], a[204:207], a[244:247], v[200:203]
v_mfma_f32_16x16x32_bf16 v[196:199], a[192:195], a[244:247], v[196:199]
v_mfma_f32_16x16x32_bf16 v[192:195], a[200:203], a[244:247], v[192:195]
s_waitcnt lgkmcnt(2)
v_mfma_f32_16x16x32_bf16 v[52:55], a[212:215], a[248:251], v[52:55]
ds_read_b128 a[244:247], v37 offset:6144
v_mfma_f32_16x16x32_bf16 v[60:63], a[220:223], a[248:251], v[60:63]
s_waitcnt vmcnt(22)
ds_read_b64_tr_b16 a[192:193], v23 offset:8192
v_mfma_f32_16x16x32_bf16 v[48:51], a[208:211], a[248:251], v[48:51]
ds_read_b64_tr_b16 a[194:195], v23 offset:8704
v_mfma_f32_16x16x32_bf16 v[56:59], a[216:219], a[248:251], v[56:59]
s_waitcnt lgkmcnt(4)
v_mfma_f32_16x16x32_bf16 v[68:71], a[212:215], a[252:255], v[68:71]
ds_read_b128 a[248:251], v37 offset:8192
v_mfma_f32_16x16x32_bf16 v[76:79], a[220:223], a[252:255], v[76:79]
ds_read_b64_tr_b16 a[196:197], v23 offset:8200
v_mfma_f32_16x16x32_bf16 v[64:67], a[208:211], a[252:255], v[64:67]
ds_read_b64_tr_b16 a[198:199], v23 offset:8712
v_mfma_f32_16x16x32_bf16 v[72:75], a[216:219], a[252:255], v[72:75]
s_waitcnt lgkmcnt(6)
v_mfma_f32_16x16x32_bf16 v[84:87], a[212:215], a[240:243], v[84:87]
ds_read_b128 a[252:255], v37 offset:10240
v_mfma_f32_16x16x32_bf16 v[92:95], a[220:223], a[240:243], v[92:95]
ds_read_b64_tr_b16 a[200:201], v40 offset:8192
v_mfma_f32_16x16x32_bf16 v[80:83], a[208:211], a[240:243], v[80:83]
ds_read_b64_tr_b16 a[202:203], v40 offset:8704
v_mfma_f32_16x16x32_bf16 v[88:91], a[216:219], a[240:243], v[88:91]
s_waitcnt lgkmcnt(8)
v_mfma_f32_16x16x32_bf16 v[100:103], a[212:215], a[244:247], v[100:103]
ds_read_b128 a[240:243], v37 offset:12288
v_mfma_f32_16x16x32_bf16 v[108:111], a[220:223], a[244:247], v[108:111]
ds_read_b64_tr_b16 a[204:205], v40 offset:8200
v_mfma_f32_16x16x32_bf16 v[96:99], a[208:211], a[244:247], v[96:99]
ds_read_b64_tr_b16 a[206:207], v40 offset:8712
v_mfma_f32_16x16x32_bf16 v[104:107], a[216:219], a[244:247], v[104:107]
s_waitcnt lgkmcnt(8)
v_mfma_f32_16x16x32_bf16 v[116:119], a[212:215], a[248:251], v[116:119]
ds_read_b128 a[244:247], v37 offset:14336
v_mfma_f32_16x16x32_bf16 v[124:127], a[220:223], a[248:251], v[124:127]
v_mfma_f32_16x16x32_bf16 v[112:115], a[208:211], a[248:251], v[112:115]
v_mfma_f32_16x16x32_bf16 v[120:123], a[216:219], a[248:251], v[120:123]
s_waitcnt lgkmcnt(6)
v_mfma_f32_16x16x32_bf16 v[140:143], a[212:215], a[252:255], v[140:143]
ds_read_b128 a[248:251], v37 offset:16384
v_mfma_f32_16x16x32_bf16 v[136:139], a[220:223], a[252:255], v[136:139]
s_add_u32 m0, s33, 0x2000
s_add_u32 s35, s37, 0x300000
v_mfma_f32_16x16x32_bf16 v[132:135], a[208:211], a[252:255], v[132:135]
s_waitcnt lgkmcnt(2)
buffer_load_dwordx4 v12, s[8:11], s35 offen nt lds
v_mfma_f32_16x16x32_bf16 v[128:131], a[216:219], a[252:255], v[128:131]
v_mfma_f32_16x16x32_bf16 v[156:159], a[212:215], a[240:243], v[156:159]
ds_read_b128 a[252:255], v37 offset:18432
v_mfma_f32_16x16x32_bf16 v[152:155], a[220:223], a[240:243], v[152:155]
buffer_load_dwordx4 v13, s[8:11], s35 offen offset:1024 nt lds
v_mfma_f32_16x16x32_bf16 v[148:151], a[208:211], a[240:243], v[148:151]
v_mfma_f32_16x16x32_bf16 v[144:147], a[216:219], a[240:243], v[144:147]
s_waitcnt lgkmcnt(2)
v_mfma_f32_16x16x32_bf16 v[172:175], a[212:215], a[244:247], v[172:175]
s_waitcnt vmcnt(19)
s_waitcnt lgkmcnt(0)
s_barrier
ds_read_b128 a[240:243], v36 offset:20480
v_mfma_f32_16x16x32_bf16 v[168:171], a[220:223], a[244:247], v[168:171]
buffer_load_dwordx4 v14, s[8:11], s35 offen offset:2048 nt lds
v_mfma_f32_16x16x32_bf16 v[164:167], a[208:211], a[244:247], v[164:167]
v_mfma_f32_16x16x32_bf16 v[160:163], a[216:219], a[244:247], v[160:163]
v_mfma_f32_16x16x32_bf16 v[188:191], a[212:215], a[248:251], v[188:191]
ds_read_b128 a[244:247], v36 offset:22528
v_mfma_f32_16x16x32_bf16 v[184:187], a[220:223], a[248:251], v[184:187]
buffer_load_dwordx4 v15, s[8:11], s35 offen offset:3072 nt lds
v_mfma_f32_16x16x32_bf16 v[180:183], a[208:211], a[248:251], v[180:183]
v_mfma_f32_16x16x32_bf16 v[176:179], a[216:219], a[248:251], v[176:179]
v_mfma_f32_16x16x32_bf16 v[204:207], a[212:215], a[252:255], v[204:207]
ds_read_b128 a[248:251], v36 offset:24576
v_mfma_f32_16x16x32_bf16 v[200:203], a[220:223], a[252:255], v[200:203]
v_mfma_f32_16x16x32_bf16 v[196:199], a[208:211], a[252:255], v[196:199]
v_mfma_f32_16x16x32_bf16 v[192:195], a[216:219], a[252:255], v[192:195]
s_waitcnt lgkmcnt(2)
v_mfma_f32_16x16x32_bf16 v[52:55], a[196:199], a[240:243], v[52:55]
ds_read_b128 a[252:255], v36 offset:26624
v_mfma_f32_16x16x32_bf16 v[60:63], a[204:207], a[240:243], v[60:63]
s_waitcnt vmcnt(17)
ds_read_b64_tr_b16 a[208:209], v23 offset:12288
v_mfma_f32_16x16x32_bf16 v[48:51], a[192:195], a[240:243], v[48:51]
ds_read_b64_tr_b16 a[210:211], v23 offset:12800
v_mfma_f32_16x16x32_bf16 v[56:59], a[200:203], a[240:243], v[56:59]
s_waitcnt lgkmcnt(4)
s_add_u32 m0, s53, 0
s_mov_b32 s36, 0x300
buffer_load_dwordx4 v22, s[4:7], s36 offen lds
v_mfma_f32_16x16x32_bf16 v[68:71], a[196:199], a[244:247], v[68:71]
ds_read_b128 a[240:243], v36 offset:28672
v_mfma_f32_16x16x32_bf16 v[76:79], a[204:207], a[244:247], v[76:79]
ds_read_b64_tr_b16 a[212:213], v23 offset:12296
v_mfma_f32_16x16x32_bf16 v[64:67], a[192:195], a[244:247], v[64:67]
ds_read_b64_tr_b16 a[214:215], v23 offset:12808
v_mfma_f32_16x16x32_bf16 v[72:75], a[200:203], a[244:247], v[72:75]
s_waitcnt lgkmcnt(6)
s_add_u32 m0, s53, 0x1000
s_mov_b32 s36, 0x7300
buffer_load_dwordx4 v22, s[4:7], s36 offen lds
v_mfma_f32_16x16x32_bf16 v[84:87], a[196:199], a[248:251], v[84:87]
ds_read_b128 a[244:247], v36 offset:30720
v_mfma_f32_16x16x32_bf16 v[92:95], a[204:207], a[248:251], v[92:95]
ds_read_b64_tr_b16 a[216:217], v40 offset:12288
v_mfma_f32_16x16x32_bf16 v[80:83], a[192:195], a[248:251], v[80:83]
ds_read_b64_tr_b16 a[218:219], v40 offset:12800
v_mfma_f32_16x16x32_bf16 v[88:91], a[200:203], a[248:251], v[88:91]
s_waitcnt lgkmcnt(8)
s_add_u32 m0, s53, 0x25000
s_mov_b32 s36, 0xe300
buffer_load_dwordx4 v22, s[4:7], s36 offen lds
v_mfma_f32_16x16x32_bf16 v[100:103], a[196:199], a[252:255], v[100:103]
ds_read_b128 a[248:251], v36 offset:32768
v_mfma_f32_16x16x32_bf16 v[108:111], a[204:207], a[252:255], v[108:111]
ds_read_b64_tr_b16 a[220:221], v40 offset:12296
v_mfma_f32_16x16x32_bf16 v[96:99], a[192:195], a[252:255], v[96:99]
ds_read_b64_tr_b16 a[222:223], v40 offset:12808
v_mfma_f32_16x16x32_bf16 v[104:107], a[200:203], a[252:255], v[104:107]
s_waitcnt lgkmcnt(8)
s_add_u32 m0, s53, 0x26000
s_mov_b32 s36, 0x15300
buffer_load_dwordx4 v22, s[4:7], s36 offen lds
v_mfma_f32_16x16x32_bf16 v[116:119], a[196:199], a[240:243], v[116:119]
ds_read_b128 a[252:255], v36 offset:34816
v_mfma_f32_16x16x32_bf16 v[124:127], a[204:207], a[240:243], v[124:127]
v_mfma_f32_16x16x32_bf16 v[112:115], a[192:195], a[240:243], v[112:115]
v_mfma_f32_16x16x32_bf16 v[120:123], a[200:203], a[240:243], v[120:123]
s_waitcnt lgkmcnt(6)
s_add_u32 m0, s53, 0x27000
s_mov_b32 s36, 0x1c300
buffer_load_dwordx4 v22, s[4:7], s36 offen lds
v_mfma_f32_16x16x32_bf16 v[140:143], a[196:199], a[244:247], v[140:143]
ds_read_b128 a[240:243], v36 offset:36864
v_mfma_f32_16x16x32_bf16 v[136:139], a[204:207], a[244:247], v[136:139]
s_add_u32 m0, s33, 0x3000
s_add_u32 s35, s37, 0x340000
v_mfma_f32_16x16x32_bf16 v[132:135], a[192:195], a[244:247], v[132:135]
s_waitcnt lgkmcnt(2)
buffer_load_dwordx4 v12, s[8:11], s35 offen nt lds
v_mfma_f32_16x16x32_bf16 v[128:131], a[200:203], a[244:247], v[128:131]
v_mfma_f32_16x16x32_bf16 v[156:159], a[196:199], a[248:251], v[156:159]
ds_read_b128 a[244:247], v36 offset:38912
v_mfma_f32_16x16x32_bf16 v[152:155], a[204:207], a[248:251], v[152:155]
buffer_load_dwordx4 v13, s[8:11], s35 offen offset:1024 nt lds
v_mfma_f32_16x16x32_bf16 v[148:151], a[192:195], a[248:251], v[148:151]
v_mfma_f32_16x16x32_bf16 v[144:147], a[200:203], a[248:251], v[144:147]
s_waitcnt lgkmcnt(2)
v_mfma_f32_16x16x32_bf16 v[172:175], a[196:199], a[252:255], v[172:175]
ds_read_b128 a[248:251], v37 offset:20480
v_mfma_f32_16x16x32_bf16 v[168:171], a[204:207], a[252:255], v[168:171]
buffer_load_dwordx4 v14, s[8:11], s35 offen offset:2048 nt lds
v_mfma_f32_16x16x32_bf16 v[164:167], a[192:195], a[252:255], v[164:167]
v_mfma_f32_16x16x32_bf16 v[160:163], a[200:203], a[252:255], v[160:163]
s_waitcnt lgkmcnt(2)
v_mfma_f32_16x16x32_bf16 v[188:191], a[196:199], a[240:243], v[188:191]
ds_read_b128 a[252:255], v37 offset:22528
v_mfma_f32_16x16x32_bf16 v[184:187], a[204:207], a[240:243], v[184:187]
buffer_load_dwordx4 v15, s[8:11], s35 offen offset:3072 nt lds
v_mfma_f32_16x16x32_bf16 v[180:183], a[192:195], a[240:243], v[180:183]
v_mfma_f32_16x16x32_bf16 v[176:179], a[200:203], a[240:243], v[176:179]
s_waitcnt lgkmcnt(2)
v_mfma_f32_16x16x32_bf16 v[204:207], a[196:199], a[244:247], v[204:207]
ds_read_b128 a[240:243], v37 offset:24576
v_mfma_f32_16x16x32_bf16 v[200:203], a[204:207], a[244:247], v[200:203]
v_mfma_f32_16x16x32_bf16 v[196:199], a[192:195], a[244:247], v[196:199]
v_mfma_f32_16x16x32_bf16 v[192:195], a[200:203], a[244:247], v[192:195]
s_waitcnt lgkmcnt(2)
v_mfma_f32_16x16x32_bf16 v[52:55], a[212:215], a[248:251], v[52:55]
ds_read_b128 a[244:247], v37 offset:26624
v_mfma_f32_16x16x32_bf16 v[60:63], a[220:223], a[248:251], v[60:63]
s_waitcnt vmcnt(22)
ds_read_b64_tr_b16 a[192:193], v23
v_mfma_f32_16x16x32_bf16 v[48:51], a[208:211], a[248:251], v[48:51]
ds_read_b64_tr_b16 a[194:195], v23 offset:512
v_mfma_f32_16x16x32_bf16 v[56:59], a[216:219], a[248:251], v[56:59]
s_waitcnt lgkmcnt(4)
v_mfma_f32_16x16x32_bf16 v[68:71], a[212:215], a[252:255], v[68:71]
ds_read_b128 a[248:251], v37 offset:28672
v_mfma_f32_16x16x32_bf16 v[76:79], a[220:223], a[252:255], v[76:79]
ds_read_b64_tr_b16 a[196:197], v23 offset:8
v_mfma_f32_16x16x32_bf16 v[64:67], a[208:211], a[252:255], v[64:67]
ds_read_b64_tr_b16 a[198:199], v23 offset:520
v_mfma_f32_16x16x32_bf16 v[72:75], a[216:219], a[252:255], v[72:75]
s_waitcnt lgkmcnt(6)
v_mfma_f32_16x16x32_bf16 v[84:87], a[212:215], a[240:243], v[84:87]
ds_read_b128 a[252:255], v37 offset:30720
v_mfma_f32_16x16x32_bf16 v[92:95], a[220:223], a[240:243], v[92:95]
ds_read_b64_tr_b16 a[200:201], v40
v_mfma_f32_16x16x32_bf16 v[80:83], a[208:211], a[240:243], v[80:83]
ds_read_b64_tr_b16 a[202:203], v40 offset:512
v_mfma_f32_16x16x32_bf16 v[88:91], a[216:219], a[240:243], v[88:91]
s_waitcnt lgkmcnt(8)
v_mfma_f32_16x16x32_bf16 v[100:103], a[212:215], a[244:247], v[100:103]
ds_read_b128 a[240:243], v37 offset:32768
v_mfma_f32_16x16x32_bf16 v[108:111], a[220:223], a[244:247], v[108:111]
ds_read_b64_tr_b16 a[204:205], v40 offset:8
v_mfma_f32_16x16x32_bf16 v[96:99], a[208:211], a[244:247], v[96:99]
ds_read_b64_tr_b16 a[206:207], v40 offset:520
v_mfma_f32_16x16x32_bf16 v[104:107], a[216:219], a[244:247], v[104:107]
s_waitcnt lgkmcnt(8)
v_mov_b32 v12, v16
v_mfma_f32_16x16x32_bf16 v[116:119], a[212:215], a[248:251], v[116:119]
ds_read_b128 a[244:247], v37 offset:34816
v_xor_b32 v15, 64, v16
v_mfma_f32_16x16x32_bf16 v[124:127], a[220:223], a[248:251], v[124:127]
v_add_u32 v13, 0xc00, v15
v_mfma_f32_16x16x32_bf16 v[112:115], a[208:211], a[248:251], v[112:115]
v_add_u32 v14, 0x1800, v16
v_mfma_f32_16x16x32_bf16 v[120:123], a[216:219], a[248:251], v[120:123]
s_waitcnt lgkmcnt(6)
v_add_u32 v15, 0x2400, v15
v_mfma_f32_16x16x32_bf16 v[140:143], a[212:215], a[252:255], v[140:143]
ds_read_b128 a[248:251], v37 offset:36864
v_mfma_f32_16x16x32_bf16 v[136:139], a[220:223], a[252:255], v[136:139]
s_add_u32 m0, s33, 0
s_add_u32 s35, s40, 0
v_mfma_f32_16x16x32_bf16 v[132:135], a[208:211], a[252:255], v[132:135]
s_waitcnt lgkmcnt(2)
buffer_load_dwordx4 v12, s[12:15], s35 offen nt lds
v_mfma_f32_16x16x32_bf16 v[128:131], a[216:219], a[252:255], v[128:131]
v_mfma_f32_16x16x32_bf16 v[156:159], a[212:215], a[240:243], v[156:159]
ds_read_b128 a[252:255], v37 offset:38912
v_mfma_f32_16x16x32_bf16 v[152:155], a[220:223], a[240:243], v[152:155]
buffer_load_dwordx4 v13, s[12:15], s35 offen offset:1024 nt lds
v_mfma_f32_16x16x32_bf16 v[148:151], a[208:211], a[240:243], v[148:151]
v_mfma_f32_16x16x32_bf16 v[144:147], a[216:219], a[240:243], v[144:147]
s_waitcnt lgkmcnt(2)
v_mfma_f32_16x16x32_bf16 v[172:175], a[212:215], a[244:247], v[172:175]
s_waitcnt vmcnt(19)
s_waitcnt lgkmcnt(0)
s_barrier
ds_read_b128 a[240:243], v36 offset:40960
v_mfma_f32_16x16x32_bf16 v[168:171], a[220:223], a[244:247], v[168:171]
buffer_load_dwordx4 v14, s[12:15], s35 offen offset:2048 nt lds
v_mfma_f32_16x16x32_bf16 v[164:167], a[208:211], a[244:247], v[164:167]
v_mfma_f32_16x16x32_bf16 v[160:163], a[216:219], a[244:247], v[160:163]
v_mfma_f32_16x16x32_bf16 v[188:191], a[212:215], a[248:251], v[188:191]
ds_read_b128 a[244:247], v36 offset:43008
v_mfma_f32_16x16x32_bf16 v[184:187], a[220:223], a[248:251], v[184:187]
buffer_load_dwordx4 v15, s[12:15], s35 offen offset:3072 nt lds
v_mfma_f32_16x16x32_bf16 v[180:183], a[208:211], a[248:251], v[180:183]
v_mfma_f32_16x16x32_bf16 v[176:179], a[216:219], a[248:251], v[176:179]
v_mfma_f32_16x16x32_bf16 v[204:207], a[212:215], a[252:255], v[204:207]
ds_read_b128 a[248:251], v36 offset:45056
v_mfma_f32_16x16x32_bf16 v[200:203], a[220:223], a[252:255], v[200:203]
v_mfma_f32_16x16x32_bf16 v[196:199], a[208:211], a[252:255], v[196:199]
v_mfma_f32_16x16x32_bf16 v[192:195], a[216:219], a[252:255], v[192:195]
s_waitcnt lgkmcnt(2)
v_mfma_f32_16x16x32_bf16 v[52:55], a[196:199], a[240:243], v[52:55]
ds_read_b128 a[252:255], v36 offset:47104
v_mfma_f32_16x16x32_bf16 v[60:63], a[204:207], a[240:243], v[60:63]
s_waitcnt vmcnt(17)
ds_read_b64_tr_b16 a[208:209], v23 offset:4096
v_mfma_f32_16x16x32_bf16 v[48:51], a[192:195], a[240:243], v[48:51]
ds_read_b64_tr_b16 a[210:211], v23 offset:4608
v_mfma_f32_16x16x32_bf16 v[56:59], a[200:203], a[240:243], v[56:59]
s_waitcnt lgkmcnt(4)
v_mov_b32 v42, 0xff800000
v_mfma_f32_16x16x32_bf16 v[68:71], a[196:199], a[244:247], v[68:71]
ds_read_b128 a[240:243], v36 offset:49152
v_mfma_f32_16x16x32_bf16 v[76:79], a[204:207], a[244:247], v[76:79]
ds_read_b64_tr_b16 a[212:213], v23 offset:4104
v_mfma_f32_16x16x32_bf16 v[64:67], a[192:195], a[244:247], v[64:67]
ds_read_b64_tr_b16 a[214:215], v23 offset:4616
v_mfma_f32_16x16x32_bf16 v[72:75], a[200:203], a[244:247], v[72:75]
s_waitcnt lgkmcnt(6)
v_mfma_f32_16x16x32_bf16 v[84:87], a[196:199], a[248:251], v[84:87]
ds_read_b128 a[244:247], v36 offset:51200
v_mfma_f32_16x16x32_bf16 v[92:95], a[204:207], a[248:251], v[92:95]
ds_read_b64_tr_b16 a[216:217], v40 offset:4096
v_mfma_f32_16x16x32_bf16 v[80:83], a[192:195], a[248:251], v[80:83]
ds_read_b64_tr_b16 a[218:219], v40 offset:4608
v_mfma_f32_16x16x32_bf16 v[88:91], a[200:203], a[248:251], v[88:91]
s_waitcnt lgkmcnt(8)
ds_write_b32 v20, v42
v_mfma_f32_16x16x32_bf16 v[100:103], a[196:199], a[252:255], v[100:103]
ds_read_b128 a[248:251], v36 offset:53248
v_mfma_f32_16x16x32_bf16 v[108:111], a[204:207], a[252:255], v[108:111]
ds_read_b64_tr_b16 a[220:221], v40 offset:4104
v_mfma_f32_16x16x32_bf16 v[96:99], a[192:195], a[252:255], v[96:99]
ds_read_b64_tr_b16 a[222:223], v40 offset:4616
v_mfma_f32_16x16x32_bf16 v[104:107], a[200:203], a[252:255], v[104:107]
s_waitcnt lgkmcnt(9)
v_mfma_f32_16x16x32_bf16 v[116:119], a[196:199], a[240:243], v[116:119]
ds_read_b128 a[252:255], v36 offset:55296
v_mfma_f32_16x16x32_bf16 v[124:127], a[204:207], a[240:243], v[124:127]
ds_write_b32 v20, v42 offset:16
v_mfma_f32_16x16x32_bf16 v[112:115], a[192:195], a[240:243], v[112:115]
v_mfma_f32_16x16x32_bf16 v[120:123], a[200:203], a[240:243], v[120:123]
s_waitcnt lgkmcnt(8)
v_mfma_f32_16x16x32_bf16 v[140:143], a[196:199], a[244:247], v[140:143]
ds_read_b128 a[240:243], v36 offset:57344
v_mfma_f32_16x16x32_bf16 v[136:139], a[204:207], a[244:247], v[136:139]
s_add_u32 m0, s33, 0x1000
s_add_u32 s35, s40, 0x10000
ds_write_b32 v20, v42 offset:32
v_mfma_f32_16x16x32_bf16 v[132:135], a[192:195], a[244:247], v[132:135]
s_waitcnt lgkmcnt(4)
buffer_load_dwordx4 v12, s[12:15], s35 offen nt lds
v_mfma_f32_16x16x32_bf16 v[128:131], a[200:203], a[244:247], v[128:131]
v_mfma_f32_16x16x32_bf16 v[156:159], a[196:199], a[248:251], v[156:159]
ds_read_b128 a[244:247], v36 offset:59392
v_mfma_f32_16x16x32_bf16 v[152:155], a[204:207], a[248:251], v[152:155]
buffer_load_dwordx4 v13, s[12:15], s35 offen offset:1024 nt lds
v_mfma_f32_16x16x32_bf16 v[148:151], a[192:195], a[248:251], v[148:151]
v_mfma_f32_16x16x32_bf16 v[144:147], a[200:203], a[248:251], v[144:147]
s_waitcnt lgkmcnt(4)
ds_write_b32 v20, v42 offset:1024
v_mfma_f32_16x16x32_bf16 v[172:175], a[196:199], a[252:255], v[172:175]
ds_read_b128 a[248:251], v37 offset:40960
v_mfma_f32_16x16x32_bf16 v[168:171], a[204:207], a[252:255], v[168:171]
buffer_load_dwordx4 v14, s[12:15], s35 offen offset:2048 nt lds
v_mfma_f32_16x16x32_bf16 v[164:167], a[192:195], a[252:255], v[164:167]
v_mfma_f32_16x16x32_bf16 v[160:163], a[200:203], a[252:255], v[160:163]
s_waitcnt lgkmcnt(4)
v_mfma_f32_16x16x32_bf16 v[188:191], a[196:199], a[240:243], v[188:191]
ds_read_b128 a[252:255], v37 offset:43008
v_mfma_f32_16x16x32_bf16 v[184:187], a[204:207], a[240:243], v[184:187]
buffer_load_dwordx4 v15, s[12:15], s35 offen offset:3072 nt lds
v_mfma_f32_16x16x32_bf16 v[180:183], a[192:195], a[240:243], v[180:183]
ds_write_b32 v20, v42 offset:1040
v_mfma_f32_16x16x32_bf16 v[176:179], a[200:203], a[240:243], v[176:179]
s_waitcnt lgkmcnt(4)
v_mfma_f32_16x16x32_bf16 v[204:207], a[196:199], a[244:247], v[204:207]
ds_read_b128 a[240:243], v37 offset:45056
v_mfma_f32_16x16x32_bf16 v[200:203], a[204:207], a[244:247], v[200:203]
ds_write_b32 v20, v42 offset:1056
v_mfma_f32_16x16x32_bf16 v[196:199], a[192:195], a[244:247], v[196:199]
v_mfma_f32_16x16x32_bf16 v[192:195], a[200:203], a[244:247], v[192:195]
s_waitcnt lgkmcnt(4)
v_mfma_f32_16x16x32_bf16 v[52:55], a[212:215], a[248:251], v[52:55]
ds_read_b128 a[244:247], v37 offset:47104
v_mfma_f32_16x16x32_bf16 v[60:63], a[220:223], a[248:251], v[60:63]
s_waitcnt vmcnt(17)
ds_read_b64_tr_b16 a[192:193], v23 offset:8192
v_mfma_f32_16x16x32_bf16 v[48:51], a[208:211], a[248:251], v[48:51]
ds_read_b64_tr_b16 a[194:195], v23 offset:8704
v_mfma_f32_16x16x32_bf16 v[56:59], a[216:219], a[248:251], v[56:59]
s_waitcnt lgkmcnt(6)
ds_read_b64_tr_b16 a[196:197], v23 offset:8200
v_mfma_f32_16x16x32_bf16 v[68:71], a[212:215], a[252:255], v[68:71]
ds_read_b128 a[248:251], v37 offset:49152
v_mfma_f32_16x16x32_bf16 v[76:79], a[220:223], a[252:255], v[76:79]
ds_read_b64_tr_b16 a[198:199], v23 offset:8712
v_mfma_f32_16x16x32_bf16 v[64:67], a[208:211], a[252:255], v[64:67]
ds_read_b64_tr_b16 a[200:201], v40 offset:8192
v_mfma_f32_16x16x32_bf16 v[72:75], a[216:219], a[252:255], v[72:75]
s_waitcnt lgkmcnt(8)
ds_read_b64_tr_b16 a[202:203], v40 offset:8704
v_mfma_f32_16x16x32_bf16 v[84:87], a[212:215], a[240:243], v[84:87]
ds_read_b128 a[252:255], v37 offset:51200
v_mfma_f32_16x16x32_bf16 v[92:95], a[220:223], a[240:243], v[92:95]
ds_read_b64_tr_b16 a[204:205], v40 offset:8200
v_mfma_f32_16x16x32_bf16 v[80:83], a[208:211], a[240:243], v[80:83]
ds_read_b64_tr_b16 a[206:207], v40 offset:8712
v_mfma_f32_16x16x32_bf16 v[88:91], a[216:219], a[240:243], v[88:91]
s_waitcnt lgkmcnt(10)
v_mfma_f32_16x16x32_bf16 v[100:103], a[212:215], a[244:247], v[100:103]
ds_read_b128 a[240:243], v37 offset:53248
v_mfma_f32_16x16x32_bf16 v[108:111], a[220:223], a[244:247], v[108:111]
v_mfma_f32_16x16x32_bf16 v[96:99], a[208:211], a[244:247], v[96:99]
s_add_u32 m0, s33, 0x2000
s_add_u32 s35, s41, 0
v_mfma_f32_16x16x32_bf16 v[104:107], a[216:219], a[244:247], v[104:107]
s_waitcnt lgkmcnt(7)
s_waitcnt lgkmcnt(1)
buffer_load_dwordx4 v12, s[12:15], s35 offen nt lds
v_mfma_f32_16x16x32_bf16 v[116:119], a[212:215], a[248:251], v[116:119]
ds_read_b128 a[244:247], v37 offset:55296
v_mfma_f32_16x16x32_bf16 v[124:127], a[220:223], a[248:251], v[124:127]
buffer_load_dwordx4 v13, s[12:15], s35 offen offset:1024 nt lds
v_mfma_f32_16x16x32_bf16 v[112:115], a[208:211], a[248:251], v[112:115]
buffer_load_dwordx4 v14, s[12:15], s35 offen offset:2048 nt lds
v_mfma_f32_16x16x32_bf16 v[120:123], a[216:219], a[248:251], v[120:123]
buffer_load_dwordx4 v15, s[12:15], s35 offen offset:3072 nt lds
v_mfma_f32_16x16x32_bf16 v[140:143], a[212:215], a[252:255], v[140:143]
ds_read_b128 a[248:251], v37 offset:57344
v_mfma_f32_16x16x32_bf16 v[136:139], a[220:223], a[252:255], v[136:139]
s_waitcnt vmcnt(12)
ds_read_b64_tr_b16 a[224:225], v23 offset:12288
v_mfma_f32_16x16x32_bf16 v[132:135], a[208:211], a[252:255], v[132:135]
ds_read_b64_tr_b16 a[226:227], v23 offset:12800
v_mfma_f32_16x16x32_bf16 v[128:131], a[216:219], a[252:255], v[128:131]
s_waitcnt lgkmcnt(4)
ds_read_b64_tr_b16 a[228:229], v23 offset:12296
v_mfma_f32_16x16x32_bf16 v[156:159], a[212:215], a[240:243], v[156:159]
ds_read_b128 a[252:255], v37 offset:59392
v_mfma_f32_16x16x32_bf16 v[152:155], a[220:223], a[240:243], v[152:155]
ds_read_b64_tr_b16 a[230:231], v23 offset:12808
v_mfma_f32_16x16x32_bf16 v[148:151], a[208:211], a[240:243], v[148:151]
ds_read_b64_tr_b16 a[232:233], v40 offset:12288
v_mfma_f32_16x16x32_bf16 v[144:147], a[216:219], a[240:243], v[144:147]
s_waitcnt lgkmcnt(7)
ds_read_b64_tr_b16 a[234:235], v40 offset:12800
v_mfma_f32_16x16x32_bf16 v[172:175], a[212:215], a[244:247], v[172:175]
s_waitcnt lgkmcnt(0)
s_barrier
ds_read_b128 a[240:243], v36
v_mfma_f32_16x16x32_bf16 v[168:171], a[220:223], a[244:247], v[168:171]
ds_read_b64_tr_b16 a[236:237], v40 offset:12296
v_mfma_f32_16x16x32_bf16 v[164:167], a[208:211], a[244:247], v[164:167]
ds_read_b64_tr_b16 a[238:239], v40 offset:12808
v_mfma_f32_16x16x32_bf16 v[160:163], a[216:219], a[244:247], v[160:163]
v_mfma_f32_16x16x32_bf16 v[188:191], a[212:215], a[248:251], v[188:191]
ds_read_b128 a[244:247], v37
v_mfma_f32_16x16x32_bf16 v[184:187], a[220:223], a[248:251], v[184:187]
v_mfma_f32_16x16x32_bf16 v[180:183], a[208:211], a[248:251], v[180:183]
s_add_u32 m0, s33, 0x3000
s_add_u32 s35, s41, 0x10000
v_mfma_f32_16x16x32_bf16 v[176:179], a[216:219], a[248:251], v[176:179]
s_waitcnt lgkmcnt(1)
buffer_load_dwordx4 v12, s[12:15], s35 offen nt lds
v_mfma_f32_16x16x32_bf16 v[204:207], a[212:215], a[252:255], v[204:207]
ds_read_b128 a[248:251], v36 offset:2048
v_mfma_f32_16x16x32_bf16 v[200:203], a[220:223], a[252:255], v[200:203]
buffer_load_dwordx4 v13, s[12:15], s35 offen offset:1024 nt lds
v_mfma_f32_16x16x32_bf16 v[196:199], a[208:211], a[252:255], v[196:199]
buffer_load_dwordx4 v14, s[12:15], s35 offen offset:2048 nt lds
v_mfma_f32_16x16x32_bf16 v[192:195], a[216:219], a[252:255], v[192:195]
buffer_load_dwordx4 v15, s[12:15], s35 offen offset:3072 nt lds
v_mfma_f32_16x16x32_bf16 v[52:55], a[196:199], a[240:243], v[52:55]
ds_read_b128 a[252:255], v37 offset:2048
v_mfma_f32_16x16x32_bf16 v[60:63], a[204:207], a[240:243], v[60:63]
s_waitcnt vmcnt(12)
ds_read_b128 a[0:3], v3
v_mfma_f32_16x16x32_bf16 v[48:51], a[192:195], a[240:243], v[48:51]
v_mfma_f32_16x16x32_bf16 v[56:59], a[200:203], a[240:243], v[56:59]
s_waitcnt lgkmcnt(3)
v_mfma_f32_16x16x32_bf16 v[52:55], a[228:231], a[244:247], v[52:55]
ds_read_b128 a[240:243], v36 offset:4096
v_mfma_f32_16x16x32_bf16 v[60:63], a[236:239], a[244:247], v[60:63]
ds_read_b128 a[4:7], v3 offset:2048
v_mfma_f32_16x16x32_bf16 v[48:51], a[224:227], a[244:247], v[48:51]
v_mfma_f32_16x16x32_bf16 v[56:59], a[232:235], a[244:247], v[56:59]
s_waitcnt lgkmcnt(4)
v_mfma_f32_16x16x32_bf16 v[68:71], a[196:199], a[248:251], v[68:71]
ds_read_b128 a[244:247], v37 offset:4096
v_mfma_f32_16x16x32_bf16 v[76:79], a[204:207], a[248:251], v[76:79]
ds_read_b128 a[8:11], v4
s_nop 1
v_cvt_pk_bf16_f32 v48, v48, v49
v_mfma_f32_16x16x32_bf16 v[64:67], a[192:195], a[248:251], v[64:67]
v_cvt_pk_bf16_f32 v49, v50, v51
v_mfma_f32_16x16x32_bf16 v[72:75], a[200:203], a[248:251], v[72:75]
s_waitcnt lgkmcnt(5)
v_cvt_pk_bf16_f32 v50, v52, v53
v_mfma_f32_16x16x32_bf16 v[68:71], a[228:231], a[252:255], v[68:71]
ds_read_b128 a[248:251], v36 offset:6144
v_cvt_pk_bf16_f32 v51, v54, v55
v_mfma_f32_16x16x32_bf16 v[76:79], a[236:239], a[252:255], v[76:79]
ds_read_b128 a[12:15], v4 offset:2048
v_cvt_pk_bf16_f32 v56, v56, v57
v_mfma_f32_16x16x32_bf16 v[64:67], a[224:227], a[252:255], v[64:67]
v_cvt_pk_bf16_f32 v57, v58, v59
v_mfma_f32_16x16x32_bf16 v[72:75], a[232:235], a[252:255], v[72:75]
s_waitcnt lgkmcnt(5)
v_cvt_pk_bf16_f32 v58, v60, v61
v_mfma_f32_16x16x32_bf16 v[84:87], a[196:199], a[240:243], v[84:87]
ds_read_b128 a[252:255], v37 offset:6144
v_cvt_pk_bf16_f32 v59, v62, v63
v_mfma_f32_16x16x32_bf16 v[92:95], a[204:207], a[240:243], v[92:95]
v_cvt_pk_bf16_f32 v64, v64, v65
v_mfma_f32_16x16x32_bf16 v[80:83], a[192:195], a[240:243], v[80:83]
v_cvt_pk_bf16_f32 v65, v66, v67
v_cvt_pk_bf16_f32 v66, v68, v69
v_mfma_f32_16x16x32_bf16 v[88:91], a[200:203], a[240:243], v[88:91]
s_waitcnt lgkmcnt(4)
v_cvt_pk_bf16_f32 v67, v70, v71
v_mfma_f32_16x16x32_bf16 v[84:87], a[228:231], a[244:247], v[84:87]
s_waitcnt lgkmcnt(0)
s_barrier
ds_read_b128 a[240:243], v38
v_mfma_f32_16x16x32_bf16 v[92:95], a[236:239], a[244:247], v[92:95]
s_add_u32 m0, s33, 0
s_add_u32 s35, s42, 0
v_cvt_pk_bf16_f32 v72, v72, v73
v_mfma_f32_16x16x32_bf16 v[80:83], a[224:227], a[244:247], v[80:83]
buffer_load_dwordx4 v12, s[12:15], s35 offen nt lds
v_cvt_pk_bf16_f32 v73, v74, v75
v_mfma_f32_16x16x32_bf16 v[88:91], a[232:235], a[244:247], v[88:91]
v_cvt_pk_bf16_f32 v74, v76, v77
v_mfma_f32_16x16x32_bf16 v[100:103], a[196:199], a[248:251], v[100:103]
ds_read_b128 a[244:247], v39
v_cvt_pk_bf16_f32 v75, v78, v79
v_mfma_f32_16x16x32_bf16 v[108:111], a[204:207], a[248:251], v[108:111]
v_cvt_pk_bf16_f32 v80, v80, v81
v_cvt_pk_bf16_f32 v81, v82, v83
v_cvt_pk_bf16_f32 v82, v84, v85
v_cvt_pk_bf16_f32 v83, v86, v87
v_mfma_f32_16x16x32_bf16 v[96:99], a[192:195], a[248:251], v[96:99]
ds_write_b128 v41, v[48:51]
v_mfma_f32_16x16x32_bf16 v[104:107], a[200:203], a[248:251], v[104:107]
buffer_load_dwordx4 v13, s[12:15], s35 offen offset:1024 nt lds
v_mfma_f32_16x16x32_bf16 v[100:103], a[228:231], a[252:255], v[100:103]
ds_read_b128 a[248:251], v38 offset:2048
v_mfma_f32_16x16x32_bf16 v[108:111], a[236:239], a[252:255], v[108:111]
ds_write_b128 v41, v[56:59] offset:10240
v_cvt_pk_bf16_f32 v88, v88, v89
v_cvt_pk_bf16_f32 v89, v90, v91
v_cvt_pk_bf16_f32 v90, v92, v93
v_cvt_pk_bf16_f32 v91, v94, v95
v_mfma_f32_16x16x32_bf16 v[96:99], a[224:227], a[252:255], v[96:99]
ds_write_b128 v41, v[64:67] offset:1024
v_mfma_f32_16x16x32_bf16 v[104:107], a[232:235], a[252:255], v[104:107]
s_waitcnt lgkmcnt(5)
buffer_load_dwordx4 v14, s[12:15], s35 offen offset:2048 nt lds
v_mfma_f32_16x16x32_bf16 v[116:119], a[196:199], a[240:243], v[116:119]
ds_read_b128 a[252:255], v39 offset:2048
ds_write_b128 v41, v[72:75] offset:11264
v_mfma_f32_16x16x32_bf16 v[124:127], a[204:207], a[240:243], v[124:127]
v_cvt_pk_bf16_f32 v96, v96, v97
v_cvt_pk_bf16_f32 v97, v98, v99
v_cvt_pk_bf16_f32 v98, v100, v101
v_cvt_pk_bf16_f32 v99, v102, v103
v_mfma_f32_16x16x32_bf16 v[112:115], a[192:195], a[240:243], v[112:115]
ds_write_b128 v41, v[80:83] offset:2048
v_mfma_f32_16x16x32_bf16 v[120:123], a[200:203], a[240:243], v[120:123]
s_waitcnt lgkmcnt(7)
buffer_load_dwordx4 v15, s[12:15], s35 offen offset:3072 nt lds
v_mfma_f32_16x16x32_bf16 v[116:119], a[228:231], a[244:247], v[116:119]
ds_read_b128 a[240:243], v38 offset:4096
v_mfma_f32_16x16x32_bf16 v[124:127], a[236:239], a[244:247], v[124:127]
ds_write_b128 v41, v[88:91] offset:12288
v_cvt_pk_bf16_f32 v104, v104, v105
v_cvt_pk_bf16_f32 v105, v106, v107
v_cvt_pk_bf16_f32 v106, v108, v109
v_mfma_f32_16x16x32_bf16 v[112:115], a[224:227], a[244:247], v[112:115]
v_cvt_pk_bf16_f32 v107, v110, v111
v_mfma_f32_16x16x32_bf16 v[120:123], a[232:235], a[244:247], v[120:123]
s_waitcnt lgkmcnt(7)
ds_write_b128 v41, v[96:99] offset:3072
v_mfma_f32_16x16x32_bf16 v[140:143], a[196:199], a[248:251], v[140:143]
ds_read_b128 a[244:247], v39 offset:4096
ds_write_b128 v41, v[104:107] offset:13312
v_mfma_f32_16x16x32_bf16 v[136:139], a[204:207], a[248:251], v[136:139]
v_cvt_pk_bf16_f32 v112, v112, v113
v_cvt_pk_bf16_f32 v113, v114, v115
v_cvt_pk_bf16_f32 v114, v116, v117
v_mfma_f32_16x16x32_bf16 v[132:135], a[192:195], a[248:251], v[132:135]
v_cvt_pk_bf16_f32 v115, v118, v119
v_mfma_f32_16x16x32_bf16 v[128:131], a[200:203], a[248:251], v[128:131]
s_waitcnt lgkmcnt(7)
s_waitcnt vmcnt(12)
ds_read_b128 a[16:19], v3 offset:4096
v_mfma_f32_16x16x32_bf16 v[140:143], a[228:231], a[252:255], v[140:143]
ds_read_b128 a[248:251], v38 offset:6144
v_mfma_f32_16x16x32_bf16 v[136:139], a[236:239], a[252:255], v[136:139]
ds_write_b128 v41, v[112:115] offset:4096
v_cvt_pk_bf16_f32 v120, v120, v121
v_cvt_pk_bf16_f32 v121, v122, v123
v_cvt_pk_bf16_f32 v122, v124, v125
v_mfma_f32_16x16x32_bf16 v[132:135], a[224:227], a[252:255], v[132:135]
v_cvt_pk_bf16_f32 v123, v126, v127
v_mfma_f32_16x16x32_bf16 v[128:131], a[232:235], a[252:255], v[128:131]
s_waitcnt lgkmcnt(7)
ds_read_b128 a[20:23], v3 offset:6144
v_mfma_f32_16x16x32_bf16 v[156:159], a[196:199], a[240:243], v[156:159]
ds_read_b128 a[252:255], v39 offset:6144
ds_write_b128 v41, v[120:123] offset:14336
v_mfma_f32_16x16x32_bf16 v[152:155], a[204:207], a[240:243], v[152:155]
v_cvt_pk_bf16_f32 v132, v132, v133
v_cvt_pk_bf16_f32 v133, v134, v135
v_cvt_pk_bf16_f32 v134, v140, v141
v_mfma_f32_16x16x32_bf16 v[148:151], a[192:195], a[240:243], v[148:151]
v_cvt_pk_bf16_f32 v135, v142, v143
v_mfma_f32_16x16x32_bf16 v[144:147], a[200:203], a[240:243], v[144:147]
s_waitcnt lgkmcnt(7)
ds_read_b128 a[24:27], v4 offset:4096
v_mfma_f32_16x16x32_bf16 v[156:159], a[228:231], a[244:247], v[156:159]
ds_read_b128 a[240:243], v38 offset:8192
v_mfma_f32_16x16x32_bf16 v[152:155], a[236:239], a[244:247], v[152:155]
ds_write_b128 v41, v[132:135] offset:5120
v_cvt_pk_bf16_f32 v128, v128, v129
v_cvt_pk_bf16_f32 v129, v130, v131
v_cvt_pk_bf16_f32 v130, v136, v137
v_mfma_f32_16x16x32_bf16 v[148:151], a[224:227], a[244:247], v[148:151]
v_cvt_pk_bf16_f32 v131, v138, v139
v_mfma_f32_16x16x32_bf16 v[144:147], a[232:235], a[244:247], v[144:147]
s_waitcnt lgkmcnt(7)
ds_read_b128 a[28:31], v4 offset:6144
v_mfma_f32_16x16x32_bf16 v[172:175], a[196:199], a[248:251], v[172:175]
ds_read_b128 a[244:247], v39 offset:8192
ds_write_b128 v41, v[128:131] offset:15360
v_mfma_f32_16x16x32_bf16 v[168:171], a[204:207], a[248:251], v[168:171]
v_cvt_pk_bf16_f32 v148, v148, v149
v_cvt_pk_bf16_f32 v149, v150, v151
v_cvt_pk_bf16_f32 v150, v156, v157
v_mfma_f32_16x16x32_bf16 v[164:167], a[192:195], a[248:251], v[164:167]
v_cvt_pk_bf16_f32 v151, v158, v159
v_mfma_f32_16x16x32_bf16 v[160:163], a[200:203], a[248:251], v[160:163]
s_waitcnt lgkmcnt(7)
ds_write_b128 v41, v[148:151] offset:6144
v_mfma_f32_16x16x32_bf16 v[172:175], a[228:231], a[252:255], v[172:175]
ds_read_b128 a[248:251], v38 offset:10240
v_cvt_pk_bf16_f32 v144, v144, v145
v_mfma_f32_16x16x32_bf16 v[168:171], a[236:239], a[252:255], v[168:171]
s_add_u32 m0, s33, 0x1000
s_add_u32 s35, s42, 0x10000
v_cvt_pk_bf16_f32 v145, v146, v147
v_cvt_pk_bf16_f32 v146, v152, v153
v_mfma_f32_16x16x32_bf16 v[164:167], a[224:227], a[252:255], v[164:167]
v_cvt_pk_bf16_f32 v147, v154, v155
v_mfma_f32_16x16x32_bf16 v[160:163], a[232:235], a[252:255], v[160:163]
s_waitcnt lgkmcnt(6)
s_waitcnt lgkmcnt(4)
buffer_load_dwordx4 v12, s[12:15], s35 offen nt lds
v_mfma_f32_16x16x32_bf16 v[188:191], a[196:199], a[240:243], v[188:191]
ds_read_b128 a[252:255], v39 offset:10240
ds_write_b128 v41, v[144:147] offset:16384
v_mfma_f32_16x16x32_bf16 v[184:187], a[204:207], a[240:243], v[184:187]
v_cvt_pk_bf16_f32 v164, v164, v165
v_cvt_pk_bf16_f32 v165, v166, v167
v_cvt_pk_bf16_f32 v166, v172, v173
v_mfma_f32_16x16x32_bf16 v[180:183], a[192:195], a[240:243], v[180:183]
v_cvt_pk_bf16_f32 v167, v174, v175
v_mfma_f32_16x16x32_bf16 v[176:179], a[200:203], a[240:243], v[176:179]
s_waitcnt lgkmcnt(5)
buffer_load_dwordx4 v13, s[12:15], s35 offen offset:1024 nt lds
v_mfma_f32_16x16x32_bf16 v[188:191], a[228:231], a[244:247], v[188:191]
s_waitcnt lgkmcnt(0)
s_barrier
ds_read_b128 a[240:243], v5
v_mfma_f32_16x16x32_bf16 v[184:187], a[236:239], a[244:247], v[184:187]
ds_write_b128 v41, v[164:167] offset:7168
v_cvt_pk_bf16_f32 v160, v160, v161
v_cvt_pk_bf16_f32 v161, v162, v163
v_mfma_f32_16x16x32_bf16 v[180:183], a[224:227], a[244:247], v[180:183]
v_cvt_pk_bf16_f32 v162, v168, v169
v_cvt_pk_bf16_f32 v163, v170, v171
v_mfma_f32_16x16x32_bf16 v[176:179], a[232:235], a[244:247], v[176:179]
buffer_load_dwordx4 v14, s[12:15], s35 offen offset:2048 nt lds
v_mfma_f32_16x16x32_bf16 v[204:207], a[196:199], a[248:251], v[204:207]
ds_read_b128 a[244:247], v5 offset:1024
ds_write_b128 v41, v[160:163] offset:17408
v_mfma_f32_16x16x32_bf16 v[200:203], a[204:207], a[248:251], v[200:203]
v_cvt_pk_bf16_f32 v180, v180, v181
v_cvt_pk_bf16_f32 v181, v182, v183
v_cvt_pk_bf16_f32 v182, v188, v189
v_mfma_f32_16x16x32_bf16 v[196:199], a[192:195], a[248:251], v[196:199]
v_cvt_pk_bf16_f32 v183, v190, v191
v_mfma_f32_16x16x32_bf16 v[192:195], a[200:203], a[248:251], v[192:195]
buffer_load_dwordx4 v15, s[12:15], s35 offen offset:3072 nt lds
v_mfma_f32_16x16x32_bf16 v[204:207], a[228:231], a[252:255], v[204:207]
ds_read_b128 a[248:251], v5 offset:2048
v_mfma_f32_16x16x32_bf16 v[200:203], a[236:239], a[252:255], v[200:203]
ds_write_b128 v41, v[180:183] offset:8192
v_cvt_pk_bf16_f32 v176, v176, v177
v_cvt_pk_bf16_f32 v177, v178, v179
v_mfma_f32_16x16x32_bf16 v[196:199], a[224:227], a[252:255], v[196:199]
v_cvt_pk_bf16_f32 v178, v184, v185
v_cvt_pk_bf16_f32 v179, v186, v187
v_mfma_f32_16x16x32_bf16 v[192:195], a[232:235], a[252:255], v[192:195]
s_waitcnt lgkmcnt(5)
ds_write_b128 v41, v[176:179] offset:18432
v_mfma_f32_16x16x32_bf16 v[48:51], a[0:3], a[240:243], 0
ds_read_b128 a[252:255], v5 offset:3072
v_mfma_f32_16x16x32_bf16 v[52:55], a[4:7], a[240:243], 0
v_cvt_pk_bf16_f32 v196, v196, v197
v_cvt_pk_bf16_f32 v197, v198, v199
v_mfma_f32_16x16x32_bf16 v[128:131], a[16:19], a[240:243], 0
v_cvt_pk_bf16_f32 v198, v204, v205
v_cvt_pk_bf16_f32 v199, v206, v207
v_mfma_f32_16x16x32_bf16 v[132:135], a[20:23], a[240:243], 0
s_waitcnt lgkmcnt(5)
v_mfma_f32_16x16x32_bf16 v[56:59], a[0:3], a[244:247], 0
ds_read_b128 a[240:243], v5 offset:4096
v_mfma_f32_16x16x32_bf16 v[60:63], a[4:7], a[244:247], 0
ds_write_b128 v41, v[196:199] offset:9216
v_mfma_f32_16x16x32_bf16 v[136:139], a[16:19], a[244:247], 0
v_cvt_pk_bf16_f32 v192, v192, v193
v_mfma_f32_16x16x32_bf16 v[140:143], a[20:23], a[244:247], 0
s_waitcnt lgkmcnt(5)
v_cvt_pk_bf16_f32 v193, v194, v195
v_cvt_pk_bf16_f32 v194, v200, v201
v_mfma_f32_16x16x32_bf16 v[64:67], a[0:3], a[248:251], 0
ds_read_b128 a[244:247], v5 offset:5120
v_cvt_pk_bf16_f32 v195, v202, v203
v_mfma_f32_16x16x32_bf16 v[68:71], a[4:7], a[248:251], 0
v_mfma_f32_16x16x32_bf16 v[144:147], a[16:19], a[248:251], 0
ds_write_b128 v41, v[192:195] offset:19456
v_mfma_f32_16x16x32_bf16 v[148:151], a[20:23], a[248:251], 0
s_waitcnt lgkmcnt(4)
v_mfma_f32_16x16x32_bf16 v[72:75], a[0:3], a[252:255], 0
s_waitcnt lgkmcnt(0)
s_barrier
ds_read_b128 a[248:251], v5 offset:6144
v_mfma_f32_16x16x32_bf16 v[76:79], a[4:7], a[252:255], 0
s_waitcnt vmcnt(12)
ds_read_b128 a[32:35], v3 offset:8192
v_mfma_f32_16x16x32_bf16 v[152:155], a[16:19], a[252:255], 0
ds_read_b128 a[36:39], v3 offset:10240
v_mfma_f32_16x16x32_bf16 v[156:159], a[20:23], a[252:255], 0
v_mfma_f32_16x16x32_bf16 v[80:83], a[0:3], a[240:243], 0
ds_read_b128 a[252:255], v5 offset:7168
v_mfma_f32_16x16x32_bf16 v[84:87], a[4:7], a[240:243], 0
ds_read_b128 a[40:43], v4 offset:8192
v_mfma_f32_16x16x32_bf16 v[160:163], a[16:19], a[240:243], 0
ds_read_b128 a[44:47], v4 offset:10240
v_mfma_f32_16x16x32_bf16 v[164:167], a[20:23], a[240:243], 0
v_mfma_f32_16x16x32_bf16 v[88:91], a[0:3], a[244:247], 0
ds_read_b128 a[240:243], v5 offset:8192
v_mfma_f32_16x16x32_bf16 v[92:95], a[4:7], a[244:247], 0
v_mfma_f32_16x16x32_bf16 v[168:171], a[16:19], a[244:247], 0
v_mfma_f32_16x16x32_bf16 v[172:175], a[20:23], a[244:247], 0
s_waitcnt lgkmcnt(6)
v_mfma_f32_16x16x32_bf16 v[96:99], a[0:3], a[248:251], 0
ds_read_b128 a[244:247], v5 offset:9216
v_mfma_f32_16x16x32_bf16 v[100:103], a[4:7], a[248:251], 0
s_add_u32 m0, s33, 0x2000
s_add_u32 s35, s43, 0
v_mfma_f32_16x16x32_bf16 v[176:179], a[16:19], a[248:251], 0
s_waitcnt lgkmcnt(2)
buffer_load_dwordx4 v12, s[12:15], s35 offen nt lds
v_mfma_f32_16x16x32_bf16 v[180:183], a[20:23], a[248:251], 0
v_mfma_f32_16x16x32_bf16 v[104:107], a[0:3], a[252:255], 0
ds_read_b128 a[248:251], v5 offset:10240
v_mfma_f32_16x16x32_bf16 v[108:111], a[4:7], a[252:255], 0
buffer_load_dwordx4 v13, s[12:15], s35 offen offset:1024 nt lds
v_mfma_f32_16x16x32_bf16 v[184:187], a[16:19], a[252:255], 0
v_mfma_f32_16x16x32_bf16 v[188:191], a[20:23], a[252:255], 0
s_waitcnt lgkmcnt(2)
v_mfma_f32_16x16x32_bf16 v[112:115], a[0:3], a[240:243], 0
ds_read_b128 a[252:255], v5 offset:11264
v_mfma_f32_16x16x32_bf16 v[116:119], a[4:7], a[240:243], 0
buffer_load_dwordx4 v14, s[12:15], s35 offen offset:2048 nt lds
v_mfma_f32_16x16x32_bf16 v[192:195], a[16:19], a[240:243], 0
v_mfma_f32_16x16x32_bf16 v[196:199], a[20:23], a[240:243], 0
s_waitcnt lgkmcnt(2)
v_mfma_f32_16x16x32_bf16 v[120:123], a[0:3], a[244:247], 0
ds_read_b128 a[240:243], v5 offset:12288
v_mfma_f32_16x16x32_bf16 v[124:127], a[4:7], a[244:247], 0
buffer_load_dwordx4 v15, s[12:15], s35 offen offset:3072 nt lds
v_mfma_f32_16x16x32_bf16 v[200:203], a[16:19], a[244:247], 0
v_mfma_f32_16x16x32_bf16 v[204:207], a[20:23], a[244:247], 0
s_waitcnt lgkmcnt(2)
v_mfma_f32_16x16x32_bf16 v[48:51], a[8:11], a[248:251], v[48:51]
ds_read_b128 a[244:247], v5 offset:13312
v_mfma_f32_16x16x32_bf16 v[52:55], a[12:15], a[248:251], v[52:55]
s_waitcnt vmcnt(12)
ds_read_b128 a[48:51], v3 offset:12288
v_mfma_f32_16x16x32_bf16 v[128:131], a[24:27], a[248:251], v[128:131]
v_mfma_f32_16x16x32_bf16 v[132:135], a[28:31], a[248:251], v[132:135]
s_waitcnt lgkmcnt(3)
v_mfma_f32_16x16x32_bf16 v[56:59], a[8:11], a[252:255], v[56:59]
ds_read_b128 a[248:251], v5 offset:14336
v_mfma_f32_16x16x32_bf16 v[60:63], a[12:15], a[252:255], v[60:63]
ds_read_b128 a[52:55], v3 offset:14336
v_mfma_f32_16x16x32_bf16 v[136:139], a[24:27], a[252:255], v[136:139]
v_mfma_f32_16x16x32_bf16 v[140:143], a[28:31], a[252:255], v[140:143]
s_waitcnt lgkmcnt(4)
v_mfma_f32_16x16x32_bf16 v[64:67], a[8:11], a[240:243], v[64:67]
ds_read_b128 a[252:255], v5 offset:15360
v_mfma_f32_16x16x32_bf16 v[68:71], a[12:15], a[240:243], v[68:71]
ds_read_b128 a[56:59], v4 offset:12288
v_mfma_f32_16x16x32_bf16 v[144:147], a[24:27], a[240:243], v[144:147]
v_mfma_f32_16x16x32_bf16 v[148:151], a[28:31], a[240:243], v[148:151]
s_waitcnt lgkmcnt(5)
v_mfma_f32_16x16x32_bf16 v[72:75], a[8:11], a[244:247], v[72:75]
ds_read_b128 a[240:243], v5 offset:16384
v_mfma_f32_16x16x32_bf16 v[76:79], a[12:15], a[244:247], v[76:79]
ds_read_b128 a[60:63], v4 offset:14336
v_mfma_f32_16x16x32_bf16 v[152:155], a[24:27], a[244:247], v[152:155]
v_mfma_f32_16x16x32_bf16 v[156:159], a[28:31], a[244:247], v[156:159]
s_waitcnt lgkmcnt(5)
v_mfma_f32_16x16x32_bf16 v[80:83], a[8:11], a[248:251], v[80:83]
ds_read_b128 a[244:247], v5 offset:17408
v_mfma_f32_16x16x32_bf16 v[84:87], a[12:15], a[248:251], v[84:87]
v_mfma_f32_16x16x32_bf16 v[160:163], a[24:27], a[248:251], v[160:163]
v_mfma_f32_16x16x32_bf16 v[164:167], a[28:31], a[248:251], v[164:167]
s_waitcnt lgkmcnt(4)
v_mfma_f32_16x16x32_bf16 v[88:91], a[8:11], a[252:255], v[88:91]
ds_read_b128 a[248:251], v5 offset:18432
v_mfma_f32_16x16x32_bf16 v[92:95], a[12:15], a[252:255], v[92:95]
s_add_u32 m0, s33, 0x3000
s_add_u32 s35, s43, 0x10000
v_mfma_f32_16x16x32_bf16 v[168:171], a[24:27], a[252:255], v[168:171]
s_waitcnt lgkmcnt(2)
buffer_load_dwordx4 v12, s[12:15], s35 offen nt lds
v_mfma_f32_16x16x32_bf16 v[172:175], a[28:31], a[252:255], v[172:175]
v_mfma_f32_16x16x32_bf16 v[96:99], a[8:11], a[240:243], v[96:99]
ds_read_b128 a[252:255], v5 offset:19456
v_mfma_f32_16x16x32_bf16 v[100:103], a[12:15], a[240:243], v[100:103]
buffer_load_dwordx4 v13, s[12:15], s35 offen offset:1024 nt lds
v_mfma_f32_16x16x32_bf16 v[176:179], a[24:27], a[240:243], v[176:179]
v_mfma_f32_16x16x32_bf16 v[180:183], a[28:31], a[240:243], v[180:183]
s_waitcnt lgkmcnt(2)
v_mfma_f32_16x16x32_bf16 v[104:107], a[8:11], a[244:247], v[104:107]
ds_read_b128 a[240:243], v6
v_mfma_f32_16x16x32_bf16 v[108:111], a[12:15], a[244:247], v[108:111]
buffer_load_dwordx4 v14, s[12:15], s35 offen offset:2048 nt lds
v_mfma_f32_16x16x32_bf16 v[184:187], a[24:27], a[244:247], v[184:187]
v_mfma_f32_16x16x32_bf16 v[188:191], a[28:31], a[244:247], v[188:191]
s_waitcnt lgkmcnt(2)
v_mfma_f32_16x16x32_bf16 v[112:115], a[8:11], a[248:251], v[112:115]
ds_read_b128 a[244:247], v6 offset:1024
v_mfma_f32_16x16x32_bf16 v[116:119], a[12:15], a[248:251], v[116:119]
buffer_load_dwordx4 v15, s[12:15], s35 offen offset:3072 nt lds
v_mfma_f32_16x16x32_bf16 v[192:195], a[24:27], a[248:251], v[192:195]
v_mfma_f32_16x16x32_bf16 v[196:199], a[28:31], a[248:251], v[196:199]
s_waitcnt lgkmcnt(2)
v_mfma_f32_16x16x32_bf16 v[120:123], a[8:11], a[252:255], v[120:123]
ds_read_b128 a[248:251], v6 offset:2048
v_mfma_f32_16x16x32_bf16 v[124:127], a[12:15], a[252:255], v[124:127]
v_mfma_f32_16x16x32_bf16 v[200:203], a[24:27], a[252:255], v[200:203]
v_mfma_f32_16x16x32_bf16 v[204:207], a[28:31], a[252:255], v[204:207]
s_waitcnt lgkmcnt(2)
s_cmp_eq_u32 s34, 0
s_cbranch_scc0 L_nx_wo
v_lshrrev_b32 v0, 9, v1
v_lshlrev_b32 v0, 13, v0
v_and_b32 v36, 0x1f0, v1
v_add_u32 v0, v0, v36
s_lshr_b32 s38, s54, 1
s_mul_i32 s38, s38, 28
s_mul_i32 s39, s32, 7
s_add_u32 s38, s38, s39
s_lshl_b32 s38, s38, 14
s_add_u32 s38, s38, 0x200
s_mov_b32 s39, 0x4000
s_branch L_nx_done
L_nx_wo:
s_mov_b32 s8, s20
s_mov_b32 s9, s21
s_mov_b32 s10, s22
s_mov_b32 s44, 0
s_mov_b32 s45, 0xe000
s_mov_b32 s46, 0x1c000
s_mov_b32 s47, 0x2a000
s_mov_b32 s57, 0x1800
s_mov_b32 s58, 0x3000
s_mov_b32 s59, 0x4800
v_lshrrev_b32 v36, 7, v1
v_and_b32 v37, 6, v36
v_bfe_u32 v38, v1, 4, 3
v_xor_b32 v37, v37, v38
v_mul_u32_u24 v36, 0x380, v36
v_lshl_add_u32 v19, v37, 4, v36
s_lshl_b32 s36, s32, 7
v_add_u32 v19, s36, v19
v_min_u32 v37, 5, v37
v_lshl_add_u32 v18, v37, 4, v36
s_mul_i32 s36, s32, 0x60
s_add_u32 s36, s36, 0x200
v_add_u32 v18, s36, v18
v_mov_b32 v0, v1
s_mul_i32 s38, s54, 28
s_mul_i32 s39, s32, 7
s_add_u32 s38, s38, s39
s_lshl_b32 s38, s38, 10
s_mov_b32 s39, 0x400
s_mov_b32 s6, 0
s_mov_b32 s53, 0x30000
s_mov_b32 s96, 0
L_nx_done:
v_mfma_f32_16x16x32_bf16 v[48:51], a[32:35], a[240:243], v[48:51]
ds_read_b128 a[252:255], v6 offset:3072
v_mfma_f32_16x16x32_bf16 v[52:55], a[36:39], a[240:243], v[52:55]
s_waitcnt vmcnt(12)
ds_read_b128 a[64:67], v3
v_mfma_f32_16x16x32_bf16 v[128:131], a[48:51], a[240:243], v[128:131]
v_mfma_f32_16x16x32_bf16 v[132:135], a[52:55], a[240:243], v[132:135]
s_waitcnt lgkmcnt(3)
v_mfma_f32_16x16x32_bf16 v[56:59], a[32:35], a[244:247], v[56:59]
ds_read_b128 a[240:243], v6 offset:4096
v_mfma_f32_16x16x32_bf16 v[60:63], a[36:39], a[244:247], v[60:63]
ds_read_b128 a[68:71], v3 offset:2048
v_mfma_f32_16x16x32_bf16 v[136:139], a[48:51], a[244:247], v[136:139]
v_mfma_f32_16x16x32_bf16 v[140:143], a[52:55], a[244:247], v[140:143]
s_waitcnt lgkmcnt(4)
v_mfma_f32_16x16x32_bf16 v[64:67], a[32:35], a[248:251], v[64:67]
ds_read_b128 a[244:247], v6 offset:5120
v_mfma_f32_16x16x32_bf16 v[68:71], a[36:39], a[248:251], v[68:71]
ds_read_b128 a[72:75], v4
v_mfma_f32_16x16x32_bf16 v[144:147], a[48:51], a[248:251], v[144:147]
v_mfma_f32_16x16x32_bf16 v[148:151], a[52:55], a[248:251], v[148:151]
s_waitcnt lgkmcnt(5)
v_mfma_f32_16x16x32_bf16 v[72:75], a[32:35], a[252:255], v[72:75]
ds_read_b128 a[248:251], v6 offset:6144
v_mfma_f32_16x16x32_bf16 v[76:79], a[36:39], a[252:255], v[76:79]
ds_read_b128 a[76:79], v4 offset:2048
v_mfma_f32_16x16x32_bf16 v[152:155], a[48:51], a[252:255], v[152:155]
v_mfma_f32_16x16x32_bf16 v[156:159], a[52:55], a[252:255], v[156:159]
s_waitcnt lgkmcnt(5)
v_mfma_f32_16x16x32_bf16 v[80:83], a[32:35], a[240:243], v[80:83]
ds_read_b128 a[252:255], v6 offset:7168
v_mfma_f32_16x16x32_bf16 v[84:87], a[36:39], a[240:243], v[84:87]
v_mfma_f32_16x16x32_bf16 v[160:163], a[48:51], a[240:243], v[160:163]
v_mfma_f32_16x16x32_bf16 v[164:167], a[52:55], a[240:243], v[164:167]
s_waitcnt lgkmcnt(4)
v_mfma_f32_16x16x32_bf16 v[88:91], a[32:35], a[244:247], v[88:91]
ds_read_b128 a[240:243], v6 offset:8192
v_mfma_f32_16x16x32_bf16 v[92:95], a[36:39], a[244:247], v[92:95]
s_add_u32 m0, s33, 0
s_add_u32 s35, s40, 0x20000
v_mfma_f32_16x16x32_bf16 v[168:171], a[48:51], a[244:247], v[168:171]
s_waitcnt lgkmcnt(2)
buffer_load_dwordx4 v12, s[12:15], s35 offen nt lds
v_mfma_f32_16x16x32_bf16 v[172:175], a[52:55], a[244:247], v[172:175]
v_mfma_f32_16x16x32_bf16 v[96:99], a[32:35], a[248:251], v[96:99]
ds_read_b128 a[244:247], v6 offset:9216
v_mfma_f32_16x16x32_bf16 v[100:103], a[36:39], a[248:251], v[100:103]
buffer_load_dwordx4 v13, s[12:15], s35 offen offset:1024 nt lds
v_mfma_f32_16x16x32_bf16 v[176:179], a[48:51], a[248:251], v[176:179]
v_mfma_f32_16x16x32_bf16 v[180:183], a[52:55], a[248:251], v[180:183]
s_waitcnt lgkmcnt(2)
v_mfma_f32_16x16x32_bf16 v[104:107], a[32:35], a[252:255], v[104:107]
ds_read_b128 a[248:251], v6 offset:10240
v_mfma_f32_16x16x32_bf16 v[108:111], a[36:39], a[252:255], v[108:111]
buffer_load_dwordx4 v14, s[12:15], s35 offen offset:2048 nt lds
v_mfma_f32_16x16x32_bf16 v[184:187], a[48:51], a[252:255], v[184:187]
v_mfma_f32_16x16x32_bf16 v[188:191], a[52:55], a[252:255], v[188:191]
s_waitcnt lgkmcnt(2)
v_mfma_f32_16x16x32_bf16 v[112:115], a[32:35], a[240:243], v[112:115]
ds_read_b128 a[252:255], v6 offset:11264
v_mfma_f32_16x16x32_bf16 v[116:119], a[36:39], a[240:243], v[116:119]
buffer_load_dwordx4 v15, s[12:15], s35 offen offset:3072 nt lds
v_mfma_f32_16x16x32_bf16 v[192:195], a[48:51], a[240:243], v[192:195]
v_mfma_f32_16x16x32_bf16 v[196:199], a[52:55], a[240:243], v[196:199]
s_waitcnt lgkmcnt(2)
v_mfma_f32_16x16x32_bf16 v[120:123], a[32:35], a[244:247], v[120:123]
ds_read_b128 a[240:243], v6 offset:12288
v_mfma_f32_16x16x32_bf16 v[124:127], a[36:39], a[244:247], v[124:127]
v_mfma_f32_16x16x32_bf16 v[200:203], a[48:51], a[244:247], v[200:203]
v_mfma_f32_16x16x32_bf16 v[204:207], a[52:55], a[244:247], v[204:207]
s_waitcnt lgkmcnt(2)
v_mfma_f32_16x16x32_bf16 v[48:51], a[40:43], a[248:251], v[48:51]
ds_read_b128 a[244:247], v6 offset:13312
v_mfma_f32_16x16x32_bf16 v[52:55], a[44:47], a[248:251], v[52:55]
s_waitcnt vmcnt(12)
ds_read_b128 a[80:83], v3 offset:4096
v_mfma_f32_16x16x32_bf16 v[128:131], a[56:59], a[248:251], v[128:131]
v_mfma_f32_16x16x32_bf16 v[132:135], a[60:63], a[248:251], v[132:135]
s_waitcnt lgkmcnt(3)
v_mfma_f32_16x16x32_bf16 v[56:59], a[40:43], a[252:255], v[56:59]
ds_read_b128 a[248:251], v6 offset:14336
v_mfma_f32_16x16x32_bf16 v[60:63], a[44:47], a[252:255], v[60:63]
ds_read_b128 a[84:87], v3 offset:6144
v_mfma_f32_16x16x32_bf16 v[136:139], a[56:59], a[252:255], v[136:139]
v_mfma_f32_16x16x32_bf16 v[140:143], a[60:63], a[252:255], v[140:143]
s_waitcnt lgkmcnt(4)
v_mfma_f32_16x16x32_bf16 v[64:67], a[40:43], a[240:243], v[64:67]
ds_read_b128 a[252:255], v6 offset:15360
v_mfma_f32_16x16x32_bf16 v[68:71], a[44:47], a[240:243], v[68:71]
ds_read_b128 a[88:91], v4 offset:4096
v_mfma_f32_16x16x32_bf16 v[144:147], a[56:59], a[240:243], v[144:147]
v_mfma_f32_16x16x32_bf16 v[148:151], a[60:63], a[240:243], v[148:151]
s_waitcnt lgkmcnt(5)
v_mfma_f32_16x16x32_bf16 v[72:75], a[40:43], a[244:247], v[72:75]
ds_read_b128 a[240:243], v6 offset:16384
v_mfma_f32_16x16x32_bf16 v[76:79], a[44:47], a[244:247], v[76:79]
ds_read_b128 a[92:95], v4 offset:6144
v_mfma_f32_16x16x32_bf16 v[152:155], a[56:59], a[244:247], v[152:155]
v_mfma_f32_16x16x32_bf16 v[156:159], a[60:63], a[244:247], v[156:159]
s_waitcnt lgkmcnt(5)
v_mfma_f32_16x16x32_bf16 v[80:83], a[40:43], a[248:251], v[80:83]
ds_read_b128 a[244:247], v6 offset:17408
v_mfma_f32_16x16x32_bf16 v[84:87], a[44:47], a[248:251], v[84:87]
v_mfma_f32_16x16x32_bf16 v[160:163], a[56:59], a[248:251], v[160:163]
v_mfma_f32_16x16x32_bf16 v[164:167], a[60:63], a[248:251], v[164:167]
s_waitcnt lgkmcnt(4)
v_mfma_f32_16x16x32_bf16 v[88:91], a[40:43], a[252:255], v[88:91]
ds_read_b128 a[248:251], v6 offset:18432
v_mfma_f32_16x16x32_bf16 v[92:95], a[44:47], a[252:255], v[92:95]
s_add_u32 m0, s33, 0x1000
s_add_u32 s35, s40, 0x30000
v_mfma_f32_16x16x32_bf16 v[168:171], a[56:59], a[252:255], v[168:171]
s_waitcnt lgkmcnt(2)
buffer_load_dwordx4 v12, s[12:15], s35 offen nt lds
v_mfma_f32_16x16x32_bf16 v[172:175], a[60:63], a[252:255], v[172:175]
v_mfma_f32_16x16x32_bf16 v[96:99], a[40:43], a[240:243], v[96:99]
ds_read_b128 a[252:255], v6 offset:19456
v_mfma_f32_16x16x32_bf16 v[100:103], a[44:47], a[240:243], v[100:103]
buffer_load_dwordx4 v13, s[12:15], s35 offen offset:1024 nt lds
v_mfma_f32_16x16x32_bf16 v[176:179], a[56:59], a[240:243], v[176:179]
v_mfma_f32_16x16x32_bf16 v[180:183], a[60:63], a[240:243], v[180:183]
s_waitcnt lgkmcnt(2)
v_mfma_f32_16x16x32_bf16 v[104:107], a[40:43], a[244:247], v[104:107]
ds_read_b128 a[240:243], v5 offset:40960
v_mfma_f32_16x16x32_bf16 v[108:111], a[44:47], a[244:247], v[108:111]
buffer_load_dwordx4 v14, s[12:15], s35 offen offset:2048 nt lds
v_mfma_f32_16x16x32_bf16 v[184:187], a[56:59], a[244:247], v[184:187]
v_mfma_f32_16x16x32_bf16 v[188:191], a[60:63], a[244:247], v[188:191]
s_waitcnt lgkmcnt(2)
v_mfma_f32_16x16x32_bf16 v[112:115], a[40:43], a[248:251], v[112:115]
ds_read_b128 a[244:247], v5 offset:41984
v_mfma_f32_16x16x32_bf16 v[116:119], a[44:47], a[248:251], v[116:119]
buffer_load_dwordx4 v15, s[12:15], s35 offen offset:3072 nt lds
v_mfma_f32_16x16x32_bf16 v[192:195], a[56:59], a[248:251], v[192:195]
v_mfma_f32_16x16x32_bf16 v[196:199], a[60:63], a[248:251], v[196:199]
s_waitcnt lgkmcnt(2)
v_mov_b32 v45, s99
v_mfma_f32_16x16x32_bf16 v[120:123], a[40:43], a[252:255], v[120:123]
ds_read_b128 a[248:251], v5 offset:43008
v_add_co_u32 v44, vcc, s98, v1
v_mfma_f32_16x16x32_bf16 v[124:127], a[44:47], a[252:255], v[124:127]
s_nop 0
v_addc_co_u32 v45, vcc, 0, v45, vcc
v_mfma_f32_16x16x32_bf16 v[200:203], a[56:59], a[252:255], v[200:203]
s_mov_b32 m0, s49
s_nop 0
global_load_lds_dwordx4 v[44:45], off
v_mfma_f32_16x16x32_bf16 v[204:207], a[60:63], a[252:255], v[204:207]
s_waitcnt lgkmcnt(2)
v_mfma_f32_16x16x32_bf16 v[48:51], a[64:67], a[240:243], v[48:51]
ds_read_b128 a[252:255], v5 offset:44032
v_mfma_f32_16x16x32_bf16 v[52:55], a[68:71], a[240:243], v[52:55]
s_waitcnt vmcnt(13)
ds_read_b128 a[96:99], v3 offset:8192
v_mfma_f32_16x16x32_bf16 v[128:131], a[80:83], a[240:243], v[128:131]
v_mfma_f32_16x16x32_bf16 v[132:135], a[84:87], a[240:243], v[132:135]
s_waitcnt lgkmcnt(3)
v_mfma_f32_16x16x32_bf16 v[56:59], a[64:67], a[244:247], v[56:59]
ds_read_b128 a[240:243], v5 offset:45056
v_mfma_f32_16x16x32_bf16 v[60:63], a[68:71], a[244:247], v[60:63]
ds_read_b128 a[100:103], v3 offset:10240
v_mfma_f32_16x16x32_bf16 v[136:139], a[80:83], a[244:247], v[136:139]
v_mfma_f32_16x16x32_bf16 v[140:143], a[84:87], a[244:247], v[140:143]
s_waitcnt lgkmcnt(4)
v_mfma_f32_16x16x32_bf16 v[64:67], a[64:67], a[248:251], v[64:67]
ds_read_b128 a[244:247], v5 offset:46080
v_mfma_f32_16x16x32_bf16 v[68:71], a[68:71], a[248:251], v[68:71]
ds_read_b128 a[104:107], v4 offset:8192
v_mfma_f32_16x16x32_bf16 v[144:147], a[80:83], a[248:251], v[144:147]
v_mfma_f32_16x16x32_bf16 v[148:151], a[84:87], a[248:251], v[148:151]
s_waitcnt lgkmcnt(5)
v_mfma_f32_16x16x32_bf16 v[72:75], a[64:67], a[252:255], v[72:75]
ds_read_b128 a[248:251], v5 offset:47104
v_mfma_f32_16x16x32_bf16 v[76:79], a[68:71], a[252:255], v[76:79]
ds_read_b128 a[108:111], v4 offset:10240
v_mfma_f32_16x16x32_bf16 v[152:155], a[80:83], a[252:255], v[152:155]
v_mfma_f32_16x16x32_bf16 v[156:159], a[84:87], a[252:255], v[156:159]
s_waitcnt lgkmcnt(5)
v_mfma_f32_16x16x32_bf16 v[80:83], a[64:67], a[240:243], v[80:83]
ds_read_b128 a[252:255], v5 offset:48128
v_mfma_f32_16x16x32_bf16 v[84:87], a[68:71], a[240:243], v[84:87]
v_mfma_f32_16x16x32_bf16 v[160:163], a[80:83], a[240:243], v[160:163]
v_mfma_f32_16x16x32_bf16 v[164:167], a[84:87], a[240:243], v[164:167]
s_waitcnt lgkmcnt(4)
v_mfma_f32_16x16x32_bf16 v[88:91], a[64:67], a[244:247], v[88:91]
ds_read_b128 a[240:243], v5 offset:49152
v_mfma_f32_16x16x32_bf16 v[92:95], a[68:71], a[244:247], v[92:95]
s_add_u32 m0, s33, 0x2000
s_add_u32 s35, s41, 0x20000
v_mfma_f32_16x16x32_bf16 v[168:171], a[80:83], a[244:247], v[168:171]
s_waitcnt lgkmcnt(2)
buffer_load_dwordx4 v12, s[12:15], s35 offen nt lds
v_mfma_f32_16x16x32_bf16 v[172:175], a[84:87], a[244:247], v[172:175]
v_mfma_f32_16x16x32_bf16 v[96:99], a[64:67], a[248:251], v[96:99]
ds_read_b128 a[244:247], v5 offset:50176
v_mfma_f32_16x16x32_bf16 v[100:103], a[68:71], a[248:251], v[100:103]
buffer_load_dwordx4 v13, s[12:15], s35 offen offset:1024 nt lds
v_mfma_f32_16x16x32_bf16 v[176:179], a[80:83], a[248:251], v[176:179]
v_mfma_f32_16x16x32_bf16 v[180:183], a[84:87], a[248:251], v[180:183]
s_waitcnt lgkmcnt(2)
v_mfma_f32_16x16x32_bf16 v[104:107], a[64:67], a[252:255], v[104:107]
ds_read_b128 a[248:251], v5 offset:51200
v_mfma_f32_16x16x32_bf16 v[108:111], a[68:71], a[252:255], v[108:111]
buffer_load_dwordx4 v14, s[12:15], s35 offen offset:2048 nt lds
v_mfma_f32_16x16x32_bf16 v[184:187], a[80:83], a[252:255], v[184:187]
v_mfma_f32_16x16x32_bf16 v[188:191], a[84:87], a[252:255], v[188:191]
s_waitcnt lgkmcnt(2)
v_mfma_f32_16x16x32_bf16 v[112:115], a[64:67], a[240:243], v[112:115]
ds_read_b128 a[252:255], v5 offset:52224
v_mfma_f32_16x16x32_bf16 v[116:119], a[68:71], a[240:243], v[116:119]
buffer_load_dwordx4 v15, s[12:15], s35 offen offset:3072 nt lds
v_mfma_f32_16x16x32_bf16 v[192:195], a[80:83], a[240:243], v[192:195]
v_mfma_f32_16x16x32_bf16 v[196:199], a[84:87], a[240:243], v[196:199]
s_waitcnt lgkmcnt(2)
v_mfma_f32_16x16x32_bf16 v[120:123], a[64:67], a[244:247], v[120:123]
ds_read_b128 a[240:243], v5 offset:53248
v_mfma_f32_16x16x32_bf16 v[124:127], a[68:71], a[244:247], v[124:127]
v_mfma_f32_16x16x32_bf16 v[200:203], a[80:83], a[244:247], v[200:203]
v_mfma_f32_16x16x32_bf16 v[204:207], a[84:87], a[244:247], v[204:207]
s_waitcnt lgkmcnt(2)
v_mfma_f32_16x16x32_bf16 v[48:51], a[72:75], a[248:251], v[48:51]
ds_read_b128 a[244:247], v5 offset:54272
v_mfma_f32_16x16x32_bf16 v[52:55], a[76:79], a[248:251], v[52:55]
s_waitcnt vmcnt(13)
ds_read_b128 v[208:211], v3 offset:12288
v_mfma_f32_16x16x32_bf16 v[128:131], a[88:91], a[248:251], v[128:131]
v_mfma_f32_16x16x32_bf16 v[132:135], a[92:95], a[248:251], v[132:135]
s_waitcnt lgkmcnt(3)
v_mfma_f32_16x16x32_bf16 v[56:59], a[72:75], a[252:255], v[56:59]
ds_read_b128 a[248:251], v5 offset:55296
v_mfma_f32_16x16x32_bf16 v[60:63], a[76:79], a[252:255], v[60:63]
ds_read_b128 v[212:215], v3 offset:14336
v_mfma_f32_16x16x32_bf16 v[136:139], a[88:91], a[252:255], v[136:139]
v_mfma_f32_16x16x32_bf16 v[140:143], a[92:95], a[252:255], v[140:143]
s_waitcnt lgkmcnt(4)
v_mfma_f32_16x16x32_bf16 v[64:67], a[72:75], a[240:243], v[64:67]
ds_read_b128 a[252:255], v5 offset:56320
v_mfma_f32_16x16x32_bf16 v[68:71], a[76:79], a[240:243], v[68:71]
ds_read_b128 v[216:219], v4 offset:12288
v_mfma_f32_16x16x32_bf16 v[144:147], a[88:91], a[240:243], v[144:147]
v_mfma_f32_16x16x32_bf16 v[148:151], a[92:95], a[240:243], v[148:151]
s_waitcnt lgkmcnt(5)
v_mfma_f32_16x16x32_bf16 v[72:75], a[72:75], a[244:247], v[72:75]
ds_read_b128 a[240:243], v5 offset:57344
v_mfma_f32_16x16x32_bf16 v[76:79], a[76:79], a[244:247], v[76:79]
ds_read_b128 v[220:223], v4 offset:14336
v_mfma_f32_16x16x32_bf16 v[152:155], a[88:91], a[244:247], v[152:155]
v_mfma_f32_16x16x32_bf16 v[156:159], a[92:95], a[244:247], v[156:159]
s_waitcnt lgkmcnt(5)
v_mfma_f32_16x16x32_bf16 v[80:83], a[72:75], a[248:251], v[80:83]
ds_read_b128 a[244:247], v5 offset:58368
v_mfma_f32_16x16x32_bf16 v[84:87], a[76:79], a[248:251], v[84:87]
v_mfma_f32_16x16x32_bf16 v[160:163], a[88:91], a[248:251], v[160:163]
v_mfma_f32_16x16x32_bf16 v[164:167], a[92:95], a[248:251], v[164:167]
s_waitcnt lgkmcnt(4)
v_mfma_f32_16x16x32_bf16 v[88:91], a[72:75], a[252:255], v[88:91]
ds_read_b128 a[248:251], v5 offset:59392
v_mfma_f32_16x16x32_bf16 v[92:95], a[76:79], a[252:255], v[92:95]
s_add_u32 m0, s33, 0x3000
s_add_u32 s35, s41, 0x30000
v_mfma_f32_16x16x32_bf16 v[168:171], a[88:91], a[252:255], v[168:171]
s_waitcnt lgkmcnt(2)
buffer_load_dwordx4 v12, s[12:15], s35 offen nt lds
v_mfma_f32_16x16x32_bf16 v[172:175], a[92:95], a[252:255], v[172:175]
v_mfma_f32_16x16x32_bf16 v[96:99], a[72:75], a[240:243], v[96:99]
ds_read_b128 a[252:255], v5 offset:60416
v_mfma_f32_16x16x32_bf16 v[100:103], a[76:79], a[240:243], v[100:103]
buffer_load_dwordx4 v13, s[12:15], s35 offen offset:1024 nt lds
v_mfma_f32_16x16x32_bf16 v[176:179], a[88:91], a[240:243], v[176:179]
v_mfma_f32_16x16x32_bf16 v[180:183], a[92:95], a[240:243], v[180:183]
s_waitcnt lgkmcnt(2)
v_mfma_f32_16x16x32_bf16 v[104:107], a[72:75], a[244:247], v[104:107]
ds_read_b128 a[240:243], v6 offset:40960
v_mfma_f32_16x16x32_bf16 v[108:111], a[76:79], a[244:247], v[108:111]
buffer_load_dwordx4 v14, s[12:15], s35 offen offset:2048 nt lds
v_mfma_f32_16x16x32_bf16 v[184:187], a[88:91], a[244:247], v[184:187]
v_mfma_f32_16x16x32_bf16 v[188:191], a[92:95], a[244:247], v[188:191]
s_waitcnt lgkmcnt(2)
v_mfma_f32_16x16x32_bf16 v[112:115], a[72:75], a[248:251], v[112:115]
ds_read_b128 a[244:247], v6 offset:41984
v_mfma_f32_16x16x32_bf16 v[116:119], a[76:79], a[248:251], v[116:119]
buffer_load_dwordx4 v15, s[12:15], s35 offen offset:3072 nt lds
v_mfma_f32_16x16x32_bf16 v[192:195], a[88:91], a[248:251], v[192:195]
v_mfma_f32_16x16x32_bf16 v[196:199], a[92:95], a[248:251], v[196:199]
s_waitcnt lgkmcnt(2)
v_mfma_f32_16x16x32_bf16 v[120:123], a[72:75], a[252:255], v[120:123]
ds_read_b128 a[248:251], v6 offset:43008
v_mfma_f32_16x16x32_bf16 v[124:127], a[76:79], a[252:255], v[124:127]
v_mfma_f32_16x16x32_bf16 v[200:203], a[88:91], a[252:255], v[200:203]
v_mfma_f32_16x16x32_bf16 v[204:207], a[92:95], a[252:255], v[204:207]
s_waitcnt lgkmcnt(2)
v_mfma_f32_16x16x32_bf16 v[48:51], a[96:99], a[240:243], v[48:51]
ds_read_b128 a[252:255], v6 offset:44032
v_mfma_f32_16x16x32_bf16 v[52:55], a[100:103], a[240:243], v[52:55]
s_waitcnt vmcnt(13)
ds_read_b128 a[192:195], v3
v_mfma_f32_16x16x32_bf16 v[128:131], v[208:211], a[240:243], v[128:131]
v_mfma_f32_16x16x32_bf16 v[132:135], v[212:215], a[240:243], v[132:135]
s_waitcnt lgkmcnt(3)
v_mfma_f32_16x16x32_bf16 v[56:59], a[96:99], a[244:247], v[56:59]
ds_read_b128 a[240:243], v6 offset:45056
v_mfma_f32_16x16x32_bf16 v[60:63], a[100:103], a[244:247], v[60:63]
ds_read_b128 a[196:199], v3 offset:2048
v_mfma_f32_16x16x32_bf16 v[136:139], v[208:211], a[244:247], v[136:139]
v_mfma_f32_16x16x32_bf16 v[140:143], v[212:215], a[244:247], v[140:143]
s_waitcnt lgkmcnt(4)
v_mfma_f32_16x16x32_bf16 v[64:67], a[96:99], a[248:251], v[64:67]
ds_read_b128 a[244:247], v6 offset:46080
v_mfma_f32_16x16x32_bf16 v[68:71], a[100:103], a[248:251], v[68:71]
ds_read_b128 a[200:203], v4
v_mfma_f32_16x16x32_bf16 v[144:147], v[208:211], a[248:251], v[144:147]
v_mfma_f32_16x16x32_bf16 v[148:151], v[212:215], a[248:251], v[148:151]
s_waitcnt lgkmcnt(5)
v_mfma_f32_16x16x32_bf16 v[72:75], a[96:99], a[252:255], v[72:75]
ds_read_b128 a[248:251], v6 offset:47104
v_mfma_f32_16x16x32_bf16 v[76:79], a[100:103], a[252:255], v[76:79]
ds_read_b128 a[204:207], v4 offset:2048
v_mfma_f32_16x16x32_bf16 v[152:155], v[208:211], a[252:255], v[152:155]
v_mfma_f32_16x16x32_bf16 v[156:159], v[212:215], a[252:255], v[156:159]
s_waitcnt lgkmcnt(5)
v_mfma_f32_16x16x32_bf16 v[80:83], a[96:99], a[240:243], v[80:83]
ds_read_b128 a[252:255], v6 offset:48128
v_mfma_f32_16x16x32_bf16 v[84:87], a[100:103], a[240:243], v[84:87]
v_mfma_f32_16x16x32_bf16 v[160:163], v[208:211], a[240:243], v[160:163]
v_mfma_f32_16x16x32_bf16 v[164:167], v[212:215], a[240:243], v[164:167]
s_waitcnt lgkmcnt(4)
v_mfma_f32_16x16x32_bf16 v[88:91], a[96:99], a[244:247], v[88:91]
ds_read_b128 a[240:243], v6 offset:49152
v_mfma_f32_16x16x32_bf16 v[92:95], a[100:103], a[244:247], v[92:95]
v_mfma_f32_16x16x32_bf16 v[168:171], v[208:211], a[244:247], v[168:171]
v_mfma_f32_16x16x32_bf16 v[172:175], v[212:215], a[244:247], v[172:175]
s_waitcnt lgkmcnt(3)
v_mfma_f32_16x16x32_bf16 v[96:99], a[96:99], a[248:251], v[96:99]
ds_read_b128 a[244:247], v6 offset:50176
v_mfma_f32_16x16x32_bf16 v[100:103], a[100:103], a[248:251], v[100:103]
s_add_u32 m0, s33, 0
s_add_u32 s35, s42, 0x20000
v_mfma_f32_16x16x32_bf16 v[176:179], v[208:211], a[248:251], v[176:179]
v_mfma_f32_16x16x32_bf16 v[180:183], v[212:215], a[248:251], v[180:183]
s_waitcnt lgkmcnt(2)
buffer_load_dwordx4 v12, s[12:15], s35 offen nt lds
v_mfma_f32_16x16x32_bf16 v[104:107], a[96:99], a[252:255], v[104:107]
ds_read_b128 a[248:251], v6 offset:51200
v_mfma_f32_16x16x32_bf16 v[108:111], a[100:103], a[252:255], v[108:111]
v_mfma_f32_16x16x32_bf16 v[184:187], v[208:211], a[252:255], v[184:187]
buffer_load_dwordx4 v13, s[12:15], s35 offen offset:1024 nt lds
v_mfma_f32_16x16x32_bf16 v[188:191], v[212:215], a[252:255], v[188:191]
s_waitcnt lgkmcnt(2)
v_mfma_f32_16x16x32_bf16 v[112:115], a[96:99], a[240:243], v[112:115]
ds_read_b128 a[252:255], v6 offset:52224
v_mfma_f32_16x16x32_bf16 v[116:119], a[100:103], a[240:243], v[116:119]
v_mfma_f32_16x16x32_bf16 v[192:195], v[208:211], a[240:243], v[192:195]
buffer_load_dwordx4 v14, s[12:15], s35 offen offset:2048 nt lds
v_mfma_f32_16x16x32_bf16 v[196:199], v[212:215], a[240:243], v[196:199]
s_waitcnt lgkmcnt(2)
v_mfma_f32_16x16x32_bf16 v[120:123], a[96:99], a[244:247], v[120:123]
ds_read_b128 a[240:243], v6 offset:53248
v_mfma_f32_16x16x32_bf16 v[124:127], a[100:103], a[244:247], v[124:127]
v_mfma_f32_16x16x32_bf16 v[200:203], v[208:211], a[244:247], v[200:203]
buffer_load_dwordx4 v15, s[12:15], s35 offen offset:3072 nt lds
v_mfma_f32_16x16x32_bf16 v[204:207], v[212:215], a[244:247], v[204:207]
s_waitcnt lgkmcnt(2)
v_mfma_f32_16x16x32_bf16 v[48:51], a[104:107], a[248:251], v[48:51]
ds_read_b128 a[244:247], v6 offset:54272
v_mfma_f32_16x16x32_bf16 v[52:55], a[108:111], a[248:251], v[52:55]
s_waitcnt vmcnt(13)
ds_read_b128 a[208:211], v3 offset:4096
v_mfma_f32_16x16x32_bf16 v[128:131], v[216:219], a[248:251], v[128:131]
v_mfma_f32_16x16x32_bf16 v[132:135], v[220:223], a[248:251], v[132:135]
s_waitcnt lgkmcnt(3)
v_mfma_f32_16x16x32_bf16 v[56:59], a[104:107], a[252:255], v[56:59]
ds_read_b128 a[248:251], v6 offset:55296
v_mfma_f32_16x16x32_bf16 v[60:63], a[108:111], a[252:255], v[60:63]
ds_read_b128 a[212:215], v3 offset:6144
v_mfma_f32_16x16x32_bf16 v[136:139], v[216:219], a[252:255], v[136:139]
v_mfma_f32_16x16x32_bf16 v[140:143], v[220:223], a[252:255], v[140:143]
s_waitcnt lgkmcnt(4)
v_mfma_f32_16x16x32_bf16 v[64:67], a[104:107], a[240:243], v[64:67]
ds_read_b128 a[252:255], v6 offset:56320
v_mfma_f32_16x16x32_bf16 v[68:71], a[108:111], a[240:243], v[68:71]
ds_read_b128 a[216:219], v4 offset:4096
v_mfma_f32_16x16x32_bf16 v[144:147], v[216:219], a[240:243], v[144:147]
v_mfma_f32_16x16x32_bf16 v[148:151], v[220:223], a[240:243], v[148:151]
s_waitcnt lgkmcnt(5)
v_mfma_f32_16x16x32_bf16 v[72:75], a[104:107], a[244:247], v[72:75]
ds_read_b128 a[240:243], v6 offset:57344
v_mfma_f32_16x16x32_bf16 v[76:79], a[108:111], a[244:247], v[76:79]
ds_read_b128 a[220:223], v4 offset:6144
v_mfma_f32_16x16x32_bf16 v[152:155], v[216:219], a[244:247], v[152:155]
v_mfma_f32_16x16x32_bf16 v[156:159], v[220:223], a[244:247], v[156:159]
s_waitcnt lgkmcnt(5)
v_mfma_f32_16x16x32_bf16 v[80:83], a[104:107], a[248:251], v[80:83]
ds_read_b128 a[244:247], v6 offset:58368
v_mfma_f32_16x16x32_bf16 v[84:87], a[108:111], a[248:251], v[84:87]
v_mfma_f32_16x16x32_bf16 v[160:163], v[216:219], a[248:251], v[160:163]
v_mfma_f32_16x16x32_bf16 v[164:167], v[220:223], a[248:251], v[164:167]
s_waitcnt lgkmcnt(4)
v_mfma_f32_16x16x32_bf16 v[88:91], a[104:107], a[252:255], v[88:91]
ds_read_b128 a[248:251], v6 offset:59392
v_mfma_f32_16x16x32_bf16 v[92:95], a[108:111], a[252:255], v[92:95]
v_mfma_f32_16x16x32_bf16 v[168:171], v[216:219], a[252:255], v[168:171]
v_mfma_f32_16x16x32_bf16 v[172:175], v[220:223], a[252:255], v[172:175]
s_waitcnt lgkmcnt(3)
v_mfma_f32_16x16x32_bf16 v[96:99], a[104:107], a[240:243], v[96:99]
ds_read_b128 a[252:255], v6 offset:60416
v_mfma_f32_16x16x32_bf16 v[100:103], a[108:111], a[240:243], v[100:103]
v_mfma_f32_16x16x32_bf16 v[176:179], v[216:219], a[240:243], v[176:179]
v_mfma_f32_16x16x32_bf16 v[180:183], v[220:223], a[240:243], v[180:183]
s_waitcnt lgkmcnt(2)
v_mfma_f32_16x16x32_bf16 v[104:107], a[104:107], a[244:247], v[104:107]
ds_read_b128 a[240:243], v5
v_mfma_f32_16x16x32_bf16 v[108:111], a[108:111], a[244:247], v[108:111]
s_add_u32 m0, s33, 0x1000
s_add_u32 s35, s42, 0x30000
v_mfma_f32_16x16x32_bf16 v[184:187], v[216:219], a[244:247], v[184:187]
v_mfma_f32_16x16x32_bf16 v[188:191], v[220:223], a[244:247], v[188:191]
s_waitcnt lgkmcnt(2)
buffer_load_dwordx4 v12, s[12:15], s35 offen nt lds
v_mfma_f32_16x16x32_bf16 v[112:115], a[104:107], a[248:251], v[112:115]
ds_read_b128 a[244:247], v5 offset:1024
v_mfma_f32_16x16x32_bf16 v[116:119], a[108:111], a[248:251], v[116:119]
v_mfma_f32_16x16x32_bf16 v[192:195], v[216:219], a[248:251], v[192:195]
buffer_load_dwordx4 v13, s[12:15], s35 offen offset:1024 nt lds
v_mfma_f32_16x16x32_bf16 v[196:199], v[220:223], a[248:251], v[196:199]
s_waitcnt lgkmcnt(2)
v_mfma_f32_16x16x32_bf16 v[120:123], a[104:107], a[252:255], v[120:123]
ds_read_b128 a[248:251], v5 offset:2048
v_mfma_f32_16x16x32_bf16 v[124:127], a[108:111], a[252:255], v[124:127]
v_mfma_f32_16x16x32_bf16 v[200:203], v[216:219], a[252:255], v[200:203]
buffer_load_dwordx4 v14, s[12:15], s35 offen offset:2048 nt lds
v_mfma_f32_16x16x32_bf16 v[204:207], v[220:223], a[252:255], v[204:207]
s_waitcnt lgkmcnt(2)
v_mfma_f32_16x16x32_bf16 v[208:211], a[192:195], a[240:243], 0
ds_read_b128 a[252:255], v5 offset:3072
v_mfma_f32_16x16x32_bf16 v[212:215], a[196:199], a[240:243], 0
s_waitcnt vmcnt(11)
ds_read_b128 a[224:227], v3 offset:8192
v_mfma_f32_16x16x32_bf16 a[32:35], a[208:211], a[240:243], 0
buffer_load_dwordx4 v15, s[12:15], s35 offen offset:3072 nt lds
v_mfma_f32_16x16x32_bf16 a[36:39], a[212:215], a[240:243], 0
s_waitcnt lgkmcnt(3)
v_max_f32 v24, v48, v49
v_max3_f32 v24, v24, v50, v51
v_mfma_f32_16x16x32_bf16 v[216:219], a[192:195], a[244:247], 0
ds_read_b128 a[240:243], v5 offset:4096
v_max3_f32 v24, v24, v52, v53
v_mfma_f32_16x16x32_bf16 v[220:223], a[196:199], a[244:247], 0
ds_read_b128 a[228:231], v3 offset:10240
v_max3_f32 v24, v24, v54, v55
v_mfma_f32_16x16x32_bf16 a[40:43], a[208:211], a[244:247], 0
v_max3_f32 v24, v24, v128, v129
v_max3_f32 v24, v24, v130, v131
v_mfma_f32_16x16x32_bf16 a[44:47], a[212:215], a[244:247], 0
s_waitcnt lgkmcnt(4)
v_max3_f32 v24, v24, v132, v133
v_max3_f32 v24, v24, v134, v135
v_mfma_f32_16x16x32_bf16 v[224:227], a[192:195], a[248:251], 0
ds_read_b128 a[244:247], v5 offset:5120
v_max_f32 v25, v56, v57
v_mfma_f32_16x16x32_bf16 v[228:231], a[196:199], a[248:251], 0
ds_read_b128 a[232:235], v4 offset:8192
v_max3_f32 v25, v25, v58, v59
v_mfma_f32_16x16x32_bf16 a[48:51], a[208:211], a[248:251], 0
v_max3_f32 v25, v25, v60, v61
v_max3_f32 v25, v25, v62, v63
v_mfma_f32_16x16x32_bf16 a[52:55], a[212:215], a[248:251], 0
s_waitcnt lgkmcnt(5)
v_max3_f32 v25, v25, v136, v137
v_max3_f32 v25, v25, v138, v139
v_mfma_f32_16x16x32_bf16 v[232:235], a[192:195], a[252:255], 0
ds_read_b128 a[248:251], v5 offset:6144
v_max3_f32 v25, v25, v140, v141
v_mfma_f32_16x16x32_bf16 v[236:239], a[196:199], a[252:255], 0
ds_read_b128 a[236:239], v4 offset:10240
v_max3_f32 v25, v25, v142, v143
v_max_f32 v26, v64, v65
v_mfma_f32_16x16x32_bf16 a[56:59], a[208:211], a[252:255], 0
v_max3_f32 v26, v26, v66, v67
v_max3_f32 v26, v26, v68, v69
v_mfma_f32_16x16x32_bf16 a[60:63], a[212:215], a[252:255], 0
s_waitcnt lgkmcnt(5)
v_max3_f32 v26, v26, v70, v71
v_max3_f32 v26, v26, v144, v145
v_mfma_f32_16x16x32_bf16 v[240:243], a[192:195], a[240:243], 0
ds_read_b128 a[252:255], v5 offset:7168
v_max3_f32 v26, v26, v146, v147
v_mfma_f32_16x16x32_bf16 v[244:247], a[196:199], a[240:243], 0
v_max3_f32 v26, v26, v148, v149
v_max3_f32 v26, v26, v150, v151
v_mfma_f32_16x16x32_bf16 a[64:67], a[208:211], a[240:243], 0
v_max_f32 v27, v72, v73
v_max3_f32 v27, v27, v74, v75
v_mfma_f32_16x16x32_bf16 a[68:71], a[212:215], a[240:243], 0
s_waitcnt lgkmcnt(4)
v_max3_f32 v27, v27, v76, v77
v_max3_f32 v27, v27, v78, v79
v_mfma_f32_16x16x32_bf16 v[248:251], a[192:195], a[244:247], 0
ds_read_b128 a[240:243], v5 offset:8192
v_max3_f32 v27, v27, v152, v153
v_mfma_f32_16x16x32_bf16 v[252:255], a[196:199], a[244:247], 0
v_max3_f32 v27, v27, v154, v155
v_max3_f32 v27, v27, v156, v157
v_mfma_f32_16x16x32_bf16 a[72:75], a[208:211], a[244:247], 0
v_max3_f32 v27, v27, v158, v159
v_max_f32 v28, v80, v81
v_mfma_f32_16x16x32_bf16 a[76:79], a[212:215], a[244:247], 0
s_waitcnt lgkmcnt(3)
v_max3_f32 v28, v28, v82, v83
v_max3_f32 v28, v28, v84, v85
v_mfma_f32_16x16x32_bf16 a[0:3], a[192:195], a[248:251], 0
ds_read_b128 a[244:247], v5 offset:9216
v_max3_f32 v28, v28, v86, v87
v_mfma_f32_16x16x32_bf16 a[4:7], a[196:199], a[248:251], 0
v_max3_f32 v28, v28, v160, v161
v_max3_f32 v28, v28, v162, v163
v_mfma_f32_16x16x32_bf16 a[80:83], a[208:211], a[248:251], 0
v_max3_f32 v28, v28, v164, v165
v_max3_f32 v28, v28, v166, v167
v_mfma_f32_16x16x32_bf16 a[84:87], a[212:215], a[248:251], 0
s_waitcnt lgkmcnt(2)
v_max_f32 v29, v88, v89
v_max3_f32 v29, v29, v90, v91
v_mfma_f32_16x16x32_bf16 a[8:11], a[192:195], a[252:255], 0
ds_read_b128 a[248:251], v5 offset:10240
v_max3_f32 v29, v29, v92, v93
v_mfma_f32_16x16x32_bf16 a[12:15], a[196:199], a[252:255], 0
v_max3_f32 v29, v29, v94, v95
v_max3_f32 v29, v29, v168, v169
v_mfma_f32_16x16x32_bf16 a[88:91], a[208:211], a[252:255], 0
v_max3_f32 v29, v29, v170, v171
v_max3_f32 v29, v29, v172, v173
v_mfma_f32_16x16x32_bf16 a[92:95], a[212:215], a[252:255], 0
s_waitcnt lgkmcnt(2)
v_max3_f32 v29, v29, v174, v175
v_max_f32 v30, v96, v97
v_mfma_f32_16x16x32_bf16 a[16:19], a[192:195], a[240:243], 0
ds_read_b128 a[252:255], v5 offset:11264
v_max3_f32 v30, v30, v98, v99
v_mfma_f32_16x16x32_bf16 a[20:23], a[196:199], a[240:243], 0
s_add_u32 m0, s33, 0x2000
s_add_u32 s35, s43, 0x20000
v_max3_f32 v30, v30, v100, v101
v_mfma_f32_16x16x32_bf16 a[96:99], a[208:211], a[240:243], 0
v_max3_f32 v30, v30, v102, v103
v_max3_f32 v30, v30, v176, v177
v_mfma_f32_16x16x32_bf16 a[100:103], a[212:215], a[240:243], 0
s_waitcnt lgkmcnt(2)
buffer_load_dwordx4 v12, s[12:15], s35 offen nt lds
v_max3_f32 v30, v30, v178, v179
v_mfma_f32_16x16x32_bf16 a[24:27], a[192:195], a[244:247], 0
ds_read_b128 a[240:243], v5 offset:12288
v_max3_f32 v30, v30, v180, v181
v_mfma_f32_16x16x32_bf16 a[28:31], a[196:199], a[244:247], 0
v_max3_f32 v30, v30, v182, v183
v_max_f32 v31, v104, v105
v_max3_f32 v31, v31, v106, v107
v_mfma_f32_16x16x32_bf16 a[104:107], a[208:211], a[244:247], 0
buffer_load_dwordx4 v13, s[12:15], s35 offen offset:1024 nt lds
v_max3_f32 v31, v31, v108, v109
v_mfma_f32_16x16x32_bf16 a[108:111], a[212:215], a[244:247], 0
s_waitcnt lgkmcnt(2)
v_max3_f32 v31, v31, v110, v111
v_max3_f32 v31, v31, v184, v185
v_mfma_f32_16x16x32_bf16 v[208:211], a[200:203], a[248:251], v[208:211]
ds_read_b128 a[244:247], v5 offset:13312
v_max3_f32 v31, v31, v186, v187
v_mfma_f32_16x16x32_bf16 v[212:215], a[204:207], a[248:251], v[212:215]
s_waitcnt vmcnt(10)
ds_read_b128 a[192:195], v3 offset:12288
v_max3_f32 v31, v31, v188, v189
v_mfma_f32_16x16x32_bf16 a[32:35], a[216:219], a[248:251], a[32:35]
buffer_load_dwordx4 v14, s[12:15], s35 offen offset:2048 nt lds
v_max3_f32 v31, v31, v190, v191
v_mfma_f32_16x16x32_bf16 a[36:39], a[220:223], a[248:251], a[36:39]
s_waitcnt lgkmcnt(3)
v_max_f32 v32, v112, v113
v_max3_f32 v32, v32, v114, v115
v_mfma_f32_16x16x32_bf16 v[216:219], a[200:203], a[252:255], v[216:219]
ds_read_b128 a[248:251], v5 offset:14336
v_max3_f32 v32, v32, v116, v117
v_mfma_f32_16x16x32_bf16 v[220:223], a[204:207], a[252:255], v[220:223]
ds_read_b128 a[196:199], v3 offset:14336
v_max3_f32 v32, v32, v118, v119
v_mfma_f32_16x16x32_bf16 a[40:43], a[216:219], a[252:255], a[40:43]
buffer_load_dwordx4 v15, s[12:15], s35 offen offset:3072 nt lds
v_max3_f32 v32, v32, v192, v193
v_mfma_f32_16x16x32_bf16 a[44:47], a[220:223], a[252:255], a[44:47]
s_waitcnt lgkmcnt(4)
v_max3_f32 v32, v32, v194, v195
v_max3_f32 v32, v32, v196, v197
v_mfma_f32_16x16x32_bf16 v[224:227], a[200:203], a[240:243], v[224:227]
ds_read_b128 a[252:255], v5 offset:15360
v_max3_f32 v32, v32, v198, v199
v_mfma_f32_16x16x32_bf16 v[228:231], a[204:207], a[240:243], v[228:231]
ds_read_b128 a[208:211], v4 offset:12288
v_max_f32 v33, v120, v121
v_mfma_f32_16x16x32_bf16 a[48:51], a[216:219], a[240:243], a[48:51]
v_max3_f32 v33, v33, v122, v123
v_max3_f32 v33, v33, v124, v125
v_mfma_f32_16x16x32_bf16 a[52:55], a[220:223], a[240:243], a[52:55]
s_waitcnt lgkmcnt(5)
v_max3_f32 v33, v33, v126, v127
v_max3_f32 v33, v33, v200, v201
v_mfma_f32_16x16x32_bf16 v[232:235], a[200:203], a[244:247], v[232:235]
ds_read_b128 a[240:243], v5 offset:16384
v_max3_f32 v33, v33, v202, v203
v_mfma_f32_16x16x32_bf16 v[236:239], a[204:207], a[244:247], v[236:239]
ds_read_b128 a[212:215], v4 offset:14336
v_max3_f32 v33, v33, v204, v205
v_mfma_f32_16x16x32_bf16 a[56:59], a[216:219], a[244:247], a[56:59]
v_max3_f32 v33, v33, v206, v207
v_permlane32_swap_b32 v24, v25
v_mfma_f32_16x16x32_bf16 a[60:63], a[220:223], a[244:247], a[60:63]
s_waitcnt lgkmcnt(5)
v_permlane32_swap_b32 v26, v27
v_permlane32_swap_b32 v28, v29
v_mfma_f32_16x16x32_bf16 v[240:243], a[200:203], a[248:251], v[240:243]
ds_read_b128 a[244:247], v5 offset:17408
v_permlane32_swap_b32 v30, v31
v_permlane32_swap_b32 v32, v33
v_mfma_f32_16x16x32_bf16 v[244:247], a[204:207], a[248:251], v[244:247]
v_max_f32 v24, v24, v25
v_max_f32 v26, v26, v27
v_mfma_f32_16x16x32_bf16 a[64:67], a[216:219], a[248:251], a[64:67]
v_max_f32 v28, v28, v29
v_max_f32 v30, v30, v31
v_mfma_f32_16x16x32_bf16 a[68:71], a[220:223], a[248:251], a[68:71]
s_waitcnt lgkmcnt(4)
v_max_f32 v32, v32, v33
v_permlane16_swap_b32 v24, v26
v_mfma_f32_16x16x32_bf16 v[248:251], a[200:203], a[252:255], v[248:251]
ds_read_b128 a[248:251], v5 offset:18432
v_permlane16_swap_b32 v28, v30
v_mfma_f32_16x16x32_bf16 v[252:255], a[204:207], a[252:255], v[252:255]
v_permlane16_swap_b32 v32, v34
v_max_f32 v24, v24, v26
v_mfma_f32_16x16x32_bf16 a[72:75], a[216:219], a[252:255], a[72:75]
v_max_f32 v28, v28, v30
v_max_f32 v32, v32, v34
v_mfma_f32_16x16x32_bf16 a[76:79], a[220:223], a[252:255], a[76:79]
s_waitcnt lgkmcnt(3)
ds_max_f32 v20, v24
v_mfma_f32_16x16x32_bf16 a[0:3], a[200:203], a[240:243], a[0:3]
ds_read_b128 a[252:255], v5 offset:19456
v_mfma_f32_16x16x32_bf16 a[4:7], a[204:207], a[240:243], a[4:7]
ds_max_f32 v20, v28 offset:16
v_mfma_f32_16x16x32_bf16 a[80:83], a[216:219], a[240:243], a[80:83]
ds_max_f32 v20, v32 offset:32
v_mfma_f32_16x16x32_bf16 a[84:87], a[220:223], a[240:243], a[84:87]
s_waitcnt lgkmcnt(5)
ds_max_f32 v20, v24 offset:1024
v_mfma_f32_16x16x32_bf16 a[8:11], a[200:203], a[244:247], a[8:11]
ds_read_b128 a[240:243], v6
v_mfma_f32_16x16x32_bf16 a[12:15], a[204:207], a[244:247], a[12:15]
ds_max_f32 v20, v28 offset:1040
ds_max_f32 v20, v32 offset:1056
v_mfma_f32_16x16x32_bf16 a[88:91], a[216:219], a[244:247], a[88:91]
s_waitcnt lgkmcnt(0)
s_barrier
v_mfma_f32_16x16x32_bf16 a[92:95], a[220:223], a[244:247], a[92:95]
ds_read_b128 v[24:27], v21
v_mfma_f32_16x16x32_bf16 a[16:19], a[200:203], a[248:251], a[16:19]
ds_read_b128 a[244:247], v6 offset:1024
v_mfma_f32_16x16x32_bf16 a[20:23], a[204:207], a[248:251], a[20:23]
ds_read_b128 v[28:31], v21 offset:16
v_mfma_f32_16x16x32_bf16 a[96:99], a[216:219], a[248:251], a[96:99]
ds_read_b128 v[32:35], v21 offset:32
s_waitcnt lgkmcnt(3)
v_mul_f32 v24, s28, -v24
v_mul_f32 v25, s28, -v25
v_mul_f32 v26, s28, -v26
v_mul_f32 v27, s28, -v27
s_waitcnt lgkmcnt(1)
v_mul_f32 v28, s28, -v28
v_mul_f32 v29, s28, -v29
v_mul_f32 v30, s28, -v30
v_mul_f32 v31, s28, -v31
s_waitcnt lgkmcnt(0)
v_mul_f32 v32, s28, -v32
v_mul_f32 v33, s28, -v33
v_mfma_f32_16x16x32_bf16 a[100:103], a[220:223], a[248:251], a[100:103]
v_fma_f32 v48, v48, s28, v24
v_fma_f32 v49, v49, s28, v24
v_fma_f32 v50, v50, s28, v24
v_mfma_f32_16x16x32_bf16 a[24:27], a[200:203], a[252:255], a[24:27]
ds_read_b128 a[248:251], v6 offset:2048
v_fma_f32 v51, v51, s28, v24
v_fma_f32 v52, v52, s28, v24
v_fma_f32 v53, v53, s28, v24
v_mfma_f32_16x16x32_bf16 a[28:31], a[204:207], a[252:255], a[28:31]
s_add_u32 m0, s33, 0x3000
s_add_u32 s35, s43, 0x30000
v_fma_f32 v54, v54, s28, v24
v_fma_f32 v55, v55, s28, v24
v_mfma_f32_16x16x32_bf16 a[104:107], a[216:219], a[252:255], a[104:107]
v_exp_f32 v48, v48
v_exp_f32 v49, v49
v_mfma_f32_16x16x32_bf16 a[108:111], a[220:223], a[252:255], a[108:111]
buffer_load_dwordx4 v12, s[12:15], s35 offen nt lds
v_exp_f32 v50, v50
v_mfma_f32_16x16x32_bf16 v[208:211], a[224:227], a[240:243], v[208:211]
ds_read_b128 a[252:255], v6 offset:3072
v_exp_f32 v51, v51
v_mfma_f32_16x16x32_bf16 v[212:215], a[228:231], a[240:243], v[212:215]
s_waitcnt vmcnt(9)
ds_read_b128 a[200:203], v3
v_exp_f32 v52, v52
v_mfma_f32_16x16x32_bf16 a[32:35], a[192:195], a[240:243], a[32:35]
buffer_load_dwordx4 v13, s[12:15], s35 offen offset:1024 nt lds
v_exp_f32 v53, v53
v_mfma_f32_16x16x32_bf16 a[36:39], a[196:199], a[240:243], a[36:39]
v_exp_f32 v54, v54
v_exp_f32 v55, v55
v_add_f32 v36, v48, v49
v_mfma_f32_16x16x32_bf16 v[216:219], a[224:227], a[244:247], v[216:219]
ds_read_b128 a[240:243], v6 offset:4096
v_add_f32 v36, v36, v50
v_add_f32 v36, v36, v51
v_mfma_f32_16x16x32_bf16 v[220:223], a[228:231], a[244:247], v[220:223]
ds_read_b128 a[204:207], v3 offset:2048
v_add_f32 v36, v36, v52
v_add_f32 v36, v36, v53
v_add_f32 v36, v36, v54
v_mfma_f32_16x16x32_bf16 a[40:43], a[192:195], a[244:247], a[40:43]
buffer_load_dwordx4 v14, s[12:15], s35 offen offset:2048 nt lds
v_add_f32 v36, v36, v55
v_cvt_pk_bf16_f32 v48, v48, v49
v_mfma_f32_16x16x32_bf16 a[44:47], a[196:199], a[244:247], a[44:47]
s_waitcnt lgkmcnt(4)
v_cvt_pk_bf16_f32 v49, v50, v51
v_cvt_pk_bf16_f32 v50, v52, v53
v_cvt_pk_bf16_f32 v51, v54, v55
v_fma_f32 v56, v56, s28, v25
v_mfma_f32_16x16x32_bf16 v[224:227], a[224:227], a[248:251], v[224:227]
ds_read_b128 a[244:247], v6 offset:5120
v_fma_f32 v57, v57, s28, v25
v_fma_f32 v58, v58, s28, v25
v_mfma_f32_16x16x32_bf16 v[228:231], a[228:231], a[248:251], v[228:231]
ds_read_b128 a[216:219], v4
v_fma_f32 v59, v59, s28, v25
v_fma_f32 v60, v60, s28, v25
v_mfma_f32_16x16x32_bf16 a[48:51], a[192:195], a[248:251], a[48:51]
buffer_load_dwordx4 v15, s[12:15], s35 offen offset:3072 nt lds
v_fma_f32 v61, v61, s28, v25
v_fma_f32 v62, v62, s28, v25
v_fma_f32 v63, v63, s28, v25
v_mfma_f32_16x16x32_bf16 a[52:55], a[196:199], a[248:251], a[52:55]
s_waitcnt lgkmcnt(5)
v_exp_f32 v56, v56
v_mfma_f32_16x16x32_bf16 v[232:235], a[224:227], a[252:255], v[232:235]
ds_read_b128 a[248:251], v6 offset:6144
v_exp_f32 v57, v57
v_exp_f32 v58, v58
v_mfma_f32_16x16x32_bf16 v[236:239], a[228:231], a[252:255], v[236:239]
ds_read_b128 a[220:223], v4 offset:2048
v_exp_f32 v59, v59
v_mfma_f32_16x16x32_bf16 a[56:59], a[192:195], a[252:255], a[56:59]
v_exp_f32 v60, v60
v_exp_f32 v61, v61
v_mfma_f32_16x16x32_bf16 a[60:63], a[196:199], a[252:255], a[60:63]
s_waitcnt lgkmcnt(5)
v_exp_f32 v62, v62
v_mfma_f32_16x16x32_bf16 v[240:243], a[224:227], a[240:243], v[240:243]
ds_read_b128 a[252:255], v6 offset:7168
v_exp_f32 v63, v63
v_add_f32 v37, v56, v57
v_add_f32 v37, v37, v58
v_mfma_f32_16x16x32_bf16 v[244:247], a[228:231], a[240:243], v[244:247]
v_add_f32 v37, v37, v59
v_add_f32 v37, v37, v60
v_add_f32 v37, v37, v61
v_mfma_f32_16x16x32_bf16 a[64:67], a[192:195], a[240:243], a[64:67]
v_add_f32 v37, v37, v62
v_add_f32 v37, v37, v63
v_cvt_pk_bf16_f32 v56, v56, v57
v_mfma_f32_16x16x32_bf16 a[68:71], a[196:199], a[240:243], a[68:71]
s_waitcnt lgkmcnt(4)
v_cvt_pk_bf16_f32 v57, v58, v59
v_cvt_pk_bf16_f32 v58, v60, v61
v_cvt_pk_bf16_f32 v59, v62, v63
v_fma_f32 v64, v64, s28, v26
v_mfma_f32_16x16x32_bf16 v[248:251], a[224:227], a[244:247], v[248:251]
ds_read_b128 a[240:243], v6 offset:8192
v_fma_f32 v65, v65, s28, v26
v_fma_f32 v66, v66, s28, v26
v_mfma_f32_16x16x32_bf16 v[252:255], a[228:231], a[244:247], v[252:255]
v_fma_f32 v67, v67, s28, v26
v_fma_f32 v68, v68, s28, v26
v_fma_f32 v69, v69, s28, v26
v_fma_f32 v70, v70, s28, v26
v_mfma_f32_16x16x32_bf16 a[72:75], a[192:195], a[244:247], a[72:75]
v_fma_f32 v71, v71, s28, v26
v_exp_f32 v64, v64
v_mfma_f32_16x16x32_bf16 a[76:79], a[196:199], a[244:247], a[76:79]
s_waitcnt lgkmcnt(3)
v_exp_f32 v65, v65
v_exp_f32 v66, v66
v_mfma_f32_16x16x32_bf16 a[0:3], a[224:227], a[248:251], a[0:3]
ds_read_b128 a[244:247], v6 offset:9216
v_exp_f32 v67, v67
v_mfma_f32_16x16x32_bf16 a[4:7], a[228:231], a[248:251], a[4:7]
v_exp_f32 v68, v68
v_mfma_f32_16x16x32_bf16 a[80:83], a[192:195], a[248:251], a[80:83]
v_exp_f32 v69, v69
v_exp_f32 v70, v70
v_mfma_f32_16x16x32_bf16 a[84:87], a[196:199], a[248:251], a[84:87]
s_waitcnt lgkmcnt(2)
v_exp_f32 v71, v71
v_add_f32 v38, v64, v65
v_add_f32 v38, v38, v66
v_mfma_f32_16x16x32_bf16 a[8:11], a[224:227], a[252:255], a[8:11]
ds_read_b128 a[248:251], v6 offset:10240
v_add_f32 v38, v38, v67
v_add_f32 v38, v38, v68
v_add_f32 v38, v38, v69
v_mfma_f32_16x16x32_bf16 a[12:15], a[228:231], a[252:255], a[12:15]
v_add_f32 v38, v38, v70
v_add_f32 v38, v38, v71
v_cvt_pk_bf16_f32 v64, v64, v65
v_mfma_f32_16x16x32_bf16 a[88:91], a[192:195], a[252:255], a[88:91]
v_cvt_pk_bf16_f32 v65, v66, v67
v_cvt_pk_bf16_f32 v66, v68, v69
v_cvt_pk_bf16_f32 v67, v70, v71
v_fma_f32 v72, v72, s28, v27
v_mfma_f32_16x16x32_bf16 a[92:95], a[196:199], a[252:255], a[92:95]
s_waitcnt lgkmcnt(2)
v_fma_f32 v73, v73, s28, v27
v_fma_f32 v74, v74, s28, v27
v_fma_f32 v75, v75, s28, v27
v_mfma_f32_16x16x32_bf16 a[16:19], a[224:227], a[240:243], a[16:19]
ds_read_b128 a[252:255], v6 offset:11264
v_fma_f32 v76, v76, s28, v27
v_fma_f32 v77, v77, s28, v27
v_mfma_f32_16x16x32_bf16 a[20:23], a[228:231], a[240:243], a[20:23]
v_fma_f32 v78, v78, s28, v27
v_fma_f32 v79, v79, s28, v27
v_exp_f32 v72, v72
v_mfma_f32_16x16x32_bf16 a[96:99], a[192:195], a[240:243], a[96:99]
v_exp_f32 v73, v73
v_mfma_f32_16x16x32_bf16 a[100:103], a[196:199], a[240:243], a[100:103]
s_waitcnt lgkmcnt(2)
v_mov_b32 v12, v17
v_exp_f32 v74, v74
v_exp_f32 v75, v75
v_mfma_f32_16x16x32_bf16 a[24:27], a[224:227], a[244:247], a[24:27]
ds_read_b128 a[240:243], v6 offset:12288
v_add_u32 v13, 0xc00, v17
v_mfma_f32_16x16x32_bf16 a[28:31], a[228:231], a[244:247], a[28:31]
v_add_u32 v14, 0x1800, v17
v_exp_f32 v76, v76
v_exp_f32 v77, v77
v_mfma_f32_16x16x32_bf16 a[104:107], a[192:195], a[244:247], a[104:107]
v_add_u32 v15, 0x2400, v17
v_exp_f32 v78, v78
v_mfma_f32_16x16x32_bf16 a[108:111], a[196:199], a[244:247], a[108:111]
s_waitcnt lgkmcnt(2)
v_exp_f32 v79, v79
v_add_f32 v39, v72, v73
v_add_f32 v39, v39, v74
v_mfma_f32_16x16x32_bf16 v[208:211], a[232:235], a[248:251], v[208:211]
ds_read_b128 a[244:247], v6 offset:13312
v_add_f32 v39, v39, v75
v_add_f32 v39, v39, v76
v_mfma_f32_16x16x32_bf16 v[212:215], a[236:239], a[248:251], v[212:215]
s_add_u32 m0, s33, 0
s_add_u32 s35, s48, 0
s_waitcnt vmcnt(8)
ds_read_b128 a[224:227], v3 offset:4096
v_add_f32 v39, v39, v77
v_mfma_f32_16x16x32_bf16 a[32:35], a[208:211], a[248:251], a[32:35]
v_add_f32 v39, v39, v78
v_add_f32 v39, v39, v79
v_cvt_pk_bf16_f32 v72, v72, v73
v_mfma_f32_16x16x32_bf16 a[36:39], a[212:215], a[248:251], a[36:39]
s_waitcnt lgkmcnt(3)
buffer_load_dwordx4 v12, s[16:19], s35 offen nt lds
v_cvt_pk_bf16_f32 v73, v74, v75
v_cvt_pk_bf16_f32 v74, v76, v77
v_mfma_f32_16x16x32_bf16 v[216:219], a[232:235], a[252:255], v[216:219]
ds_read_b128 a[248:251], v6 offset:14336
v_cvt_pk_bf16_f32 v75, v78, v79
v_fma_f32 v80, v80, s28, v28
v_fma_f32 v81, v81, s28, v28
v_mfma_f32_16x16x32_bf16 v[220:223], a[236:239], a[252:255], v[220:223]
ds_read_b128 a[228:231], v3 offset:6144
v_fma_f32 v82, v82, s28, v28
v_fma_f32 v83, v83, s28, v28
v_mfma_f32_16x16x32_bf16 a[40:43], a[208:211], a[252:255], a[40:43]
buffer_load_dwordx4 v13, s[16:19], s35 offen offset:1024 nt lds
v_fma_f32 v84, v84, s28, v28
v_fma_f32 v85, v85, s28, v28
v_fma_f32 v86, v86, s28, v28
v_mfma_f32_16x16x32_bf16 a[44:47], a[212:215], a[252:255], a[44:47]
s_waitcnt lgkmcnt(4)
v_fma_f32 v87, v87, s28, v28
v_exp_f32 v80, v80
v_mfma_f32_16x16x32_bf16 v[224:227], a[232:235], a[240:243], v[224:227]
ds_read_b128 a[252:255], v6 offset:15360
v_exp_f32 v81, v81
v_mfma_f32_16x16x32_bf16 v[228:231], a[236:239], a[240:243], v[228:231]
ds_read_b128 a[192:195], v4 offset:4096
v_exp_f32 v82, v82
v_mfma_f32_16x16x32_bf16 a[48:51], a[208:211], a[240:243], a[48:51]
buffer_load_dwordx4 v14, s[16:19], s35 offen offset:2048 nt lds
v_exp_f32 v83, v83
v_exp_f32 v84, v84
v_mfma_f32_16x16x32_bf16 a[52:55], a[212:215], a[240:243], a[52:55]
s_waitcnt lgkmcnt(5)
v_exp_f32 v85, v85
v_mfma_f32_16x16x32_bf16 v[232:235], a[232:235], a[244:247], v[232:235]
ds_read_b128 a[240:243], v6 offset:16384
v_exp_f32 v86, v86
v_mfma_f32_16x16x32_bf16 v[236:239], a[236:239], a[244:247], v[236:239]
ds_read_b128 a[196:199], v4 offset:6144
v_exp_f32 v87, v87
v_add_f32 v40, v80, v81
v_add_f32 v40, v40, v82
v_mfma_f32_16x16x32_bf16 a[56:59], a[208:211], a[244:247], a[56:59]
buffer_load_dwordx4 v15, s[16:19], s35 offen offset:3072 nt lds
v_add_f32 v40, v40, v83
v_add_f32 v40, v40, v84
v_mfma_f32_16x16x32_bf16 a[60:63], a[212:215], a[244:247], a[60:63]
s_waitcnt lgkmcnt(5)
v_add_f32 v40, v40, v85
v_add_f32 v40, v40, v86
v_add_f32 v40, v40, v87
v_cvt_pk_bf16_f32 v80, v80, v81
v_mfma_f32_16x16x32_bf16 v[240:243], a[232:235], a[248:251], v[240:243]
ds_read_b128 a[244:247], v6 offset:17408
v_cvt_pk_bf16_f32 v81, v82, v83
v_cvt_pk_bf16_f32 v82, v84, v85
v_mfma_f32_16x16x32_bf16 v[244:247], a[236:239], a[248:251], v[244:247]
v_cvt_pk_bf16_f32 v83, v86, v87
v_fma_f32 v88, v88, s28, v29
v_fma_f32 v89, v89, s28, v29
v_fma_f32 v90, v90, s28, v29
v_mfma_f32_16x16x32_bf16 a[64:67], a[208:211], a[248:251], a[64:67]
v_fma_f32 v91, v91, s28, v29
v_fma_f32 v92, v92, s28, v29
v_fma_f32 v93, v93, s28, v29
v_mfma_f32_16x16x32_bf16 a[68:71], a[212:215], a[248:251], a[68:71]
s_waitcnt lgkmcnt(4)
v_fma_f32 v94, v94, s28, v29
v_fma_f32 v95, v95, s28, v29
v_exp_f32 v88, v88
v_mfma_f32_16x16x32_bf16 v[248:251], a[232:235], a[252:255], v[248:251]
ds_read_b128 a[248:251], v6 offset:18432
v_exp_f32 v89, v89
v_mfma_f32_16x16x32_bf16 v[252:255], a[236:239], a[252:255], v[252:255]
v_exp_f32 v90, v90
v_mfma_f32_16x16x32_bf16 a[72:75], a[208:211], a[252:255], a[72:75]
v_exp_f32 v91, v91
v_exp_f32 v92, v92
v_mfma_f32_16x16x32_bf16 a[76:79], a[212:215], a[252:255], a[76:79]
s_waitcnt lgkmcnt(3)
v_exp_f32 v93, v93
v_exp_f32 v94, v94
v_mfma_f32_16x16x32_bf16 a[0:3], a[232:235], a[240:243], a[0:3]
ds_read_b128 a[252:255], v6 offset:19456
v_exp_f32 v95, v95
v_add_f32 v41, v88, v89
v_mfma_f32_16x16x32_bf16 a[4:7], a[236:239], a[240:243], a[4:7]
v_add_f32 v41, v41, v90
v_add_f32 v41, v41, v91
v_add_f32 v41, v41, v92
v_mfma_f32_16x16x32_bf16 a[80:83], a[208:211], a[240:243], a[80:83]
v_add_f32 v41, v41, v93
v_add_f32 v41, v41, v94
v_add_f32 v41, v41, v95
v_cvt_pk_bf16_f32 v88, v88, v89
v_mfma_f32_16x16x32_bf16 a[84:87], a[212:215], a[240:243], a[84:87]
s_waitcnt lgkmcnt(2)
v_cvt_pk_bf16_f32 v89, v90, v91
v_cvt_pk_bf16_f32 v90, v92, v93
v_cvt_pk_bf16_f32 v91, v94, v95
v_mfma_f32_16x16x32_bf16 a[8:11], a[232:235], a[244:247], a[8:11]
s_waitcnt lgkmcnt(0)
s_barrier
ds_read_b128 a[240:243], v5 offset:40960
v_mfma_f32_16x16x32_bf16 a[12:15], a[236:239], a[244:247], a[12:15]
v_mfma_f32_16x16x32_bf16 a[88:91], a[208:211], a[244:247], a[88:91]
ds_write_b128 v7, v[48:51]
v_mfma_f32_16x16x32_bf16 a[92:95], a[212:215], a[244:247], a[92:95]
v_fma_f32 v96, v96, s28, v30
v_fma_f32 v97, v97, s28, v30
v_fma_f32 v98, v98, s28, v30
v_mfma_f32_16x16x32_bf16 a[16:19], a[232:235], a[248:251], a[16:19]
ds_read_b128 a[244:247], v5 offset:41984
v_fma_f32 v99, v99, s28, v30
v_fma_f32 v100, v100, s28, v30
v_fma_f32 v101, v101, s28, v30
v_mfma_f32_16x16x32_bf16 a[20:23], a[236:239], a[248:251], a[20:23]
v_fma_f32 v102, v102, s28, v30
v_fma_f32 v103, v103, s28, v30
v_exp_f32 v96, v96
v_mfma_f32_16x16x32_bf16 a[96:99], a[208:211], a[248:251], a[96:99]
v_exp_f32 v97, v97
v_exp_f32 v98, v98
v_mfma_f32_16x16x32_bf16 a[100:103], a[212:215], a[248:251], a[100:103]
v_exp_f32 v99, v99
v_exp_f32 v100, v100
v_mfma_f32_16x16x32_bf16 a[24:27], a[232:235], a[252:255], a[24:27]
ds_read_b128 a[248:251], v5 offset:43008
v_exp_f32 v101, v101
v_mfma_f32_16x16x32_bf16 a[28:31], a[236:239], a[252:255], a[28:31]
v_exp_f32 v102, v102
v_exp_f32 v103, v103
v_add_f32 v42, v96, v97
v_mfma_f32_16x16x32_bf16 a[104:107], a[208:211], a[252:255], a[104:107]
v_add_f32 v42, v42, v98
v_add_f32 v42, v42, v99
v_add_f32 v42, v42, v100
v_add_f32 v42, v42, v101
v_mfma_f32_16x16x32_bf16 a[108:111], a[212:215], a[252:255], a[108:111]
s_waitcnt lgkmcnt(3)
v_add_f32 v42, v42, v102
v_add_f32 v42, v42, v103
v_cvt_pk_bf16_f32 v96, v96, v97
v_cvt_pk_bf16_f32 v97, v98, v99
v_mfma_f32_16x16x32_bf16 v[208:211], a[200:203], a[240:243], v[208:211]
ds_read_b128 a[252:255], v5 offset:44032
v_cvt_pk_bf16_f32 v98, v100, v101
v_cvt_pk_bf16_f32 v99, v102, v103
v_mfma_f32_16x16x32_bf16 v[212:215], a[204:207], a[240:243], v[212:215]
s_waitcnt vmcnt(8)
ds_read_b128 a[232:235], v3 offset:8192
v_mfma_f32_16x16x32_bf16 a[32:35], a[224:227], a[240:243], a[32:35]
ds_write_b128 v7, v[56:59] offset:1024
v_fma_f32 v104, v104, s28, v31
v_fma_f32 v105, v105, s28, v31
v_fma_f32 v106, v106, s28, v31
v_mfma_f32_16x16x32_bf16 a[36:39], a[228:231], a[240:243], a[36:39]
s_waitcnt lgkmcnt(4)
v_fma_f32 v107, v107, s28, v31
v_fma_f32 v108, v108, s28, v31
v_fma_f32 v109, v109, s28, v31
v_fma_f32 v110, v110, s28, v31
v_mfma_f32_16x16x32_bf16 v[216:219], a[200:203], a[244:247], v[216:219]
ds_read_b128 a[240:243], v5 offset:45056
v_fma_f32 v111, v111, s28, v31
v_exp_f32 v104, v104
v_mfma_f32_16x16x32_bf16 v[220:223], a[204:207], a[244:247], v[220:223]
s_add_u32 m0, s33, 0x1000
s_add_u32 s35, s48, 0x4000
ds_read_b128 a[236:239], v3 offset:10240
v_exp_f32 v105, v105
v_mfma_f32_16x16x32_bf16 a[40:43], a[224:227], a[244:247], a[40:43]
v_exp_f32 v106, v106
v_exp_f32 v107, v107
v_mfma_f32_16x16x32_bf16 a[44:47], a[228:231], a[244:247], a[44:47]
s_waitcnt lgkmcnt(5)
buffer_load_dwordx4 v12, s[16:19], s35 offen nt lds
v_exp_f32 v108, v108
v_mfma_f32_16x16x32_bf16 v[224:227], a[200:203], a[248:251], v[224:227]
ds_read_b128 a[244:247], v5 offset:46080
v_exp_f32 v109, v109
v_exp_f32 v110, v110
v_mfma_f32_16x16x32_bf16 v[228:231], a[204:207], a[248:251], v[228:231]
ds_read_b128 a[208:211], v4 offset:8192
v_exp_f32 v111, v111
v_mfma_f32_16x16x32_bf16 a[48:51], a[224:227], a[248:251], a[48:51]
buffer_load_dwordx4 v13, s[16:19], s35 offen offset:1024 nt lds
v_add_f32 v43, v104, v105
v_add_f32 v43, v43, v106
v_add_f32 v43, v43, v107
v_mfma_f32_16x16x32_bf16 a[52:55], a[228:231], a[248:251], a[52:55]
s_waitcnt lgkmcnt(6)
v_add_f32 v43, v43, v108
v_add_f32 v43, v43, v109
v_add_f32 v43, v43, v110
v_add_f32 v43, v43, v111
v_mfma_f32_16x16x32_bf16 v[232:235], a[200:203], a[252:255], v[232:235]
ds_read_b128 a[248:251], v5 offset:47104
v_cvt_pk_bf16_f32 v104, v104, v105
v_cvt_pk_bf16_f32 v105, v106, v107
v_cvt_pk_bf16_f32 v106, v108, v109
v_mfma_f32_16x16x32_bf16 v[236:239], a[204:207], a[252:255], v[236:239]
ds_read_b128 a[212:215], v4 offset:10240
v_cvt_pk_bf16_f32 v107, v110, v111
v_mfma_f32_16x16x32_bf16 a[56:59], a[224:227], a[252:255], a[56:59]
buffer_load_dwordx4 v14, s[16:19], s35 offen offset:2048 nt lds
v_mfma_f32_16x16x32_bf16 a[60:63], a[228:231], a[252:255], a[60:63]
s_waitcnt lgkmcnt(5)
ds_write_b128 v7, v[64:67] offset:2048
v_fma_f32 v112, v112, s28, v32
v_fma_f32 v113, v113, s28, v32
v_fma_f32 v114, v114, s28, v32
v_fma_f32 v115, v115, s28, v32
v_mfma_f32_16x16x32_bf16 v[240:243], a[200:203], a[240:243], v[240:243]
ds_read_b128 a[252:255], v5 offset:48128
v_fma_f32 v116, v116, s28, v32
v_fma_f32 v117, v117, s28, v32
v_fma_f32 v118, v118, s28, v32
v_mfma_f32_16x16x32_bf16 v[244:247], a[204:207], a[240:243], v[244:247]
v_fma_f32 v119, v119, s28, v32
v_exp_f32 v112, v112
v_mfma_f32_16x16x32_bf16 a[64:67], a[224:227], a[240:243], a[64:67]
buffer_load_dwordx4 v15, s[16:19], s35 offen offset:3072 nt lds
v_exp_f32 v113, v113
v_exp_f32 v114, v114
v_mfma_f32_16x16x32_bf16 a[68:71], a[228:231], a[240:243], a[68:71]
s_waitcnt lgkmcnt(5)
v_exp_f32 v115, v115
v_exp_f32 v116, v116
v_mfma_f32_16x16x32_bf16 v[248:251], a[200:203], a[244:247], v[248:251]
ds_read_b128 a[240:243], v5 offset:49152
v_exp_f32 v117, v117
v_mfma_f32_16x16x32_bf16 v[252:255], a[204:207], a[244:247], v[252:255]
v_exp_f32 v118, v118
v_exp_f32 v119, v119
v_add_f32 v44, v112, v113
v_mfma_f32_16x16x32_bf16 a[72:75], a[224:227], a[244:247], a[72:75]
v_add_f32 v44, v44, v114
v_add_f32 v44, v44, v115
v_add_f32 v44, v44, v116
v_add_f32 v44, v44, v117
v_mfma_f32_16x16x32_bf16 a[76:79], a[228:231], a[244:247], a[76:79]
s_waitcnt lgkmcnt(4)
v_add_f32 v44, v44, v118
v_add_f32 v44, v44, v119
v_cvt_pk_bf16_f32 v112, v112, v113
v_cvt_pk_bf16_f32 v113, v114, v115
v_mfma_f32_16x16x32_bf16 a[0:3], a[200:203], a[248:251], a[0:3]
ds_read_b128 a[244:247], v5 offset:50176
v_cvt_pk_bf16_f32 v114, v116, v117
v_cvt_pk_bf16_f32 v115, v118, v119
v_mfma_f32_16x16x32_bf16 a[4:7], a[204:207], a[248:251], a[4:7]
ds_write_b128 v7, v[72:75] offset:3072
v_mfma_f32_16x16x32_bf16 a[80:83], a[224:227], a[248:251], a[80:83]
v_fma_f32 v120, v120, s28, v33
v_fma_f32 v121, v121, s28, v33
v_fma_f32 v122, v122, s28, v33
v_fma_f32 v123, v123, s28, v33
v_mfma_f32_16x16x32_bf16 a[84:87], a[228:231], a[248:251], a[84:87]
s_waitcnt lgkmcnt(3)
v_fma_f32 v124, v124, s28, v33
v_fma_f32 v125, v125, s28, v33
v_fma_f32 v126, v126, s28, v33
v_fma_f32 v127, v127, s28, v33
v_mfma_f32_16x16x32_bf16 a[8:11], a[200:203], a[252:255], a[8:11]
ds_read_b128 a[248:251], v5 offset:51200
v_exp_f32 v120, v120
v_mfma_f32_16x16x32_bf16 a[12:15], a[204:207], a[252:255], a[12:15]
v_exp_f32 v121, v121
v_exp_f32 v122, v122
v_mfma_f32_16x16x32_bf16 a[88:91], a[224:227], a[252:255], a[88:91]
v_exp_f32 v123, v123
v_exp_f32 v124, v124
v_mfma_f32_16x16x32_bf16 a[92:95], a[228:231], a[252:255], a[92:95]
s_waitcnt lgkmcnt(3)
v_exp_f32 v125, v125
v_exp_f32 v126, v126
v_mfma_f32_16x16x32_bf16 a[16:19], a[200:203], a[240:243], a[16:19]
ds_read_b128 a[252:255], v5 offset:52224
v_exp_f32 v127, v127
v_add_f32 v45, v120, v121
v_add_f32 v45, v45, v122
v_mfma_f32_16x16x32_bf16 a[20:23], a[204:207], a[240:243], a[20:23]
v_add_f32 v45, v45, v123
v_add_f32 v45, v45, v124
v_add_f32 v45, v45, v125
v_add_f32 v45, v45, v126
v_mfma_f32_16x16x32_bf16 a[96:99], a[224:227], a[240:243], a[96:99]
v_add_f32 v45, v45, v127
v_cvt_pk_bf16_f32 v120, v120, v121
v_cvt_pk_bf16_f32 v121, v122, v123
v_cvt_pk_bf16_f32 v122, v124, v125
v_mfma_f32_16x16x32_bf16 a[100:103], a[228:231], a[240:243], a[100:103]
s_waitcnt lgkmcnt(3)
v_cvt_pk_bf16_f32 v123, v126, v127
v_mfma_f32_16x16x32_bf16 a[24:27], a[200:203], a[244:247], a[24:27]
ds_read_b128 a[240:243], v5 offset:53248
v_mfma_f32_16x16x32_bf16 a[28:31], a[204:207], a[244:247], a[28:31]
ds_write_b128 v7, v[80:83] offset:4096
v_fma_f32 v128, v128, s28, v24
v_fma_f32 v129, v129, s28, v24
v_fma_f32 v130, v130, s28, v24
v_fma_f32 v131, v131, s28, v24
v_fma_f32 v132, v132, s28, v24
v_mfma_f32_16x16x32_bf16 a[104:107], a[224:227], a[244:247], a[104:107]
v_fma_f32 v133, v133, s28, v24
v_fma_f32 v134, v134, s28, v24
v_fma_f32 v135, v135, s28, v24
v_mfma_f32_16x16x32_bf16 a[108:111], a[228:231], a[244:247], a[108:111]
s_waitcnt lgkmcnt(3)
v_exp_f32 v128, v128
v_exp_f32 v129, v129
v_mfma_f32_16x16x32_bf16 v[208:211], a[216:219], a[248:251], v[208:211]
ds_read_b128 a[244:247], v5 offset:54272
v_exp_f32 v130, v130
v_exp_f32 v131, v131
v_mfma_f32_16x16x32_bf16 v[212:215], a[220:223], a[248:251], v[212:215]
s_waitcnt vmcnt(8)
ds_read_b128 a[200:203], v3 offset:12288
v_exp_f32 v132, v132
v_mfma_f32_16x16x32_bf16 a[32:35], a[192:195], a[248:251], a[32:35]
v_exp_f32 v133, v133
v_exp_f32 v134, v134
v_mfma_f32_16x16x32_bf16 a[36:39], a[196:199], a[248:251], a[36:39]
s_waitcnt lgkmcnt(4)
v_exp_f32 v135, v135
v_add_f32 v36, v36, v128
v_add_f32 v36, v36, v129
v_add_f32 v36, v36, v130
v_mfma_f32_16x16x32_bf16 v[216:219], a[216:219], a[252:255], v[216:219]
ds_read_b128 a[248:251], v5 offset:55296
v_add_f32 v36, v36, v131
v_add_f32 v36, v36, v132
v_add_f32 v36, v36, v133
v_mfma_f32_16x16x32_bf16 v[220:223], a[220:223], a[252:255], v[220:223]
ds_read_b128 a[204:207], v3 offset:14336
v_add_f32 v36, v36, v134
v_add_f32 v36, v36, v135
v_cvt_pk_bf16_f32 v128, v128, v129
v_mfma_f32_16x16x32_bf16 a[40:43], a[192:195], a[252:255], a[40:43]
v_cvt_pk_bf16_f32 v129, v130, v131
v_cvt_pk_bf16_f32 v130, v132, v133
v_cvt_pk_bf16_f32 v131, v134, v135
v_mfma_f32_16x16x32_bf16 a[44:47], a[196:199], a[252:255], a[44:47]
s_waitcnt lgkmcnt(5)
ds_write_b128 v7, v[88:91] offset:5120
v_mfma_f32_16x16x32_bf16 v[224:227], a[216:219], a[240:243], v[224:227]
ds_read_b128 a[252:255], v5 offset:56320
v_fma_f32 v136, v136, s28, v25
v_fma_f32 v137, v137, s28, v25
v_mfma_f32_16x16x32_bf16 v[228:231], a[220:223], a[240:243], v[228:231]
s_add_u32 m0, s33, 0x2000
s_add_u32 s35, s48, 0x8000
ds_read_b128 a[224:227], v4 offset:12288
v_fma_f32 v138, v138, s28, v25
v_fma_f32 v139, v139, s28, v25
v_mfma_f32_16x16x32_bf16 a[48:51], a[192:195], a[240:243], a[48:51]
v_fma_f32 v140, v140, s28, v25
v_fma_f32 v141, v141, s28, v25
v_fma_f32 v142, v142, s28, v25
v_fma_f32 v143, v143, s28, v25
v_mfma_f32_16x16x32_bf16 a[52:55], a[196:199], a[240:243], a[52:55]
s_waitcnt lgkmcnt(6)
buffer_load_dwordx4 v12, s[16:19], s35 offen nt lds
v_exp_f32 v136, v136
v_mfma_f32_16x16x32_bf16 v[232:235], a[216:219], a[244:247], v[232:235]
ds_read_b128 a[240:243], v5 offset:57344
v_exp_f32 v137, v137
v_exp_f32 v138, v138
v_mfma_f32_16x16x32_bf16 v[236:239], a[220:223], a[244:247], v[236:239]
ds_read_b128 a[228:231], v4 offset:14336
v_exp_f32 v139, v139
v_mfma_f32_16x16x32_bf16 a[56:59], a[192:195], a[244:247], a[56:59]
buffer_load_dwordx4 v13, s[16:19], s35 offen offset:1024 nt lds
v_exp_f32 v140, v140
v_exp_f32 v141, v141
v_mfma_f32_16x16x32_bf16 a[60:63], a[196:199], a[244:247], a[60:63]
s_waitcnt lgkmcnt(6)
v_exp_f32 v142, v142
v_exp_f32 v143, v143
v_mfma_f32_16x16x32_bf16 v[240:243], a[216:219], a[248:251], v[240:243]
ds_read_b128 a[244:247], v5 offset:58368
v_add_f32 v37, v37, v136
v_add_f32 v37, v37, v137
v_add_f32 v37, v37, v138
v_mfma_f32_16x16x32_bf16 v[244:247], a[220:223], a[248:251], v[244:247]
v_add_f32 v37, v37, v139
v_add_f32 v37, v37, v140
v_add_f32 v37, v37, v141
v_add_f32 v37, v37, v142
v_mfma_f32_16x16x32_bf16 a[64:67], a[192:195], a[248:251], a[64:67]
buffer_load_dwordx4 v14, s[16:19], s35 offen offset:2048 nt lds
v_add_f32 v37, v37, v143
v_cvt_pk_bf16_f32 v136, v136, v137
v_cvt_pk_bf16_f32 v137, v138, v139
v_mfma_f32_16x16x32_bf16 a[68:71], a[196:199], a[248:251], a[68:71]
s_waitcnt lgkmcnt(4)
v_cvt_pk_bf16_f32 v138, v140, v141
v_cvt_pk_bf16_f32 v139, v142, v143
v_mfma_f32_16x16x32_bf16 v[248:251], a[216:219], a[252:255], v[248:251]
ds_read_b128 a[248:251], v5 offset:59392
v_mfma_f32_16x16x32_bf16 v[252:255], a[220:223], a[252:255], v[252:255]
ds_write_b128 v7, v[96:99] offset:6144
v_fma_f32 v144, v144, s28, v26
v_fma_f32 v145, v145, s28, v26
v_fma_f32 v146, v146, s28, v26
v_fma_f32 v147, v147, s28, v26
v_mfma_f32_16x16x32_bf16 a[72:75], a[192:195], a[252:255], a[72:75]
buffer_load_dwordx4 v15, s[16:19], s35 offen offset:3072 nt lds
v_fma_f32 v148, v148, s28, v26
v_fma_f32 v149, v149, s28, v26
v_fma_f32 v150, v150, s28, v26
v_mfma_f32_16x16x32_bf16 a[76:79], a[196:199], a[252:255], a[76:79]
s_waitcnt lgkmcnt(4)
v_fma_f32 v151, v151, s28, v26
v_exp_f32 v144, v144
v_mfma_f32_16x16x32_bf16 a[0:3], a[216:219], a[240:243], a[0:3]
ds_read_b128 a[252:255], v5 offset:60416
v_exp_f32 v145, v145
v_exp_f32 v146, v146
v_mfma_f32_16x16x32_bf16 a[4:7], a[220:223], a[240:243], a[4:7]
v_exp_f32 v147, v147
v_exp_f32 v148, v148
v_mfma_f32_16x16x32_bf16 a[80:83], a[192:195], a[240:243], a[80:83]
v_exp_f32 v149, v149
v_exp_f32 v150, v150
v_mfma_f32_16x16x32_bf16 a[84:87], a[196:199], a[240:243], a[84:87]
s_waitcnt lgkmcnt(3)
v_exp_f32 v151, v151
v_add_f32 v38, v38, v144
v_add_f32 v38, v38, v145
v_mfma_f32_16x16x32_bf16 a[8:11], a[216:219], a[244:247], a[8:11]
ds_read_b128 a[240:243], v6 offset:40960
v_add_f32 v38, v38, v146
v_add_f32 v38, v38, v147
v_add_f32 v38, v38, v148
v_mfma_f32_16x16x32_bf16 a[12:15], a[220:223], a[244:247], a[12:15]
v_add_f32 v38, v38, v149
v_add_f32 v38, v38, v150
v_add_f32 v38, v38, v151
v_cvt_pk_bf16_f32 v144, v144, v145
v_mfma_f32_16x16x32_bf16 a[88:91], a[192:195], a[244:247], a[88:91]
v_cvt_pk_bf16_f32 v145, v146, v147
v_cvt_pk_bf16_f32 v146, v148, v149
v_cvt_pk_bf16_f32 v147, v150, v151
v_mfma_f32_16x16x32_bf16 a[92:95], a[196:199], a[244:247], a[92:95]
s_waitcnt lgkmcnt(3)
ds_write_b128 v7, v[104:107] offset:7168
v_mfma_f32_16x16x32_bf16 a[16:19], a[216:219], a[248:251], a[16:19]
ds_read_b128 a[244:247], v6 offset:41984
v_fma_f32 v152, v152, s28, v27
v_fma_f32 v153, v153, s28, v27
v_fma_f32 v154, v154, s28, v27
v_mfma_f32_16x16x32_bf16 a[20:23], a[220:223], a[248:251], a[20:23]
v_fma_f32 v155, v155, s28, v27
v_fma_f32 v156, v156, s28, v27
v_fma_f32 v157, v157, s28, v27
v_fma_f32 v158, v158, s28, v27
v_mfma_f32_16x16x32_bf16 a[96:99], a[192:195], a[248:251], a[96:99]
v_fma_f32 v159, v159, s28, v27
v_exp_f32 v152, v152
v_mfma_f32_16x16x32_bf16 a[100:103], a[196:199], a[248:251], a[100:103]
s_waitcnt lgkmcnt(3)
v_exp_f32 v153, v153
v_exp_f32 v154, v154
v_mfma_f32_16x16x32_bf16 a[24:27], a[216:219], a[252:255], a[24:27]
ds_read_b128 a[248:251], v6 offset:43008
v_exp_f32 v155, v155
v_exp_f32 v156, v156
v_mfma_f32_16x16x32_bf16 a[28:31], a[220:223], a[252:255], a[28:31]
v_exp_f32 v157, v157
v_exp_f32 v158, v158
v_mfma_f32_16x16x32_bf16 a[104:107], a[192:195], a[252:255], a[104:107]
v_exp_f32 v159, v159
v_add_f32 v39, v39, v152
v_add_f32 v39, v39, v153
v_mfma_f32_16x16x32_bf16 a[108:111], a[196:199], a[252:255], a[108:111]
s_waitcnt lgkmcnt(3)
v_add_f32 v39, v39, v154
v_add_f32 v39, v39, v155
v_add_f32 v39, v39, v156
v_add_f32 v39, v39, v157
v_mfma_f32_16x16x32_bf16 v[208:211], a[232:235], a[240:243], v[208:211]
ds_read_b128 a[252:255], v6 offset:44032
v_add_f32 v39, v39, v158
v_add_f32 v39, v39, v159
v_cvt_pk_bf16_f32 v152, v152, v153
v_mfma_f32_16x16x32_bf16 v[212:215], a[236:239], a[240:243], v[212:215]
v_cvt_pk_bf16_f32 v153, v154, v155
v_cvt_pk_bf16_f32 v154, v156, v157
v_cvt_pk_bf16_f32 v155, v158, v159
v_mfma_f32_16x16x32_bf16 a[32:35], a[200:203], a[240:243], a[32:35]
ds_write_b128 v7, v[112:115] offset:8192
v_mfma_f32_16x16x32_bf16 a[36:39], a[204:207], a[240:243], a[36:39]
s_waitcnt lgkmcnt(3)
v_fma_f32 v160, v160, s28, v28
v_fma_f32 v161, v161, s28, v28
v_fma_f32 v162, v162, s28, v28
v_fma_f32 v163, v163, s28, v28
v_mfma_f32_16x16x32_bf16 v[216:219], a[232:235], a[244:247], v[216:219]
ds_read_b128 a[240:243], v6 offset:45056
v_fma_f32 v164, v164, s28, v28
v_fma_f32 v165, v165, s28, v28
v_fma_f32 v166, v166, s28, v28
v_mfma_f32_16x16x32_bf16 v[220:223], a[236:239], a[244:247], v[220:223]
v_fma_f32 v167, v167, s28, v28
v_exp_f32 v160, v160
v_mfma_f32_16x16x32_bf16 a[40:43], a[200:203], a[244:247], a[40:43]
v_exp_f32 v161, v161
v_exp_f32 v162, v162
v_mfma_f32_16x16x32_bf16 a[44:47], a[204:207], a[244:247], a[44:47]
s_waitcnt lgkmcnt(3)
v_exp_f32 v163, v163
v_exp_f32 v164, v164
v_mfma_f32_16x16x32_bf16 v[224:227], a[232:235], a[248:251], v[224:227]
ds_read_b128 a[244:247], v6 offset:46080
v_exp_f32 v165, v165
v_mfma_f32_16x16x32_bf16 v[228:231], a[236:239], a[248:251], v[228:231]
v_exp_f32 v166, v166
v_exp_f32 v167, v167
v_add_f32 v40, v40, v160
v_mfma_f32_16x16x32_bf16 a[48:51], a[200:203], a[248:251], a[48:51]
v_add_f32 v40, v40, v161
v_add_f32 v40, v40, v162
v_add_f32 v40, v40, v163
v_add_f32 v40, v40, v164
v_mfma_f32_16x16x32_bf16 a[52:55], a[204:207], a[248:251], a[52:55]
s_waitcnt lgkmcnt(3)
v_add_f32 v40, v40, v165
v_add_f32 v40, v40, v166
v_add_f32 v40, v40, v167
v_cvt_pk_bf16_f32 v160, v160, v161
v_mfma_f32_16x16x32_bf16 v[232:235], a[232:235], a[252:255], v[232:235]
ds_read_b128 a[248:251], v6 offset:47104
v_cvt_pk_bf16_f32 v161, v162, v163
v_cvt_pk_bf16_f32 v162, v164, v165
v_cvt_pk_bf16_f32 v163, v166, v167
v_mfma_f32_16x16x32_bf16 v[236:239], a[236:239], a[252:255], v[236:239]
s_add_u32 m0, s33, 0x3000
s_add_u32 s35, s48, 0xc000
ds_write_b128 v7, v[120:123] offset:9216
v_mfma_f32_16x16x32_bf16 a[56:59], a[200:203], a[252:255], a[56:59]
v_fma_f32 v168, v168, s28, v29
v_fma_f32 v169, v169, s28, v29
v_mfma_f32_16x16x32_bf16 a[60:63], a[204:207], a[252:255], a[60:63]
s_waitcnt lgkmcnt(3)
buffer_load_dwordx4 v12, s[16:19], s35 offen nt lds
v_fma_f32 v170, v170, s28, v29
v_fma_f32 v171, v171, s28, v29
v_fma_f32 v172, v172, s28, v29
v_mfma_f32_16x16x32_bf16 v[240:243], a[232:235], a[240:243], v[240:243]
ds_read_b128 a[252:255], v6 offset:48128
v_fma_f32 v173, v173, s28, v29
v_fma_f32 v174, v174, s28, v29
v_fma_f32 v175, v175, s28, v29
v_mfma_f32_16x16x32_bf16 v[244:247], a[236:239], a[240:243], v[244:247]
s_waitcnt vmcnt(9)
ds_read_b64_tr_b16 a[216:217], v8
v_exp_f32 v168, v168
v_mfma_f32_16x16x32_bf16 a[64:67], a[200:203], a[240:243], a[64:67]
buffer_load_dwordx4 v13, s[16:19], s35 offen offset:1024 nt lds
ds_read_b64_tr_b16 a[218:219], v8 offset:2048
v_exp_f32 v169, v169
v_mfma_f32_16x16x32_bf16 a[68:71], a[204:207], a[240:243], a[68:71]
s_waitcnt lgkmcnt(5)
v_exp_f32 v170, v170
v_exp_f32 v171, v171
v_mfma_f32_16x16x32_bf16 v[248:251], a[232:235], a[244:247], v[248:251]
ds_read_b128 a[240:243], v6 offset:49152
v_exp_f32 v172, v172
v_exp_f32 v173, v173
v_mfma_f32_16x16x32_bf16 v[252:255], a[236:239], a[244:247], v[252:255]
ds_read_b64_tr_b16 a[220:221], v9
v_exp_f32 v174, v174
v_mfma_f32_16x16x32_bf16 a[72:75], a[200:203], a[244:247], a[72:75]
buffer_load_dwordx4 v14, s[16:19], s35 offen offset:2048 nt lds
ds_read_b64_tr_b16 a[222:223], v9 offset:2048
v_exp_f32 v175, v175
v_add_f32 v41, v41, v168
v_mfma_f32_16x16x32_bf16 a[76:79], a[204:207], a[244:247], a[76:79]
s_waitcnt lgkmcnt(7)
v_add_f32 v41, v41, v169
v_add_f32 v41, v41, v170
v_add_f32 v41, v41, v171
v_add_f32 v41, v41, v172
v_mfma_f32_16x16x32_bf16 a[0:3], a[232:235], a[248:251], a[0:3]
ds_read_b128 a[244:247], v6 offset:50176
v_add_f32 v41, v41, v173
v_add_f32 v41, v41, v174
v_add_f32 v41, v41, v175
v_mfma_f32_16x16x32_bf16 a[4:7], a[236:239], a[248:251], a[4:7]
ds_read_b64_tr_b16 a[192:193], v10
v_cvt_pk_bf16_f32 v168, v168, v169
v_cvt_pk_bf16_f32 v169, v170, v171
v_cvt_pk_bf16_f32 v170, v172, v173
v_mfma_f32_16x16x32_bf16 a[80:83], a[200:203], a[248:251], a[80:83]
buffer_load_dwordx4 v15, s[16:19], s35 offen offset:3072 nt lds
ds_read_b64_tr_b16 a[194:195], v10 offset:2048
v_cvt_pk_bf16_f32 v171, v174, v175
v_fma_f32 v176, v176, s28, v30
v_mfma_f32_16x16x32_bf16 a[84:87], a[204:207], a[248:251], a[84:87]
s_waitcnt lgkmcnt(8)
v_fma_f32 v177, v177, s28, v30
v_fma_f32 v178, v178, s28, v30
v_fma_f32 v179, v179, s28, v30
v_fma_f32 v180, v180, s28, v30
v_mfma_f32_16x16x32_bf16 a[8:11], a[232:235], a[252:255], a[8:11]
ds_read_b128 a[248:251], v6 offset:51200
v_fma_f32 v181, v181, s28, v30
v_fma_f32 v182, v182, s28, v30
v_fma_f32 v183, v183, s28, v30
v_mfma_f32_16x16x32_bf16 a[12:15], a[236:239], a[252:255], a[12:15]
ds_read_b64_tr_b16 a[196:197], v11
v_exp_f32 v176, v176
v_mfma_f32_16x16x32_bf16 a[88:91], a[200:203], a[252:255], a[88:91]
ds_read_b64_tr_b16 a[198:199], v11 offset:2048
v_exp_f32 v177, v177
v_exp_f32 v178, v178
v_mfma_f32_16x16x32_bf16 a[92:95], a[204:207], a[252:255], a[92:95]
s_waitcnt lgkmcnt(8)
v_exp_f32 v179, v179
v_exp_f32 v180, v180
v_mfma_f32_16x16x32_bf16 a[16:19], a[232:235], a[240:243], a[16:19]
ds_read_b128 a[252:255], v6 offset:52224
v_exp_f32 v181, v181
v_mfma_f32_16x16x32_bf16 a[20:23], a[236:239], a[240:243], a[20:23]
v_exp_f32 v182, v182
v_exp_f32 v183, v183
v_add_f32 v42, v42, v176
v_mfma_f32_16x16x32_bf16 a[96:99], a[200:203], a[240:243], a[96:99]
v_add_f32 v42, v42, v177
v_add_f32 v42, v42, v178
v_add_f32 v42, v42, v179
v_add_f32 v42, v42, v180
v_mfma_f32_16x16x32_bf16 a[100:103], a[204:207], a[240:243], a[100:103]
s_waitcnt lgkmcnt(6)
v_add_f32 v42, v42, v181
v_add_f32 v42, v42, v182
v_add_f32 v42, v42, v183
v_cvt_pk_bf16_f32 v176, v176, v177
v_mfma_f32_16x16x32_bf16 a[24:27], a[232:235], a[244:247], a[24:27]
ds_read_b128 a[240:243], v6 offset:53248
v_cvt_pk_bf16_f32 v177, v178, v179
v_cvt_pk_bf16_f32 v178, v180, v181
v_cvt_pk_bf16_f32 v179, v182, v183
v_mfma_f32_16x16x32_bf16 a[28:31], a[236:239], a[244:247], a[28:31]
v_fma_f32 v184, v184, s28, v31
v_fma_f32 v185, v185, s28, v31
v_fma_f32 v186, v186, s28, v31
v_fma_f32 v187, v187, s28, v31
v_mfma_f32_16x16x32_bf16 a[104:107], a[200:203], a[244:247], a[104:107]
v_fma_f32 v188, v188, s28, v31
v_fma_f32 v189, v189, s28, v31
v_fma_f32 v190, v190, s28, v31
v_fma_f32 v191, v191, s28, v31
v_mfma_f32_16x16x32_bf16 a[108:111], a[204:207], a[244:247], a[108:111]
s_waitcnt lgkmcnt(4)
v_exp_f32 v184, v184
v_exp_f32 v185, v185
v_mfma_f32_16x16x32_bf16 v[208:211], a[208:211], a[248:251], v[208:211]
ds_read_b128 a[244:247], v6 offset:54272
v_exp_f32 v186, v186
v_mfma_f32_16x16x32_bf16 v[212:215], a[212:215], a[248:251], v[212:215]
v_exp_f32 v187, v187
v_exp_f32 v188, v188
v_mfma_f32_16x16x32_bf16 a[32:35], a[224:227], a[248:251], a[32:35]
v_exp_f32 v189, v189
v_exp_f32 v190, v190
v_mfma_f32_16x16x32_bf16 a[36:39], a[228:231], a[248:251], a[36:39]
s_waitcnt lgkmcnt(2)
v_exp_f32 v191, v191
v_add_f32 v43, v43, v184
v_add_f32 v43, v43, v185
v_add_f32 v43, v43, v186
v_mfma_f32_16x16x32_bf16 v[216:219], a[208:211], a[252:255], v[216:219]
ds_read_b128 a[248:251], v6 offset:55296
v_add_f32 v43, v43, v187
v_add_f32 v43, v43, v188
v_add_f32 v43, v43, v189
v_mfma_f32_16x16x32_bf16 v[220:223], a[212:215], a[252:255], v[220:223]
v_add_f32 v43, v43, v190
v_add_f32 v43, v43, v191
v_cvt_pk_bf16_f32 v184, v184, v185
v_cvt_pk_bf16_f32 v185, v186, v187
v_mfma_f32_16x16x32_bf16 a[40:43], a[224:227], a[252:255], a[40:43]
v_cvt_pk_bf16_f32 v186, v188, v189
v_cvt_pk_bf16_f32 v187, v190, v191
v_fma_f32 v192, v192, s28, v32
v_fma_f32 v193, v193, s28, v32
v_mfma_f32_16x16x32_bf16 a[44:47], a[228:231], a[252:255], a[44:47]
s_waitcnt lgkmcnt(2)
v_fma_f32 v194, v194, s28, v32
v_fma_f32 v195, v195, s28, v32
v_fma_f32 v196, v196, s28, v32
v_mfma_f32_16x16x32_bf16 v[224:227], a[208:211], a[240:243], v[224:227]
ds_read_b128 a[252:255], v6 offset:56320
v_fma_f32 v197, v197, s28, v32
v_fma_f32 v198, v198, s28, v32
v_fma_f32 v199, v199, s28, v32
v_mfma_f32_16x16x32_bf16 v[228:231], a[212:215], a[240:243], v[228:231]
v_exp_f32 v192, v192
v_exp_f32 v193, v193
v_mfma_f32_16x16x32_bf16 a[48:51], a[224:227], a[240:243], a[48:51]
v_exp_f32 v194, v194
v_exp_f32 v195, v195
v_mfma_f32_16x16x32_bf16 a[52:55], a[228:231], a[240:243], a[52:55]
s_waitcnt lgkmcnt(2)
v_exp_f32 v196, v196
v_exp_f32 v197, v197
v_mfma_f32_16x16x32_bf16 v[232:235], a[208:211], a[244:247], v[232:235]
ds_read_b128 a[240:243], v6 offset:57344
v_exp_f32 v198, v198
v_mfma_f32_16x16x32_bf16 v[236:239], a[212:215], a[244:247], v[236:239]
v_exp_f32 v199, v199
v_add_f32 v44, v44, v192
v_add_f32 v44, v44, v193
v_add_f32 v44, v44, v194
v_mfma_f32_16x16x32_bf16 a[56:59], a[224:227], a[244:247], a[56:59]
v_add_f32 v44, v44, v195
v_add_f32 v44, v44, v196
v_add_f32 v44, v44, v197
v_add_f32 v44, v44, v198
v_mfma_f32_16x16x32_bf16 a[60:63], a[228:231], a[244:247], a[60:63]
s_waitcnt lgkmcnt(2)
v_add_f32 v44, v44, v199
v_cvt_pk_bf16_f32 v192, v192, v193
v_cvt_pk_bf16_f32 v193, v194, v195
v_cvt_pk_bf16_f32 v194, v196, v197
v_mfma_f32_16x16x32_bf16 v[240:243], a[208:211], a[248:251], v[240:243]
ds_read_b128 a[244:247], v6 offset:58368
v_cvt_pk_bf16_f32 v195, v198, v199
v_fma_f32 v200, v200, s28, v33
v_fma_f32 v201, v201, s28, v33
v_mfma_f32_16x16x32_bf16 v[244:247], a[212:215], a[248:251], v[244:247]
s_add_u32 m0, s33, 0
s_add_u32 s35, s48, 0x10000
v_fma_f32 v202, v202, s28, v33
v_fma_f32 v203, v203, s28, v33
v_fma_f32 v204, v204, s28, v33
v_mfma_f32_16x16x32_bf16 a[64:67], a[224:227], a[248:251], a[64:67]
v_fma_f32 v205, v205, s28, v33
v_fma_f32 v206, v206, s28, v33
v_fma_f32 v207, v207, s28, v33
v_mfma_f32_16x16x32_bf16 a[68:71], a[228:231], a[248:251], a[68:71]
s_waitcnt lgkmcnt(2)
buffer_load_dwordx4 v12, s[16:19], s35 offen nt lds
v_exp_f32 v200, v200
v_exp_f32 v201, v201
v_mfma_f32_16x16x32_bf16 v[248:251], a[208:211], a[252:255], v[248:251]
ds_read_b128 a[248:251], v6 offset:59392
v_exp_f32 v202, v202
v_mfma_f32_16x16x32_bf16 v[252:255], a[212:215], a[252:255], v[252:255]
v_exp_f32 v203, v203
v_exp_f32 v204, v204
v_mfma_f32_16x16x32_bf16 a[72:75], a[224:227], a[252:255], a[72:75]
buffer_load_dwordx4 v13, s[16:19], s35 offen offset:1024 nt lds
v_exp_f32 v205, v205
v_exp_f32 v206, v206
v_mfma_f32_16x16x32_bf16 a[76:79], a[228:231], a[252:255], a[76:79]
s_waitcnt lgkmcnt(2)
v_exp_f32 v207, v207
v_add_f32 v45, v45, v200
v_add_f32 v45, v45, v201
v_mfma_f32_16x16x32_bf16 a[0:3], a[208:211], a[240:243], a[0:3]
ds_read_b128 a[252:255], v6 offset:60416
v_add_f32 v45, v45, v202
v_add_f32 v45, v45, v203
v_add_f32 v45, v45, v204
v_mfma_f32_16x16x32_bf16 a[4:7], a[212:215], a[240:243], a[4:7]
v_add_f32 v45, v45, v205
v_add_f32 v45, v45, v206
v_add_f32 v45, v45, v207
v_cvt_pk_bf16_f32 v200, v200, v201
v_mfma_f32_16x16x32_bf16 a[80:83], a[224:227], a[240:243], a[80:83]
buffer_load_dwordx4 v14, s[16:19], s35 offen offset:2048 nt lds
v_cvt_pk_bf16_f32 v201, v202, v203
v_cvt_pk_bf16_f32 v202, v204, v205
v_cvt_pk_bf16_f32 v203, v206, v207
v_mfma_f32_16x16x32_bf16 a[84:87], a[228:231], a[240:243], a[84:87]
s_waitcnt lgkmcnt(2)
v_mfma_f32_16x16x32_bf16 a[8:11], a[208:211], a[244:247], a[8:11]
s_waitcnt lgkmcnt(0)
s_barrier
ds_read_b128 a[240:243], v1
v_mfma_f32_16x16x32_bf16 a[12:15], a[212:215], a[244:247], a[12:15]
ds_write_b128 v7, v[128:131] offset:40960
v_mfma_f32_16x16x32_bf16 a[88:91], a[224:227], a[244:247], a[88:91]
buffer_load_dwordx4 v15, s[16:19], s35 offen offset:3072 nt lds
v_mfma_f32_16x16x32_bf16 a[92:95], a[228:231], a[244:247], a[92:95]
v_mfma_f32_16x16x32_bf16 a[16:19], a[208:211], a[248:251], a[16:19]
ds_read_b128 a[244:247], v1 offset:1024
v_mfma_f32_16x16x32_bf16 a[20:23], a[212:215], a[248:251], a[20:23]
ds_write_b128 v7, v[136:139] offset:41984
v_mfma_f32_16x16x32_bf16 a[96:99], a[224:227], a[248:251], a[96:99]
v_mfma_f32_16x16x32_bf16 a[100:103], a[228:231], a[248:251], a[100:103]
ds_write_b128 v7, v[144:147] offset:43008
v_mfma_f32_16x16x32_bf16 a[24:27], a[208:211], a[252:255], a[24:27]
ds_read_b128 a[248:251], v1 offset:2048
v_mfma_f32_16x16x32_bf16 a[28:31], a[212:215], a[252:255], a[28:31]
ds_write_b128 v7, v[152:155] offset:44032
v_mfma_f32_16x16x32_bf16 a[104:107], a[224:227], a[252:255], a[104:107]
v_mfma_f32_16x16x32_bf16 a[108:111], a[228:231], a[252:255], a[108:111]
s_waitcnt lgkmcnt(6)
v_mfma_f32_16x16x32_bf16 v[48:51], a[216:219], a[240:243], 0
ds_read_b128 a[252:255], v1 offset:3072
v_mfma_f32_16x16x32_bf16 v[52:55], a[220:223], a[240:243], 0
s_waitcnt vmcnt(12)
ds_read_b64_tr_b16 a[232:233], v8 offset:4096
v_mfma_f32_16x16x32_bf16 v[56:59], a[192:195], a[240:243], 0
ds_read_b64_tr_b16 a[234:235], v8 offset:6144
v_mfma_f32_16x16x32_bf16 v[60:63], a[196:199], a[240:243], 0
s_waitcnt lgkmcnt(7)
ds_write_b128 v7, v[160:163] offset:45056
v_mfma_f32_16x16x32_bf16 v[64:67], a[216:219], a[244:247], 0
ds_read_b128 a[240:243], v1 offset:4096
v_max_f32 v24, v208, v209
v_max3_f32 v24, v24, v210, v211
v_mfma_f32_16x16x32_bf16 v[68:71], a[220:223], a[244:247], 0
ds_read_b64_tr_b16 a[236:237], v9 offset:4096
v_max3_f32 v24, v24, v212, v213
v_max3_f32 v24, v24, v214, v215
v_mfma_f32_16x16x32_bf16 v[72:75], a[192:195], a[244:247], 0
ds_read_b64_tr_b16 a[238:239], v9 offset:6144
v_accvgpr_read_b32 v46, a32
v_mfma_f32_16x16x32_bf16 v[76:79], a[196:199], a[244:247], 0
s_waitcnt lgkmcnt(8)
ds_write_b128 v7, v[168:171] offset:46080
v_mfma_f32_16x16x32_bf16 v[80:83], a[216:219], a[248:251], 0
ds_read_b128 a[244:247], v1 offset:5120
v_accvgpr_read_b32 v47, a33
v_max3_f32 v24, v24, v46, v47
v_mfma_f32_16x16x32_bf16 v[84:87], a[220:223], a[248:251], 0
ds_read_b64_tr_b16 a[200:201], v10 offset:4096
v_accvgpr_read_b32 v35, a34
v_accvgpr_read_b32 v34, a35
v_mfma_f32_16x16x32_bf16 v[88:91], a[192:195], a[248:251], 0
ds_read_b64_tr_b16 a[202:203], v10 offset:6144
v_max3_f32 v24, v24, v35, v34
v_accvgpr_read_b32 v46, a36
v_mfma_f32_16x16x32_bf16 v[92:95], a[196:199], a[248:251], 0
s_waitcnt lgkmcnt(10)
ds_write_b128 v7, v[176:179] offset:47104
v_mfma_f32_16x16x32_bf16 v[96:99], a[216:219], a[252:255], 0
ds_read_b128 a[248:251], v1 offset:6144
v_accvgpr_read_b32 v47, a37
v_mfma_f32_16x16x32_bf16 v[100:103], a[220:223], a[252:255], 0
ds_read_b64_tr_b16 a[204:205], v11 offset:4096
v_max3_f32 v24, v24, v46, v47
v_accvgpr_read_b32 v35, a38
v_mfma_f32_16x16x32_bf16 v[104:107], a[192:195], a[252:255], 0
ds_read_b64_tr_b16 a[206:207], v11 offset:6144
v_accvgpr_read_b32 v34, a39
v_max3_f32 v24, v24, v35, v34
v_mfma_f32_16x16x32_bf16 v[108:111], a[196:199], a[252:255], 0
s_waitcnt lgkmcnt(10)
ds_write_b128 v7, v[184:187] offset:48128
v_mfma_f32_16x16x32_bf16 v[112:115], a[216:219], a[240:243], 0
ds_read_b128 a[252:255], v1 offset:7168
v_max_f32 v25, v216, v217
v_max3_f32 v25, v25, v218, v219
v_mfma_f32_16x16x32_bf16 v[116:119], a[220:223], a[240:243], 0
ds_write_b128 v7, v[192:195] offset:49152
v_mfma_f32_16x16x32_bf16 v[120:123], a[192:195], a[240:243], 0
ds_write_b128 v7, v[200:203] offset:50176
v_mfma_f32_16x16x32_bf16 v[124:127], a[196:199], a[240:243], 0
s_waitcnt lgkmcnt(10)
v_max3_f32 v25, v25, v220, v221
v_max3_f32 v25, v25, v222, v223
v_mfma_f32_16x16x32_bf16 v[132:135], a[216:219], a[244:247], 0
ds_read_b128 a[240:243], v1 offset:8192
v_accvgpr_read_b32 v46, a40
v_accvgpr_read_b32 v47, a41
v_mfma_f32_16x16x32_bf16 v[140:143], a[220:223], a[244:247], 0
s_add_u32 m0, s33, 0x1000
s_add_u32 s35, s48, 0x14000
v_max3_f32 v25, v25, v46, v47
v_accvgpr_read_b32 v35, a42
v_mfma_f32_16x16x32_bf16 v[128:131], a[192:195], a[244:247], 0
s_waitcnt lgkmcnt(5)
buffer_load_dwordx4 v12, s[16:19], s35 offen nt lds
v_accvgpr_read_b32 v34, a43
v_max3_f32 v25, v25, v35, v34
v_mfma_f32_16x16x32_bf16 v[136:139], a[196:199], a[244:247], 0
v_accvgpr_read_b32 v46, a44
v_accvgpr_read_b32 v47, a45
v_mfma_f32_16x16x32_bf16 v[148:151], a[216:219], a[248:251], 0
ds_read_b128 a[244:247], v1 offset:9216
v_max3_f32 v25, v25, v46, v47
v_accvgpr_read_b32 v35, a46
v_mfma_f32_16x16x32_bf16 v[156:159], a[220:223], a[248:251], 0
buffer_load_dwordx4 v13, s[16:19], s35 offen offset:1024 nt lds
v_accvgpr_read_b32 v34, a47
v_max3_f32 v25, v25, v35, v34
v_mfma_f32_16x16x32_bf16 v[144:147], a[192:195], a[248:251], 0
v_max_f32 v26, v224, v225
v_max3_f32 v26, v26, v226, v227
v_mfma_f32_16x16x32_bf16 v[152:155], a[196:199], a[248:251], 0
s_waitcnt lgkmcnt(4)
v_max3_f32 v26, v26, v228, v229
v_max3_f32 v26, v26, v230, v231
v_accvgpr_read_b32 v46, a48
v_mfma_f32_16x16x32_bf16 v[164:167], a[216:219], a[252:255], 0
ds_read_b128 a[248:251], v1 offset:10240
v_accvgpr_read_b32 v47, a49
v_max3_f32 v26, v26, v46, v47
v_mfma_f32_16x16x32_bf16 v[172:175], a[220:223], a[252:255], 0
buffer_load_dwordx4 v14, s[16:19], s35 offen offset:2048 nt lds
v_accvgpr_read_b32 v35, a50
v_accvgpr_read_b32 v34, a51
v_mfma_f32_16x16x32_bf16 v[160:163], a[192:195], a[252:255], 0
v_max3_f32 v26, v26, v35, v34
v_accvgpr_read_b32 v46, a52
v_mfma_f32_16x16x32_bf16 v[168:171], a[196:199], a[252:255], 0
s_waitcnt lgkmcnt(2)
v_accvgpr_read_b32 v47, a53
v_max3_f32 v26, v26, v46, v47
v_accvgpr_read_b32 v35, a54
v_mfma_f32_16x16x32_bf16 v[180:183], a[216:219], a[240:243], 0
ds_read_b128 a[252:255], v1 offset:11264
v_accvgpr_read_b32 v34, a55
v_max3_f32 v26, v26, v35, v34
v_mfma_f32_16x16x32_bf16 v[188:191], a[220:223], a[240:243], 0
buffer_load_dwordx4 v15, s[16:19], s35 offen offset:3072 nt lds
v_max_f32 v27, v232, v233
v_max3_f32 v27, v27, v234, v235
v_mfma_f32_16x16x32_bf16 v[176:179], a[192:195], a[240:243], 0
v_max3_f32 v27, v27, v236, v237
v_max3_f32 v27, v27, v238, v239
v_mfma_f32_16x16x32_bf16 v[184:187], a[196:199], a[240:243], 0
s_waitcnt lgkmcnt(2)
v_accvgpr_read_b32 v46, a56
v_accvgpr_read_b32 v47, a57
v_max3_f32 v27, v27, v46, v47
v_mfma_f32_16x16x32_bf16 v[196:199], a[216:219], a[244:247], 0
ds_read_b128 a[240:243], v1 offset:12288
v_accvgpr_read_b32 v35, a58
v_accvgpr_read_b32 v34, a59
v_mfma_f32_16x16x32_bf16 v[204:207], a[220:223], a[244:247], 0
v_max3_f32 v27, v27, v35, v34
v_accvgpr_read_b32 v46, a60
v_accvgpr_read_b32 v47, a61
v_mfma_f32_16x16x32_bf16 v[192:195], a[192:195], a[244:247], 0
v_max3_f32 v27, v27, v46, v47
v_accvgpr_read_b32 v35, a62
v_mfma_f32_16x16x32_bf16 v[200:203], a[196:199], a[244:247], 0
s_waitcnt lgkmcnt(2)
v_accvgpr_read_b32 v34, a63
v_max3_f32 v27, v27, v35, v34
v_max_f32 v28, v240, v241
v_mfma_f32_16x16x32_bf16 v[48:51], a[232:235], a[248:251], v[48:51]
ds_read_b128 a[244:247], v1 offset:13312
v_max3_f32 v28, v28, v242, v243
v_max3_f32 v28, v28, v244, v245
v_mfma_f32_16x16x32_bf16 v[52:55], a[236:239], a[248:251], v[52:55]
s_waitcnt vmcnt(12)
ds_read_b64_tr_b16 a[216:217], v8 offset:8192
v_max3_f32 v28, v28, v246, v247
v_accvgpr_read_b32 v46, a64
v_mfma_f32_16x16x32_bf16 v[56:59], a[200:203], a[248:251], v[56:59]
ds_read_b64_tr_b16 a[218:219], v8 offset:10240
v_accvgpr_read_b32 v47, a65
v_mfma_f32_16x16x32_bf16 v[60:63], a[204:207], a[248:251], v[60:63]
s_waitcnt lgkmcnt(4)
v_max3_f32 v28, v28, v46, v47
v_accvgpr_read_b32 v35, a66
v_accvgpr_read_b32 v34, a67
v_mfma_f32_16x16x32_bf16 v[64:67], a[232:235], a[252:255], v[64:67]
ds_read_b128 a[248:251], v1 offset:14336
v_max3_f32 v28, v28, v35, v34
v_accvgpr_read_b32 v46, a68
v_mfma_f32_16x16x32_bf16 v[68:71], a[236:239], a[252:255], v[68:71]
ds_read_b64_tr_b16 a[220:221], v9 offset:8192
v_accvgpr_read_b32 v47, a69
v_max3_f32 v28, v28, v46, v47
v_mfma_f32_16x16x32_bf16 v[72:75], a[200:203], a[252:255], v[72:75]
ds_read_b64_tr_b16 a[222:223], v9 offset:10240
v_accvgpr_read_b32 v35, a70
v_mfma_f32_16x16x32_bf16 v[76:79], a[204:207], a[252:255], v[76:79]
s_waitcnt lgkmcnt(6)
v_accvgpr_read_b32 v34, a71
v_max3_f32 v28, v28, v35, v34
v_max_f32 v29, v248, v249
v_mfma_f32_16x16x32_bf16 v[80:83], a[232:235], a[240:243], v[80:83]
ds_read_b128 a[252:255], v1 offset:15360
v_max3_f32 v29, v29, v250, v251
v_max3_f32 v29, v29, v252, v253
v_mfma_f32_16x16x32_bf16 v[84:87], a[236:239], a[240:243], v[84:87]
ds_read_b64_tr_b16 a[192:193], v10 offset:8192
v_max3_f32 v29, v29, v254, v255
v_accvgpr_read_b32 v46, a72
v_mfma_f32_16x16x32_bf16 v[88:91], a[200:203], a[240:243], v[88:91]
ds_read_b64_tr_b16 a[194:195], v10 offset:10240
v_accvgpr_read_b32 v47, a73
v_mfma_f32_16x16x32_bf16 v[92:95], a[204:207], a[240:243], v[92:95]
s_waitcnt lgkmcnt(8)
v_max3_f32 v29, v29, v46, v47
v_accvgpr_read_b32 v35, a74
v_accvgpr_read_b32 v34, a75
v_mfma_f32_16x16x32_bf16 v[96:99], a[232:235], a[244:247], v[96:99]
ds_read_b128 a[240:243], v1 offset:16384
v_max3_f32 v29, v29, v35, v34
v_accvgpr_read_b32 v46, a76
v_mfma_f32_16x16x32_bf16 v[100:103], a[236:239], a[244:247], v[100:103]
ds_read_b64_tr_b16 a[196:197], v11 offset:8192
v_accvgpr_read_b32 v47, a77
v_mfma_f32_16x16x32_bf16 v[104:107], a[200:203], a[244:247], v[104:107]
ds_read_b64_tr_b16 a[198:199], v11 offset:10240
v_max3_f32 v29, v29, v46, v47
v_accvgpr_read_b32 v35, a78
v_mfma_f32_16x16x32_bf16 v[108:111], a[204:207], a[244:247], v[108:111]
s_waitcnt lgkmcnt(8)
v_accvgpr_read_b32 v34, a79
v_max3_f32 v29, v29, v35, v34
v_accvgpr_read_b32 v46, a0
v_mfma_f32_16x16x32_bf16 v[112:115], a[232:235], a[248:251], v[112:115]
ds_read_b128 a[244:247], v1 offset:17408
v_accvgpr_read_b32 v47, a1
v_max_f32 v30, v46, v47
v_mfma_f32_16x16x32_bf16 v[116:119], a[236:239], a[248:251], v[116:119]
v_accvgpr_read_b32 v35, a2
v_accvgpr_read_b32 v34, a3
v_mfma_f32_16x16x32_bf16 v[120:123], a[200:203], a[248:251], v[120:123]
v_max3_f32 v30, v30, v35, v34
v_accvgpr_read_b32 v46, a4
v_accvgpr_read_b32 v47, a5
v_mfma_f32_16x16x32_bf16 v[124:127], a[204:207], a[248:251], v[124:127]
s_waitcnt lgkmcnt(6)
v_max3_f32 v30, v30, v46, v47
v_accvgpr_read_b32 v35, a6
v_accvgpr_read_b32 v34, a7
v_mfma_f32_16x16x32_bf16 v[132:135], a[232:235], a[252:255], v[132:135]
ds_read_b128 a[248:251], v1 offset:18432
v_max3_f32 v30, v30, v35, v34
v_accvgpr_read_b32 v46, a80
v_mfma_f32_16x16x32_bf16 v[140:143], a[236:239], a[252:255], v[140:143]
s_add_u32 m0, s33, 0x2000
s_add_u32 s35, s48, 0x18000
v_accvgpr_read_b32 v47, a81
v_mfma_f32_16x16x32_bf16 v[128:131], a[200:203], a[252:255], v[128:131]
s_waitcnt lgkmcnt(2)
buffer_load_dwordx4 v12, s[16:19], s35 offen nt lds
v_max3_f32 v30, v30, v46, v47
v_accvgpr_read_b32 v35, a82
v_mfma_f32_16x16x32_bf16 v[136:139], a[204:207], a[252:255], v[136:139]
v_accvgpr_read_b32 v34, a83
v_max3_f32 v30, v30, v35, v34
v_accvgpr_read_b32 v46, a84
v_mfma_f32_16x16x32_bf16 v[148:151], a[232:235], a[240:243], v[148:151]
ds_read_b128 a[252:255], v1 offset:19456
v_accvgpr_read_b32 v47, a85
v_max3_f32 v30, v30, v46, v47
v_mfma_f32_16x16x32_bf16 v[156:159], a[236:239], a[240:243], v[156:159]
buffer_load_dwordx4 v13, s[16:19], s35 offen offset:1024 nt lds
v_accvgpr_read_b32 v35, a86
v_mfma_f32_16x16x32_bf16 v[144:147], a[200:203], a[240:243], v[144:147]
v_accvgpr_read_b32 v34, a87
v_max3_f32 v30, v30, v35, v34
v_accvgpr_read_b32 v46, a8
v_mfma_f32_16x16x32_bf16 v[152:155], a[204:207], a[240:243], v[152:155]
s_waitcnt lgkmcnt(2)
v_accvgpr_read_b32 v47, a9
v_max_f32 v31, v46, v47
v_accvgpr_read_b32 v35, a10
v_mfma_f32_16x16x32_bf16 v[164:167], a[232:235], a[244:247], v[164:167]
ds_read_b128 a[240:243], v1 offset:20480
v_accvgpr_read_b32 v34, a11
v_max3_f32 v31, v31, v35, v34
v_mfma_f32_16x16x32_bf16 v[172:175], a[236:239], a[244:247], v[172:175]
buffer_load_dwordx4 v14, s[16:19], s35 offen offset:2048 nt lds
v_accvgpr_read_b32 v46, a12
v_mfma_f32_16x16x32_bf16 v[160:163], a[200:203], a[244:247], v[160:163]
v_accvgpr_read_b32 v47, a13
v_max3_f32 v31, v31, v46, v47
v_accvgpr_read_b32 v35, a14
v_mfma_f32_16x16x32_bf16 v[168:171], a[204:207], a[244:247], v[168:171]
s_waitcnt lgkmcnt(2)
v_accvgpr_read_b32 v34, a15
v_max3_f32 v31, v31, v35, v34
v_accvgpr_read_b32 v46, a88
v_mfma_f32_16x16x32_bf16 v[180:183], a[232:235], a[248:251], v[180:183]
ds_read_b128 a[244:247], v1 offset:21504
v_accvgpr_read_b32 v47, a89
v_max3_f32 v31, v31, v46, v47
v_mfma_f32_16x16x32_bf16 v[188:191], a[236:239], a[248:251], v[188:191]
buffer_load_dwordx4 v15, s[16:19], s35 offen offset:3072 nt lds
v_accvgpr_read_b32 v35, a90
v_mfma_f32_16x16x32_bf16 v[176:179], a[200:203], a[248:251], v[176:179]
v_accvgpr_read_b32 v34, a91
v_max3_f32 v31, v31, v35, v34
v_accvgpr_read_b32 v46, a92
v_mfma_f32_16x16x32_bf16 v[184:187], a[204:207], a[248:251], v[184:187]
s_waitcnt lgkmcnt(2)
v_accvgpr_read_b32 v47, a93
v_max3_f32 v31, v31, v46, v47
v_accvgpr_read_b32 v35, a94
v_mfma_f32_16x16x32_bf16 v[196:199], a[232:235], a[252:255], v[196:199]
ds_read_b128 a[248:251], v1 offset:22528
v_accvgpr_read_b32 v34, a95
v_max3_f32 v31, v31, v35, v34
v_mfma_f32_16x16x32_bf16 v[204:207], a[236:239], a[252:255], v[204:207]
v_accvgpr_read_b32 v46, a16
v_accvgpr_read_b32 v47, a17
v_mfma_f32_16x16x32_bf16 v[192:195], a[200:203], a[252:255], v[192:195]
v_max_f32 v32, v46, v47
v_accvgpr_read_b32 v35, a18
v_accvgpr_read_b32 v34, a19
v_mfma_f32_16x16x32_bf16 v[200:203], a[204:207], a[252:255], v[200:203]
s_waitcnt lgkmcnt(2)
v_max3_f32 v32, v32, v35, v34
v_accvgpr_read_b32 v46, a20
v_accvgpr_read_b32 v47, a21
v_mfma_f32_16x16x32_bf16 v[48:51], a[216:219], a[240:243], v[48:51]
ds_read_b128 a[252:255], v1 offset:23552
v_max3_f32 v32, v32, v46, v47
v_mfma_f32_16x16x32_bf16 v[52:55], a[220:223], a[240:243], v[52:55]
s_waitcnt vmcnt(12)
ds_read_b64_tr_b16 a[232:233], v8 offset:12288
v_accvgpr_read_b32 v35, a22
v_accvgpr_read_b32 v34, a23
v_mfma_f32_16x16x32_bf16 v[56:59], a[192:195], a[240:243], v[56:59]
ds_read_b64_tr_b16 a[234:235], v8 offset:14336
v_max3_f32 v32, v32, v35, v34
v_accvgpr_read_b32 v46, a96
v_mfma_f32_16x16x32_bf16 v[60:63], a[196:199], a[240:243], v[60:63]
s_waitcnt lgkmcnt(4)
v_accvgpr_read_b32 v47, a97
v_max3_f32 v32, v32, v46, v47
v_accvgpr_read_b32 v35, a98
v_mfma_f32_16x16x32_bf16 v[64:67], a[216:219], a[244:247], v[64:67]
ds_read_b128 a[240:243], v1 offset:24576
v_accvgpr_read_b32 v34, a99
v_mfma_f32_16x16x32_bf16 v[68:71], a[220:223], a[244:247], v[68:71]
ds_read_b64_tr_b16 a[236:237], v9 offset:12288
v_max3_f32 v32, v32, v35, v34
v_accvgpr_read_b32 v46, a100
v_mfma_f32_16x16x32_bf16 v[72:75], a[192:195], a[244:247], v[72:75]
ds_read_b64_tr_b16 a[238:239], v9 offset:14336
v_accvgpr_read_b32 v47, a101
v_max3_f32 v32, v32, v46, v47
v_mfma_f32_16x16x32_bf16 v[76:79], a[196:199], a[244:247], v[76:79]
s_waitcnt lgkmcnt(6)
v_accvgpr_read_b32 v35, a102
v_accvgpr_read_b32 v34, a103
v_max3_f32 v32, v32, v35, v34
v_mfma_f32_16x16x32_bf16 v[80:83], a[216:219], a[248:251], v[80:83]
ds_read_b128 a[244:247], v1 offset:25600
v_accvgpr_read_b32 v46, a24
v_mfma_f32_16x16x32_bf16 v[84:87], a[220:223], a[248:251], v[84:87]
ds_read_b64_tr_b16 a[200:201], v10 offset:12288
v_accvgpr_read_b32 v47, a25
v_max_f32 v33, v46, v47
v_mfma_f32_16x16x32_bf16 v[88:91], a[192:195], a[248:251], v[88:91]
ds_read_b64_tr_b16 a[202:203], v10 offset:14336
v_accvgpr_read_b32 v35, a26
v_accvgpr_read_b32 v34, a27
v_mfma_f32_16x16x32_bf16 v[92:95], a[196:199], a[248:251], v[92:95]
s_waitcnt lgkmcnt(8)
v_max3_f32 v33, v33, v35, v34
v_accvgpr_read_b32 v46, a28
v_accvgpr_read_b32 v47, a29
v_mfma_f32_16x16x32_bf16 v[96:99], a[216:219], a[252:255], v[96:99]
ds_read_b128 a[248:251], v1 offset:26624
v_max3_f32 v33, v33, v46, v47
v_mfma_f32_16x16x32_bf16 v[100:103], a[220:223], a[252:255], v[100:103]
ds_read_b64_tr_b16 a[204:205], v11 offset:12288
v_accvgpr_read_b32 v35, a30
v_accvgpr_read_b32 v34, a31
v_mfma_f32_16x16x32_bf16 v[104:107], a[192:195], a[252:255], v[104:107]
ds_read_b64_tr_b16 a[206:207], v11 offset:14336
v_max3_f32 v33, v33, v35, v34
v_accvgpr_read_b32 v46, a104
v_mfma_f32_16x16x32_bf16 v[108:111], a[196:199], a[252:255], v[108:111]
s_waitcnt lgkmcnt(8)
v_accvgpr_read_b32 v47, a105
v_max3_f32 v33, v33, v46, v47
v_accvgpr_read_b32 v35, a106
v_mfma_f32_16x16x32_bf16 v[112:115], a[216:219], a[240:243], v[112:115]
ds_read_b128 a[252:255], v1 offset:27648
v_accvgpr_read_b32 v34, a107
v_mfma_f32_16x16x32_bf16 v[116:119], a[220:223], a[240:243], v[116:119]
v_max3_f32 v33, v33, v35, v34
v_accvgpr_read_b32 v46, a108
v_accvgpr_read_b32 v47, a109
v_mfma_f32_16x16x32_bf16 v[120:123], a[192:195], a[240:243], v[120:123]
v_max3_f32 v33, v33, v46, v47
v_accvgpr_read_b32 v35, a110
v_accvgpr_read_b32 v34, a111
v_mfma_f32_16x16x32_bf16 v[124:127], a[196:199], a[240:243], v[124:127]
s_waitcnt lgkmcnt(6)
v_max3_f32 v33, v33, v35, v34
v_permlane32_swap_b32 v24, v25
v_permlane32_swap_b32 v26, v27
v_mfma_f32_16x16x32_bf16 v[132:135], a[216:219], a[244:247], v[132:135]
ds_read_b128 a[240:243], v1 offset:28672
v_permlane32_swap_b32 v28, v29
v_mfma_f32_16x16x32_bf16 v[140:143], a[220:223], a[244:247], v[140:143]
s_add_u32 m0, s33, 0x3000
s_add_u32 s35, s48, 0x1c000
v_permlane32_swap_b32 v30, v31
v_permlane32_swap_b32 v32, v33
v_mfma_f32_16x16x32_bf16 v[128:131], a[192:195], a[244:247], v[128:131]
s_waitcnt lgkmcnt(2)
buffer_load_dwordx4 v12, s[16:19], s35 offen nt lds
v_max_f32 v24, v24, v25
v_max_f32 v26, v26, v27
v_mfma_f32_16x16x32_bf16 v[136:139], a[196:199], a[244:247], v[136:139]
v_max_f32 v28, v28, v29
v_max_f32 v30, v30, v31
v_max_f32 v32, v32, v33
v_mfma_f32_16x16x32_bf16 v[148:151], a[216:219], a[248:251], v[148:151]
ds_read_b128 a[244:247], v1 offset:29696
v_permlane16_swap_b32 v24, v26
v_mfma_f32_16x16x32_bf16 v[156:159], a[220:223], a[248:251], v[156:159]
buffer_load_dwordx4 v13, s[16:19], s35 offen offset:1024 nt lds
v_permlane16_swap_b32 v28, v30
v_permlane16_swap_b32 v32, v34
v_mfma_f32_16x16x32_bf16 v[144:147], a[192:195], a[248:251], v[144:147]
v_max_f32 v24, v24, v26
v_max_f32 v28, v28, v30
v_max_f32 v32, v32, v34
v_mfma_f32_16x16x32_bf16 v[152:155], a[196:199], a[248:251], v[152:155]
s_waitcnt lgkmcnt(2)
ds_max_f32 v20, v24
v_mfma_f32_16x16x32_bf16 v[164:167], a[216:219], a[252:255], v[164:167]
ds_read_b128 a[248:251], v1 offset:30720
v_mfma_f32_16x16x32_bf16 v[172:175], a[220:223], a[252:255], v[172:175]
buffer_load_dwordx4 v14, s[16:19], s35 offen offset:2048 nt lds
ds_max_f32 v20, v28 offset:16
ds_max_f32 v20, v32 offset:32
v_mfma_f32_16x16x32_bf16 v[160:163], a[192:195], a[252:255], v[160:163]
s_waitcnt lgkmcnt(0)
s_barrier
v_mfma_f32_16x16x32_bf16 v[168:171], a[196:199], a[252:255], v[168:171]
ds_read_b128 a[208:211], v21 offset:1024
v_mfma_f32_16x16x32_bf16 v[180:183], a[216:219], a[240:243], v[180:183]
ds_read_b128 a[252:255], v1 offset:31744
v_mfma_f32_16x16x32_bf16 v[188:191], a[220:223], a[240:243], v[188:191]
buffer_load_dwordx4 v15, s[16:19], s35 offen offset:3072 nt lds
v_mfma_f32_16x16x32_bf16 v[176:179], a[192:195], a[240:243], v[176:179]
ds_read_b128 a[212:215], v21 offset:1040
v_mfma_f32_16x16x32_bf16 v[184:187], a[196:199], a[240:243], v[184:187]
ds_read_b128 a[224:227], v21 offset:1056
v_mfma_f32_16x16x32_bf16 v[196:199], a[216:219], a[244:247], v[196:199]
ds_read_b128 a[240:243], v1 offset:32768
v_mfma_f32_16x16x32_bf16 v[204:207], a[220:223], a[244:247], v[204:207]
ds_read_b128 v[24:27], v21
v_mfma_f32_16x16x32_bf16 v[192:195], a[192:195], a[244:247], v[192:195]
ds_read_b128 v[28:31], v21 offset:16
v_mfma_f32_16x16x32_bf16 v[200:203], a[196:199], a[244:247], v[200:203]
ds_read_b128 v[32:35], v21 offset:32
s_waitcnt lgkmcnt(2)
v_mul_f32 v24, s28, -v24
v_mul_f32 v25, s28, -v25
v_mul_f32 v26, s28, -v26
v_mul_f32 v27, s28, -v27
s_waitcnt lgkmcnt(1)
v_mul_f32 v28, s28, -v28
v_mul_f32 v29, s28, -v29
v_mul_f32 v30, s28, -v30
v_mul_f32 v31, s28, -v31
s_waitcnt lgkmcnt(0)
v_mul_f32 v32, s28, -v32
v_mul_f32 v33, s28, -v33
v_accvgpr_read_b32 v46, a208
v_fma_f32 v46, v46, s28, v24
v_exp_f32 v46, v46
s_nop 0
v_mul_f32 v36, v36, v46
v_mfma_f32_16x16x32_bf16 v[48:51], a[232:235], a[248:251], v[48:51]
ds_read_b128 a[244:247], v1 offset:33792
v_accvgpr_write_b32 a208, v46
v_mfma_f32_16x16x32_bf16 v[52:55], a[236:239], a[248:251], v[52:55]
s_waitcnt vmcnt(12)
ds_read_b64_tr_b16 a[216:217], v8
v_accvgpr_read_b32 v47, a209
v_fma_f32 v47, v47, s28, v25
v_mfma_f32_16x16x32_bf16 v[56:59], a[200:203], a[248:251], v[56:59]
ds_read_b64_tr_b16 a[218:219], v8 offset:2048
v_mfma_f32_16x16x32_bf16 v[60:63], a[204:207], a[248:251], v[60:63]
v_exp_f32 v47, v47
s_nop 0
v_mul_f32 v37, v37, v47
v_accvgpr_write_b32 a209, v47
v_mfma_f32_16x16x32_bf16 v[64:67], a[232:235], a[252:255], v[64:67]
ds_read_b128 a[248:251], v1 offset:34816
v_accvgpr_read_b32 v46, a210
v_fma_f32 v46, v46, s28, v26
v_mfma_f32_16x16x32_bf16 v[68:71], a[236:239], a[252:255], v[68:71]
ds_read_b64_tr_b16 a[220:221], v9
v_mfma_f32_16x16x32_bf16 v[72:75], a[200:203], a[252:255], v[72:75]
ds_read_b64_tr_b16 a[222:223], v9 offset:2048
v_exp_f32 v46, v46
s_nop 0
v_mul_f32 v38, v38, v46
v_mfma_f32_16x16x32_bf16 v[76:79], a[204:207], a[252:255], v[76:79]
v_accvgpr_write_b32 a210, v46
v_accvgpr_read_b32 v47, a211
v_fma_f32 v47, v47, s28, v27
v_mfma_f32_16x16x32_bf16 v[80:83], a[232:235], a[240:243], v[80:83]
ds_read_b128 a[252:255], v1 offset:35840
v_mfma_f32_16x16x32_bf16 v[84:87], a[236:239], a[240:243], v[84:87]
ds_read_b64_tr_b16 a[192:193], v10
v_exp_f32 v47, v47
s_nop 0
v_mul_f32 v39, v39, v47
v_mfma_f32_16x16x32_bf16 v[88:91], a[200:203], a[240:243], v[88:91]
ds_read_b64_tr_b16 a[194:195], v10 offset:2048
v_accvgpr_write_b32 a211, v47
v_mfma_f32_16x16x32_bf16 v[92:95], a[204:207], a[240:243], v[92:95]
s_waitcnt lgkmcnt(8)
v_accvgpr_read_b32 v46, a212
v_fma_f32 v46, v46, s28, v28
v_mfma_f32_16x16x32_bf16 v[96:99], a[232:235], a[244:247], v[96:99]
ds_read_b128 a[240:243], v1 offset:36864
v_exp_f32 v46, v46
s_nop 0
v_mul_f32 v40, v40, v46
v_mfma_f32_16x16x32_bf16 v[100:103], a[236:239], a[244:247], v[100:103]
ds_read_b64_tr_b16 a[196:197], v11
v_accvgpr_write_b32 a212, v46
v_mfma_f32_16x16x32_bf16 v[104:107], a[200:203], a[244:247], v[104:107]
ds_read_b64_tr_b16 a[198:199], v11 offset:2048
v_accvgpr_read_b32 v47, a213
v_fma_f32 v47, v47, s28, v29
v_mfma_f32_16x16x32_bf16 v[108:111], a[204:207], a[244:247], v[108:111]
s_waitcnt lgkmcnt(8)
v_exp_f32 v47, v47
s_nop 0
v_mul_f32 v41, v41, v47
v_mfma_f32_16x16x32_bf16 v[112:115], a[232:235], a[248:251], v[112:115]
ds_read_b128 a[244:247], v1 offset:37888
v_accvgpr_write_b32 a213, v47
v_mfma_f32_16x16x32_bf16 v[116:119], a[236:239], a[248:251], v[116:119]
v_accvgpr_read_b32 v46, a214
v_fma_f32 v46, v46, s28, v30
v_mfma_f32_16x16x32_bf16 v[120:123], a[200:203], a[248:251], v[120:123]
v_exp_f32 v46, v46
s_nop 0
v_mul_f32 v42, v42, v46
v_mfma_f32_16x16x32_bf16 v[124:127], a[204:207], a[248:251], v[124:127]
s_waitcnt lgkmcnt(6)
v_accvgpr_write_b32 a214, v46
v_accvgpr_read_b32 v47, a215
v_fma_f32 v47, v47, s28, v31
v_mfma_f32_16x16x32_bf16 v[132:135], a[232:235], a[252:255], v[132:135]
ds_read_b128 a[248:251], v1 offset:38912
v_exp_f32 v47, v47
v_mfma_f32_16x16x32_bf16 v[140:143], a[236:239], a[252:255], v[140:143]
s_add_u32 m0, s33, 0
s_add_u32 s35, s48, 0x20000
v_mul_f32 v43, v43, v47
v_mfma_f32_16x16x32_bf16 v[128:131], a[200:203], a[252:255], v[128:131]
s_waitcnt lgkmcnt(2)
buffer_load_dwordx4 v12, s[16:19], s35 offen nt lds
v_accvgpr_write_b32 a215, v47
v_accvgpr_read_b32 v46, a224
v_mfma_f32_16x16x32_bf16 v[136:139], a[204:207], a[252:255], v[136:139]
v_fma_f32 v46, v46, s28, v32
v_exp_f32 v46, v46
v_mfma_f32_16x16x32_bf16 v[148:151], a[232:235], a[240:243], v[148:151]
ds_read_b128 a[252:255], v1 offset:39936
v_mul_f32 v44, v44, v46
v_mfma_f32_16x16x32_bf16 v[156:159], a[236:239], a[240:243], v[156:159]
buffer_load_dwordx4 v13, s[16:19], s35 offen offset:1024 nt lds
v_accvgpr_write_b32 a224, v46
v_accvgpr_read_b32 v47, a225
v_mfma_f32_16x16x32_bf16 v[144:147], a[200:203], a[240:243], v[144:147]
v_fma_f32 v47, v47, s28, v33
v_mfma_f32_16x16x32_bf16 v[152:155], a[204:207], a[240:243], v[152:155]
s_waitcnt lgkmcnt(2)
v_exp_f32 v47, v47
s_nop 0
v_mul_f32 v45, v45, v47
v_accvgpr_write_b32 a225, v47
v_mfma_f32_16x16x32_bf16 v[164:167], a[232:235], a[244:247], v[164:167]
s_waitcnt lgkmcnt(0)
s_barrier
ds_read_b128 a[240:243], v2
v_mfma_f32_16x16x32_bf16 v[172:175], a[236:239], a[244:247], v[172:175]
buffer_load_dwordx4 v14, s[16:19], s35 offen offset:2048 nt lds
v_fma_f32 v208, v208, s28, v24
v_fma_f32 v209, v209, s28, v24
v_fma_f32 v210, v210, s28, v24
v_mfma_f32_16x16x32_bf16 v[160:163], a[200:203], a[244:247], v[160:163]
v_fma_f32 v211, v211, s28, v24
v_fma_f32 v212, v212, s28, v24
v_fma_f32 v213, v213, s28, v24
v_mfma_f32_16x16x32_bf16 v[168:171], a[204:207], a[244:247], v[168:171]
v_fma_f32 v214, v214, s28, v24
v_fma_f32 v215, v215, s28, v24
v_exp_f32 v208, v208
v_mfma_f32_16x16x32_bf16 v[180:183], a[232:235], a[248:251], v[180:183]
ds_read_b128 a[244:247], v2 offset:1024
v_exp_f32 v209, v209
v_mfma_f32_16x16x32_bf16 v[188:191], a[236:239], a[248:251], v[188:191]
buffer_load_dwordx4 v15, s[16:19], s35 offen offset:3072 nt lds
v_exp_f32 v210, v210
v_exp_f32 v211, v211
v_mfma_f32_16x16x32_bf16 v[176:179], a[200:203], a[248:251], v[176:179]
v_exp_f32 v212, v212
v_mfma_f32_16x16x32_bf16 v[184:187], a[204:207], a[248:251], v[184:187]
v_exp_f32 v213, v213
v_exp_f32 v214, v214
v_mfma_f32_16x16x32_bf16 v[196:199], a[232:235], a[252:255], v[196:199]
ds_read_b128 a[248:251], v2 offset:2048
v_exp_f32 v215, v215
v_add_f32 v36, v36, v208
v_add_f32 v36, v36, v209
v_mfma_f32_16x16x32_bf16 v[204:207], a[236:239], a[252:255], v[204:207]
v_add_f32 v36, v36, v210
v_add_f32 v36, v36, v211
v_add_f32 v36, v36, v212
v_mfma_f32_16x16x32_bf16 v[192:195], a[200:203], a[252:255], v[192:195]
v_add_f32 v36, v36, v213
v_add_f32 v36, v36, v214
v_add_f32 v36, v36, v215
v_cvt_pk_bf16_f32 v208, v208, v209
v_mfma_f32_16x16x32_bf16 v[200:203], a[204:207], a[252:255], v[200:203]
s_waitcnt lgkmcnt(2)
v_cvt_pk_bf16_f32 v209, v210, v211
v_cvt_pk_bf16_f32 v210, v212, v213
v_cvt_pk_bf16_f32 v211, v214, v215
v_mfma_f32_16x16x32_bf16 v[48:51], a[216:219], a[240:243], v[48:51]
ds_read_b128 a[252:255], v2 offset:3072
v_mfma_f32_16x16x32_bf16 v[52:55], a[220:223], a[240:243], v[52:55]
s_waitcnt vmcnt(12)
ds_read_b64_tr_b16 a[232:233], v8 offset:4096
v_mfma_f32_16x16x32_bf16 v[56:59], a[192:195], a[240:243], v[56:59]
ds_read_b64_tr_b16 a[234:235], v8 offset:6144
v_mfma_f32_16x16x32_bf16 v[60:63], a[196:199], a[240:243], v[60:63]
s_waitcnt lgkmcnt(4)
ds_write_b128 v7, v[208:211]
v_fma_f32 v216, v216, s28, v25
v_fma_f32 v217, v217, s28, v25
v_fma_f32 v218, v218, s28, v25
v_fma_f32 v219, v219, s28, v25
v_fma_f32 v220, v220, s28, v25
v_fma_f32 v221, v221, s28, v25
v_fma_f32 v222, v222, s28, v25
v_fma_f32 v223, v223, s28, v25
v_mfma_f32_16x16x32_bf16 v[64:67], a[216:219], a[244:247], v[64:67]
ds_read_b128 a[240:243], v2 offset:4096
v_exp_f32 v216, v216
v_mfma_f32_16x16x32_bf16 v[68:71], a[220:223], a[244:247], v[68:71]
ds_read_b64_tr_b16 a[236:237], v9 offset:4096
v_exp_f32 v217, v217
v_mfma_f32_16x16x32_bf16 v[72:75], a[192:195], a[244:247], v[72:75]
ds_read_b64_tr_b16 a[238:239], v9 offset:6144
v_exp_f32 v218, v218
v_exp_f32 v219, v219
v_mfma_f32_16x16x32_bf16 v[76:79], a[196:199], a[244:247], v[76:79]
s_waitcnt lgkmcnt(7)
v_exp_f32 v220, v220
v_mfma_f32_16x16x32_bf16 v[80:83], a[216:219], a[248:251], v[80:83]
ds_read_b128 a[244:247], v2 offset:5120
v_exp_f32 v221, v221
v_exp_f32 v222, v222
v_mfma_f32_16x16x32_bf16 v[84:87], a[220:223], a[248:251], v[84:87]
ds_read_b64_tr_b16 a[200:201], v10 offset:4096
v_exp_f32 v223, v223
v_add_f32 v37, v37, v216
v_mfma_f32_16x16x32_bf16 v[88:91], a[192:195], a[248:251], v[88:91]
ds_read_b64_tr_b16 a[202:203], v10 offset:6144
v_add_f32 v37, v37, v217
v_add_f32 v37, v37, v218
v_add_f32 v37, v37, v219
v_mfma_f32_16x16x32_bf16 v[92:95], a[196:199], a[248:251], v[92:95]
s_waitcnt lgkmcnt(9)
v_add_f32 v37, v37, v220
v_add_f32 v37, v37, v221
v_add_f32 v37, v37, v222
v_mfma_f32_16x16x32_bf16 v[96:99], a[216:219], a[252:255], v[96:99]
ds_read_b128 a[248:251], v2 offset:6144
v_add_f32 v37, v37, v223
v_cvt_pk_bf16_f32 v216, v216, v217
v_cvt_pk_bf16_f32 v217, v218, v219
v_mfma_f32_16x16x32_bf16 v[100:103], a[220:223], a[252:255], v[100:103]
ds_read_b64_tr_b16 a[204:205], v11 offset:4096
v_cvt_pk_bf16_f32 v218, v220, v221
v_cvt_pk_bf16_f32 v219, v222, v223
v_mfma_f32_16x16x32_bf16 v[104:107], a[192:195], a[252:255], v[104:107]
ds_read_b64_tr_b16 a[206:207], v11 offset:6144
v_mfma_f32_16x16x32_bf16 v[108:111], a[196:199], a[252:255], v[108:111]
s_waitcnt lgkmcnt(8)
ds_write_b128 v7, v[216:219] offset:1024
v_fma_f32 v224, v224, s28, v26
v_fma_f32 v225, v225, s28, v26
v_mfma_f32_16x16x32_bf16 v[112:115], a[216:219], a[240:243], v[112:115]
ds_read_b128 a[252:255], v2 offset:7168
v_fma_f32 v226, v226, s28, v26
v_fma_f32 v227, v227, s28, v26
v_fma_f32 v228, v228, s28, v26
v_mfma_f32_16x16x32_bf16 v[116:119], a[220:223], a[240:243], v[116:119]
v_fma_f32 v229, v229, s28, v26
v_fma_f32 v230, v230, s28, v26
v_fma_f32 v231, v231, s28, v26
v_mfma_f32_16x16x32_bf16 v[120:123], a[192:195], a[240:243], v[120:123]
v_exp_f32 v224, v224
v_exp_f32 v225, v225
v_mfma_f32_16x16x32_bf16 v[124:127], a[196:199], a[240:243], v[124:127]
s_waitcnt lgkmcnt(7)
v_exp_f32 v226, v226
v_exp_f32 v227, v227
v_mfma_f32_16x16x32_bf16 v[132:135], a[216:219], a[244:247], v[132:135]
ds_read_b128 a[240:243], v2 offset:8192
v_exp_f32 v228, v228
v_mfma_f32_16x16x32_bf16 v[140:143], a[220:223], a[244:247], v[140:143]
s_add_u32 m0, s33, 0x1000
s_add_u32 s35, s48, 0x24000
v_exp_f32 v229, v229
v_mfma_f32_16x16x32_bf16 v[128:131], a[192:195], a[244:247], v[128:131]
s_waitcnt lgkmcnt(3)
buffer_load_dwordx4 v12, s[16:19], s35 offen nt lds
v_exp_f32 v230, v230
v_exp_f32 v231, v231
v_mfma_f32_16x16x32_bf16 v[136:139], a[196:199], a[244:247], v[136:139]
v_add_f32 v38, v38, v224
v_add_f32 v38, v38, v225
v_add_f32 v38, v38, v226
v_add_f32 v38, v38, v227
v_mfma_f32_16x16x32_bf16 v[148:151], a[216:219], a[248:251], v[148:151]
ds_read_b128 a[244:247], v2 offset:9216
v_add_f32 v38, v38, v228
v_add_f32 v38, v38, v229
v_mfma_f32_16x16x32_bf16 v[156:159], a[220:223], a[248:251], v[156:159]
buffer_load_dwordx4 v13, s[16:19], s35 offen offset:1024 nt lds
v_add_f32 v38, v38, v230
v_add_f32 v38, v38, v231
v_cvt_pk_bf16_f32 v224, v224, v225
v_mfma_f32_16x16x32_bf16 v[144:147], a[192:195], a[248:251], v[144:147]
v_cvt_pk_bf16_f32 v225, v226, v227
v_cvt_pk_bf16_f32 v226, v228, v229
v_cvt_pk_bf16_f32 v227, v230, v231
v_mfma_f32_16x16x32_bf16 v[152:155], a[196:199], a[248:251], v[152:155]
s_waitcnt lgkmcnt(2)
ds_write_b128 v7, v[224:227] offset:2048
v_mfma_f32_16x16x32_bf16 v[164:167], a[216:219], a[252:255], v[164:167]
ds_read_b128 a[248:251], v2 offset:10240
v_fma_f32 v232, v232, s28, v27
v_fma_f32 v233, v233, s28, v27
v_mfma_f32_16x16x32_bf16 v[172:175], a[220:223], a[252:255], v[172:175]
buffer_load_dwordx4 v14, s[16:19], s35 offen offset:2048 nt lds
v_fma_f32 v234, v234, s28, v27
v_fma_f32 v235, v235, s28, v27
v_fma_f32 v236, v236, s28, v27
v_mfma_f32_16x16x32_bf16 v[160:163], a[192:195], a[252:255], v[160:163]
v_fma_f32 v237, v237, s28, v27
v_fma_f32 v238, v238, s28, v27
v_fma_f32 v239, v239, s28, v27
v_mfma_f32_16x16x32_bf16 v[168:171], a[196:199], a[252:255], v[168:171]
s_waitcnt lgkmcnt(3)
v_exp_f32 v232, v232
v_exp_f32 v233, v233
v_mfma_f32_16x16x32_bf16 v[180:183], a[216:219], a[240:243], v[180:183]
ds_read_b128 a[252:255], v2 offset:11264
v_exp_f32 v234, v234
v_mfma_f32_16x16x32_bf16 v[188:191], a[220:223], a[240:243], v[188:191]
buffer_load_dwordx4 v15, s[16:19], s35 offen offset:3072 nt lds
v_exp_f32 v235, v235
v_exp_f32 v236, v236
v_mfma_f32_16x16x32_bf16 v[176:179], a[192:195], a[240:243], v[176:179]
v_exp_f32 v237, v237
v_exp_f32 v238, v238
v_mfma_f32_16x16x32_bf16 v[184:187], a[196:199], a[240:243], v[184:187]
s_waitcnt lgkmcnt(3)
v_exp_f32 v239, v239
v_add_f32 v39, v39, v232
v_mfma_f32_16x16x32_bf16 v[196:199], a[216:219], a[244:247], v[196:199]
ds_read_b128 a[240:243], v2 offset:12288
v_add_f32 v39, v39, v233
v_add_f32 v39, v39, v234
v_add_f32 v39, v39, v235
v_mfma_f32_16x16x32_bf16 v[204:207], a[220:223], a[244:247], v[204:207]
v_add_f32 v39, v39, v236
v_add_f32 v39, v39, v237
v_add_f32 v39, v39, v238
v_add_f32 v39, v39, v239
v_mfma_f32_16x16x32_bf16 v[192:195], a[192:195], a[244:247], v[192:195]
v_cvt_pk_bf16_f32 v232, v232, v233
v_cvt_pk_bf16_f32 v233, v234, v235
v_cvt_pk_bf16_f32 v234, v236, v237
v_mfma_f32_16x16x32_bf16 v[200:203], a[196:199], a[244:247], v[200:203]
s_waitcnt lgkmcnt(2)
v_cvt_pk_bf16_f32 v235, v238, v239
v_mfma_f32_16x16x32_bf16 v[48:51], a[232:235], a[248:251], v[48:51]
ds_read_b128 a[244:247], v2 offset:13312
v_mfma_f32_16x16x32_bf16 v[52:55], a[236:239], a[248:251], v[52:55]
s_waitcnt vmcnt(12)
ds_read_b64_tr_b16 a[216:217], v8 offset:8192
v_mfma_f32_16x16x32_bf16 v[56:59], a[200:203], a[248:251], v[56:59]
ds_read_b64_tr_b16 a[218:219], v8 offset:10240
v_mfma_f32_16x16x32_bf16 v[60:63], a[204:207], a[248:251], v[60:63]
s_waitcnt lgkmcnt(4)
ds_write_b128 v7, v[232:235] offset:3072
v_fma_f32 v240, v240, s28, v28
v_fma_f32 v241, v241, s28, v28
v_fma_f32 v242, v242, s28, v28
v_fma_f32 v243, v243, s28, v28
v_fma_f32 v244, v244, s28, v28
v_fma_f32 v245, v245, s28, v28
v_fma_f32 v246, v246, s28, v28
v_fma_f32 v247, v247, s28, v28
v_exp_f32 v240, v240
v_mfma_f32_16x16x32_bf16 v[64:67], a[232:235], a[252:255], v[64:67]
ds_read_b128 a[248:251], v2 offset:14336
v_exp_f32 v241, v241
v_mfma_f32_16x16x32_bf16 v[68:71], a[236:239], a[252:255], v[68:71]
ds_read_b64_tr_b16 a[220:221], v9 offset:8192
v_exp_f32 v242, v242
v_mfma_f32_16x16x32_bf16 v[72:75], a[200:203], a[252:255], v[72:75]
ds_read_b64_tr_b16 a[222:223], v9 offset:10240
v_exp_f32 v243, v243
v_exp_f32 v244, v244
v_mfma_f32_16x16x32_bf16 v[76:79], a[204:207], a[252:255], v[76:79]
s_waitcnt lgkmcnt(7)
v_exp_f32 v245, v245
v_exp_f32 v246, v246
v_mfma_f32_16x16x32_bf16 v[80:83], a[232:235], a[240:243], v[80:83]
ds_read_b128 a[252:255], v2 offset:15360
v_exp_f32 v247, v247
v_mfma_f32_16x16x32_bf16 v[84:87], a[236:239], a[240:243], v[84:87]
ds_read_b64_tr_b16 a[192:193], v10 offset:8192
v_add_f32 v40, v40, v240
v_add_f32 v40, v40, v241
v_add_f32 v40, v40, v242
v_mfma_f32_16x16x32_bf16 v[88:91], a[200:203], a[240:243], v[88:91]
ds_read_b64_tr_b16 a[194:195], v10 offset:10240
v_add_f32 v40, v40, v243
v_add_f32 v40, v40, v244
v_add_f32 v40, v40, v245
v_mfma_f32_16x16x32_bf16 v[92:95], a[204:207], a[240:243], v[92:95]
s_waitcnt lgkmcnt(9)
v_add_f32 v40, v40, v246
v_add_f32 v40, v40, v247
v_cvt_pk_bf16_f32 v240, v240, v241
v_cvt_pk_bf16_f32 v241, v242, v243
v_mfma_f32_16x16x32_bf16 v[96:99], a[232:235], a[244:247], v[96:99]
ds_read_b128 a[240:243], v2 offset:16384
v_cvt_pk_bf16_f32 v242, v244, v245
v_cvt_pk_bf16_f32 v243, v246, v247
v_mfma_f32_16x16x32_bf16 v[100:103], a[236:239], a[244:247], v[100:103]
ds_read_b64_tr_b16 a[196:197], v11 offset:8192
v_mfma_f32_16x16x32_bf16 v[104:107], a[200:203], a[244:247], v[104:107]
ds_read_b64_tr_b16 a[198:199], v11 offset:10240
v_mfma_f32_16x16x32_bf16 v[108:111], a[204:207], a[244:247], v[108:111]
s_waitcnt lgkmcnt(8)
ds_write_b128 v7, v[240:243] offset:4096
v_fma_f32 v248, v248, s28, v29
v_fma_f32 v249, v249, s28, v29
v_fma_f32 v250, v250, s28, v29
v_fma_f32 v251, v251, s28, v29
v_mfma_f32_16x16x32_bf16 v[112:115], a[232:235], a[248:251], v[112:115]
ds_read_b128 a[244:247], v2 offset:17408
v_fma_f32 v252, v252, s28, v29
v_fma_f32 v253, v253, s28, v29
v_fma_f32 v254, v254, s28, v29
v_mfma_f32_16x16x32_bf16 v[116:119], a[236:239], a[248:251], v[116:119]
v_fma_f32 v255, v255, s28, v29
v_exp_f32 v248, v248
v_mfma_f32_16x16x32_bf16 v[120:123], a[200:203], a[248:251], v[120:123]
v_exp_f32 v249, v249
v_exp_f32 v250, v250
v_mfma_f32_16x16x32_bf16 v[124:127], a[204:207], a[248:251], v[124:127]
s_waitcnt lgkmcnt(7)
v_exp_f32 v251, v251
v_exp_f32 v252, v252
v_mfma_f32_16x16x32_bf16 v[132:135], a[232:235], a[252:255], v[132:135]
ds_read_b128 a[248:251], v2 offset:18432
v_exp_f32 v253, v253
v_mfma_f32_16x16x32_bf16 v[140:143], a[236:239], a[252:255], v[140:143]
s_add_u32 m0, s33, 0x2000
s_add_u32 s35, s48, 0x28000
v_exp_f32 v254, v254
v_exp_f32 v255, v255
v_mfma_f32_16x16x32_bf16 v[128:131], a[200:203], a[252:255], v[128:131]
s_waitcnt lgkmcnt(3)
buffer_load_dwordx4 v12, s[16:19], s35 offen nt lds
v_add_f32 v41, v41, v248
v_add_f32 v41, v41, v249
v_mfma_f32_16x16x32_bf16 v[136:139], a[204:207], a[252:255], v[136:139]
v_add_f32 v41, v41, v250
v_add_f32 v41, v41, v251
v_add_f32 v41, v41, v252
v_add_f32 v41, v41, v253
v_mfma_f32_16x16x32_bf16 v[148:151], a[232:235], a[240:243], v[148:151]
ds_read_b128 a[252:255], v2 offset:19456
v_add_f32 v41, v41, v254
v_add_f32 v41, v41, v255
v_cvt_pk_bf16_f32 v248, v248, v249
v_mfma_f32_16x16x32_bf16 v[156:159], a[236:239], a[240:243], v[156:159]
buffer_load_dwordx4 v13, s[16:19], s35 offen offset:1024 nt lds
v_cvt_pk_bf16_f32 v249, v250, v251
v_cvt_pk_bf16_f32 v250, v252, v253
v_cvt_pk_bf16_f32 v251, v254, v255
v_mfma_f32_16x16x32_bf16 v[144:147], a[200:203], a[240:243], v[144:147]
ds_write_b128 v7, v[248:251] offset:5120
v_mfma_f32_16x16x32_bf16 v[152:155], a[204:207], a[240:243], v[152:155]
s_waitcnt lgkmcnt(3)
v_accvgpr_read_b32 v212, a0
v_accvgpr_read_b32 v213, a1
v_mfma_f32_16x16x32_bf16 v[164:167], a[232:235], a[244:247], v[164:167]
ds_read_b128 a[240:243], v2 offset:20480
v_accvgpr_read_b32 v214, a2
v_accvgpr_read_b32 v215, a3
v_accvgpr_read_b32 v208, a4
v_mfma_f32_16x16x32_bf16 v[172:175], a[236:239], a[244:247], v[172:175]
buffer_load_dwordx4 v14, s[16:19], s35 offen offset:2048 nt lds
v_accvgpr_read_b32 v209, a5
v_accvgpr_read_b32 v210, a6
v_mfma_f32_16x16x32_bf16 v[160:163], a[200:203], a[244:247], v[160:163]
v_accvgpr_read_b32 v211, a7
v_fma_f32 v212, v212, s28, v30
v_fma_f32 v213, v213, s28, v30
v_fma_f32 v214, v214, s28, v30
v_mfma_f32_16x16x32_bf16 v[168:171], a[204:207], a[244:247], v[168:171]
s_waitcnt lgkmcnt(3)
v_fma_f32 v215, v215, s28, v30
v_fma_f32 v208, v208, s28, v30
v_fma_f32 v209, v209, s28, v30
v_fma_f32 v210, v210, s28, v30
v_mfma_f32_16x16x32_bf16 v[180:183], a[232:235], a[248:251], v[180:183]
ds_read_b128 a[244:247], v2 offset:21504
v_fma_f32 v211, v211, s28, v30
v_mfma_f32_16x16x32_bf16 v[188:191], a[236:239], a[248:251], v[188:191]
buffer_load_dwordx4 v15, s[16:19], s35 offen offset:3072 nt lds
v_exp_f32 v212, v212
v_exp_f32 v213, v213
v_mfma_f32_16x16x32_bf16 v[176:179], a[200:203], a[248:251], v[176:179]
v_exp_f32 v214, v214
v_exp_f32 v215, v215
v_mfma_f32_16x16x32_bf16 v[184:187], a[204:207], a[248:251], v[184:187]
s_waitcnt lgkmcnt(3)
v_exp_f32 v208, v208
v_exp_f32 v209, v209
v_mfma_f32_16x16x32_bf16 v[196:199], a[232:235], a[252:255], v[196:199]
ds_read_b128 a[248:251], v2 offset:22528
v_exp_f32 v210, v210
v_mfma_f32_16x16x32_bf16 v[204:207], a[236:239], a[252:255], v[204:207]
v_exp_f32 v211, v211
v_add_f32 v42, v42, v212
v_add_f32 v42, v42, v213
v_mfma_f32_16x16x32_bf16 v[192:195], a[200:203], a[252:255], v[192:195]
v_add_f32 v42, v42, v214
v_add_f32 v42, v42, v215
v_add_f32 v42, v42, v208
v_add_f32 v42, v42, v209
v_mfma_f32_16x16x32_bf16 v[200:203], a[204:207], a[252:255], v[200:203]
s_waitcnt lgkmcnt(2)
v_add_f32 v42, v42, v210
v_add_f32 v42, v42, v211
v_cvt_pk_bf16_f32 v212, v212, v213
v_mfma_f32_16x16x32_bf16 v[48:51], a[216:219], a[240:243], v[48:51]
ds_read_b128 a[252:255], v2 offset:23552
v_cvt_pk_bf16_f32 v213, v214, v215
v_cvt_pk_bf16_f32 v214, v208, v209
v_cvt_pk_bf16_f32 v215, v210, v211
v_mfma_f32_16x16x32_bf16 v[52:55], a[220:223], a[240:243], v[52:55]
s_waitcnt vmcnt(12)
ds_read_b64_tr_b16 a[232:233], v8 offset:12288
v_mfma_f32_16x16x32_bf16 v[56:59], a[192:195], a[240:243], v[56:59]
ds_read_b64_tr_b16 a[234:235], v8 offset:14336
v_mfma_f32_16x16x32_bf16 v[60:63], a[196:199], a[240:243], v[60:63]
s_waitcnt lgkmcnt(4)
ds_write_b128 v7, v[212:215] offset:6144
v_accvgpr_read_b32 v220, a8
v_accvgpr_read_b32 v221, a9
v_accvgpr_read_b32 v222, a10
v_accvgpr_read_b32 v223, a11
v_mfma_f32_16x16x32_bf16 v[64:67], a[216:219], a[244:247], v[64:67]
ds_read_b128 a[240:243], v2 offset:24576
v_accvgpr_read_b32 v216, a12
v_accvgpr_read_b32 v217, a13
v_accvgpr_read_b32 v218, a14
v_mfma_f32_16x16x32_bf16 v[68:71], a[220:223], a[244:247], v[68:71]
ds_read_b64_tr_b16 a[236:237], v9 offset:12288
v_accvgpr_read_b32 v219, a15
v_fma_f32 v220, v220, s28, v31
v_fma_f32 v221, v221, s28, v31
v_mfma_f32_16x16x32_bf16 v[72:75], a[192:195], a[244:247], v[72:75]
ds_read_b64_tr_b16 a[238:239], v9 offset:14336
v_fma_f32 v222, v222, s28, v31
v_fma_f32 v223, v223, s28, v31
v_mfma_f32_16x16x32_bf16 v[76:79], a[196:199], a[244:247], v[76:79]
s_waitcnt lgkmcnt(7)
v_fma_f32 v216, v216, s28, v31
v_fma_f32 v217, v217, s28, v31
v_fma_f32 v218, v218, s28, v31
v_fma_f32 v219, v219, s28, v31
v_mfma_f32_16x16x32_bf16 v[80:83], a[216:219], a[248:251], v[80:83]
ds_read_b128 a[244:247], v2 offset:25600
v_exp_f32 v220, v220
v_mfma_f32_16x16x32_bf16 v[84:87], a[220:223], a[248:251], v[84:87]
ds_read_b64_tr_b16 a[200:201], v10 offset:12288
v_exp_f32 v221, v221
v_mfma_f32_16x16x32_bf16 v[88:91], a[192:195], a[248:251], v[88:91]
ds_read_b64_tr_b16 a[202:203], v10 offset:14336
v_exp_f32 v222, v222
v_exp_f32 v223, v223
v_mfma_f32_16x16x32_bf16 v[92:95], a[196:199], a[248:251], v[92:95]
s_waitcnt lgkmcnt(9)
v_exp_f32 v216, v216
v_exp_f32 v217, v217
v_mfma_f32_16x16x32_bf16 v[96:99], a[216:219], a[252:255], v[96:99]
ds_read_b128 a[248:251], v2 offset:26624
v_exp_f32 v218, v218
v_mfma_f32_16x16x32_bf16 v[100:103], a[220:223], a[252:255], v[100:103]
ds_read_b64_tr_b16 a[204:205], v11 offset:12288
v_exp_f32 v219, v219
v_add_f32 v43, v43, v220
v_mfma_f32_16x16x32_bf16 v[104:107], a[192:195], a[252:255], v[104:107]
ds_read_b64_tr_b16 a[206:207], v11 offset:14336
v_add_f32 v43, v43, v221
v_add_f32 v43, v43, v222
v_add_f32 v43, v43, v223
v_mfma_f32_16x16x32_bf16 v[108:111], a[196:199], a[252:255], v[108:111]
s_waitcnt lgkmcnt(8)
v_add_f32 v43, v43, v216
v_add_f32 v43, v43, v217
v_add_f32 v43, v43, v218
v_add_f32 v43, v43, v219
v_mfma_f32_16x16x32_bf16 v[112:115], a[216:219], a[240:243], v[112:115]
ds_read_b128 a[252:255], v2 offset:27648
v_cvt_pk_bf16_f32 v220, v220, v221
v_cvt_pk_bf16_f32 v221, v222, v223
v_mfma_f32_16x16x32_bf16 v[116:119], a[220:223], a[240:243], v[116:119]
v_cvt_pk_bf16_f32 v222, v216, v217
v_cvt_pk_bf16_f32 v223, v218, v219
v_mfma_f32_16x16x32_bf16 v[120:123], a[192:195], a[240:243], v[120:123]
ds_write_b128 v7, v[220:223] offset:7168
v_accvgpr_read_b32 v228, a16
v_mfma_f32_16x16x32_bf16 v[124:127], a[196:199], a[240:243], v[124:127]
s_waitcnt lgkmcnt(7)
v_accvgpr_read_b32 v229, a17
v_accvgpr_read_b32 v230, a18
v_accvgpr_read_b32 v231, a19
v_accvgpr_read_b32 v224, a20
v_mfma_f32_16x16x32_bf16 v[132:135], a[216:219], a[244:247], v[132:135]
ds_read_b128 a[240:243], v2 offset:28672
v_accvgpr_read_b32 v225, a21
v_accvgpr_read_b32 v226, a22
v_mfma_f32_16x16x32_bf16 v[140:143], a[220:223], a[244:247], v[140:143]
s_add_u32 m0, s33, 0x3000
s_add_u32 s35, s48, 0x2c000
v_accvgpr_read_b32 v227, a23
v_fma_f32 v228, v228, s28, v32
v_fma_f32 v229, v229, s28, v32
v_mfma_f32_16x16x32_bf16 v[128:131], a[192:195], a[244:247], v[128:131]
s_waitcnt lgkmcnt(3)
buffer_load_dwordx4 v12, s[16:19], s35 offen nt lds
v_fma_f32 v230, v230, s28, v32
v_fma_f32 v231, v231, s28, v32
v_fma_f32 v224, v224, s28, v32
v_mfma_f32_16x16x32_bf16 v[136:139], a[196:199], a[244:247], v[136:139]
v_fma_f32 v225, v225, s28, v32
v_fma_f32 v226, v226, s28, v32
v_fma_f32 v227, v227, s28, v32
v_mfma_f32_16x16x32_bf16 v[148:151], a[216:219], a[248:251], v[148:151]
ds_read_b128 a[244:247], v2 offset:29696
v_exp_f32 v228, v228
v_mfma_f32_16x16x32_bf16 v[156:159], a[220:223], a[248:251], v[156:159]
buffer_load_dwordx4 v13, s[16:19], s35 offen offset:1024 nt lds
v_exp_f32 v229, v229
v_exp_f32 v230, v230
v_mfma_f32_16x16x32_bf16 v[144:147], a[192:195], a[248:251], v[144:147]
v_exp_f32 v231, v231
v_exp_f32 v224, v224
v_mfma_f32_16x16x32_bf16 v[152:155], a[196:199], a[248:251], v[152:155]
s_waitcnt lgkmcnt(3)
v_exp_f32 v225, v225
v_mfma_f32_16x16x32_bf16 v[164:167], a[216:219], a[252:255], v[164:167]
ds_read_b128 a[248:251], v2 offset:30720
v_exp_f32 v226, v226
v_exp_f32 v227, v227
v_mfma_f32_16x16x32_bf16 v[172:175], a[220:223], a[252:255], v[172:175]
buffer_load_dwordx4 v14, s[16:19], s35 offen offset:2048 nt lds
v_add_f32 v44, v44, v228
v_add_f32 v44, v44, v229
v_add_f32 v44, v44, v230
v_mfma_f32_16x16x32_bf16 v[160:163], a[192:195], a[252:255], v[160:163]
v_add_f32 v44, v44, v231
v_add_f32 v44, v44, v224
v_add_f32 v44, v44, v225
v_mfma_f32_16x16x32_bf16 v[168:171], a[196:199], a[252:255], v[168:171]
s_waitcnt lgkmcnt(2)
v_add_f32 v44, v44, v226
v_add_f32 v44, v44, v227
v_cvt_pk_bf16_f32 v228, v228, v229
v_cvt_pk_bf16_f32 v229, v230, v231
v_mfma_f32_16x16x32_bf16 v[180:183], a[216:219], a[240:243], v[180:183]
ds_read_b128 a[252:255], v2 offset:31744
v_cvt_pk_bf16_f32 v230, v224, v225
v_cvt_pk_bf16_f32 v231, v226, v227
v_mfma_f32_16x16x32_bf16 v[188:191], a[220:223], a[240:243], v[188:191]
buffer_load_dwordx4 v15, s[16:19], s35 offen offset:3072 nt lds
v_mfma_f32_16x16x32_bf16 v[176:179], a[192:195], a[240:243], v[176:179]
ds_write_b128 v7, v[228:231] offset:8192
v_accvgpr_read_b32 v236, a24
v_accvgpr_read_b32 v237, a25
v_mfma_f32_16x16x32_bf16 v[184:187], a[196:199], a[240:243], v[184:187]
s_waitcnt lgkmcnt(3)
v_accvgpr_read_b32 v238, a26
v_accvgpr_read_b32 v239, a27
v_accvgpr_read_b32 v232, a28
v_accvgpr_read_b32 v233, a29
v_mfma_f32_16x16x32_bf16 v[196:199], a[216:219], a[244:247], v[196:199]
ds_read_b128 a[240:243], v2 offset:32768
v_accvgpr_read_b32 v234, a30
v_accvgpr_read_b32 v235, a31
v_fma_f32 v236, v236, s28, v33
v_mfma_f32_16x16x32_bf16 v[204:207], a[220:223], a[244:247], v[204:207]
s_mov_b32 m0, s49
s_add_u32 s38, s38, s39
v_fma_f32 v237, v237, s28, v33
v_fma_f32 v238, v238, s28, v33
v_mfma_f32_16x16x32_bf16 v[192:195], a[192:195], a[244:247], v[192:195]
s_sub_u32 s36, s38, s39
buffer_load_dwordx4 v0, s[8:11], s36 offen lds
v_fma_f32 v239, v239, s28, v33
v_fma_f32 v232, v232, s28, v33
v_fma_f32 v233, v233, s28, v33
v_mfma_f32_16x16x32_bf16 v[200:203], a[196:199], a[244:247], v[200:203]
s_waitcnt lgkmcnt(3)
v_fma_f32 v234, v234, s28, v33
v_fma_f32 v235, v235, s28, v33
v_exp_f32 v236, v236
v_mfma_f32_16x16x32_bf16 v[48:51], a[232:235], a[248:251], v[48:51]
ds_read_b128 a[244:247], v2 offset:33792
v_exp_f32 v237, v237
v_mfma_f32_16x16x32_bf16 v[52:55], a[236:239], a[248:251], v[52:55]
s_waitcnt vmcnt(13)
ds_read_b64_tr_b16 a[216:217], v8
v_exp_f32 v238, v238
v_mfma_f32_16x16x32_bf16 v[56:59], a[200:203], a[248:251], v[56:59]
ds_read_b64_tr_b16 a[218:219], v8 offset:2048
v_exp_f32 v239, v239
v_exp_f32 v232, v232
v_mfma_f32_16x16x32_bf16 v[60:63], a[204:207], a[248:251], v[60:63]
s_waitcnt lgkmcnt(5)
v_exp_f32 v233, v233
v_exp_f32 v234, v234
v_mfma_f32_16x16x32_bf16 v[64:67], a[232:235], a[252:255], v[64:67]
ds_read_b128 a[248:251], v2 offset:34816
v_exp_f32 v235, v235
v_mfma_f32_16x16x32_bf16 v[68:71], a[236:239], a[252:255], v[68:71]
ds_read_b64_tr_b16 a[220:221], v9
v_add_f32 v45, v45, v236
v_add_f32 v45, v45, v237
v_add_f32 v45, v45, v238
v_mfma_f32_16x16x32_bf16 v[72:75], a[200:203], a[252:255], v[72:75]
ds_read_b64_tr_b16 a[222:223], v9 offset:2048
v_accvgpr_read_b32 v46, a208
v_mul_f32 v48, v48, v46
v_add_f32 v45, v45, v239
v_mfma_f32_16x16x32_bf16 v[76:79], a[204:207], a[252:255], v[76:79]
s_waitcnt lgkmcnt(6)
v_mul_f32 v49, v49, v46
v_mul_f32 v50, v50, v46
v_mul_f32 v51, v51, v46
v_add_f32 v45, v45, v232
v_mfma_f32_16x16x32_bf16 v[80:83], a[232:235], a[240:243], v[80:83]
ds_read_b128 a[252:255], v2 offset:35840
v_mul_f32 v52, v52, v46
v_mul_f32 v53, v53, v46
v_mfma_f32_16x16x32_bf16 v[84:87], a[236:239], a[240:243], v[84:87]
ds_read_b64_tr_b16 a[192:193], v10
v_mul_f32 v54, v54, v46
v_mul_f32 v55, v55, v46
v_mul_f32 v56, v56, v46
v_mfma_f32_16x16x32_bf16 v[88:91], a[200:203], a[240:243], v[88:91]
ds_read_b64_tr_b16 a[194:195], v10 offset:2048
v_mul_f32 v57, v57, v46
v_mul_f32 v58, v58, v46
v_add_f32 v45, v45, v233
v_mfma_f32_16x16x32_bf16 v[92:95], a[204:207], a[240:243], v[92:95]
s_waitcnt lgkmcnt(8)
v_mul_f32 v59, v59, v46
v_mul_f32 v60, v60, v46
v_mul_f32 v61, v61, v46
v_add_f32 v45, v45, v234
v_mfma_f32_16x16x32_bf16 v[96:99], a[232:235], a[244:247], v[96:99]
ds_read_b128 a[240:243], v2 offset:36864
v_mul_f32 v62, v62, v46
v_mul_f32 v63, v63, v46
v_add_f32 v45, v45, v235
v_mfma_f32_16x16x32_bf16 v[100:103], a[236:239], a[244:247], v[100:103]
ds_read_b64_tr_b16 a[196:197], v11
v_accvgpr_read_b32 v47, a209
v_mul_f32 v64, v64, v47
v_mul_f32 v65, v65, v47
v_mfma_f32_16x16x32_bf16 v[104:107], a[200:203], a[244:247], v[104:107]
ds_read_b64_tr_b16 a[198:199], v11 offset:2048
v_mul_f32 v66, v66, v47
v_mul_f32 v67, v67, v47
v_mfma_f32_16x16x32_bf16 v[108:111], a[204:207], a[244:247], v[108:111]
s_waitcnt lgkmcnt(8)
v_mul_f32 v68, v68, v47
v_mul_f32 v69, v69, v47
v_mul_f32 v70, v70, v47
v_cvt_pk_bf16_f32 v236, v236, v237
v_mfma_f32_16x16x32_bf16 v[112:115], a[232:235], a[248:251], v[112:115]
ds_read_b128 a[244:247], v2 offset:37888
v_mul_f32 v71, v71, v47
v_mul_f32 v72, v72, v47
v_cvt_pk_bf16_f32 v237, v238, v239
v_mfma_f32_16x16x32_bf16 v[116:119], a[236:239], a[248:251], v[116:119]
v_mul_f32 v73, v73, v47
v_mul_f32 v74, v74, v47
v_mul_f32 v75, v75, v47
v_mul_f32 v76, v76, v47
v_mfma_f32_16x16x32_bf16 v[120:123], a[200:203], a[248:251], v[120:123]
v_mul_f32 v77, v77, v47
v_mul_f32 v78, v78, v47
v_mul_f32 v79, v79, v47
v_cvt_pk_bf16_f32 v238, v232, v233
v_mfma_f32_16x16x32_bf16 v[124:127], a[204:207], a[248:251], v[124:127]
s_waitcnt lgkmcnt(6)
v_accvgpr_read_b32 v35, a210
v_mul_f32 v80, v80, v35
v_mul_f32 v81, v81, v35
v_cvt_pk_bf16_f32 v239, v234, v235
v_mfma_f32_16x16x32_bf16 v[132:135], a[232:235], a[252:255], v[132:135]
ds_read_b128 a[248:251], v2 offset:38912
v_mul_f32 v82, v82, v35
v_mul_f32 v83, v83, v35
v_mfma_f32_16x16x32_bf16 v[140:143], a[236:239], a[252:255], v[140:143]
s_add_u32 m0, s33, 0
s_add_u32 s35, s48, 0x30000
v_mul_f32 v84, v84, v35
v_mul_f32 v85, v85, v35
v_mfma_f32_16x16x32_bf16 v[128:131], a[200:203], a[252:255], v[128:131]
s_waitcnt lgkmcnt(2)
buffer_load_dwordx4 v12, s[16:19], s35 offen nt lds
v_mul_f32 v86, v86, v35
v_mul_f32 v87, v87, v35
v_mul_f32 v88, v88, v35
v_mfma_f32_16x16x32_bf16 v[136:139], a[204:207], a[252:255], v[136:139]
v_mul_f32 v89, v89, v35
v_mul_f32 v90, v90, v35
v_mul_f32 v91, v91, v35
v_mfma_f32_16x16x32_bf16 v[148:151], a[232:235], a[240:243], v[148:151]
ds_read_b128 a[252:255], v2 offset:39936
v_mul_f32 v92, v92, v35
v_mul_f32 v93, v93, v35
v_mfma_f32_16x16x32_bf16 v[156:159], a[236:239], a[240:243], v[156:159]
buffer_load_dwordx4 v13, s[16:19], s35 offen offset:1024 nt lds
v_mul_f32 v94, v94, v35
v_mul_f32 v95, v95, v35
v_mfma_f32_16x16x32_bf16 v[144:147], a[200:203], a[240:243], v[144:147]
v_accvgpr_read_b32 v34, a211
v_mul_f32 v96, v96, v34
v_mul_f32 v97, v97, v34
v_mfma_f32_16x16x32_bf16 v[152:155], a[204:207], a[240:243], v[152:155]
s_waitcnt lgkmcnt(2)
v_mul_f32 v98, v98, v34
v_mul_f32 v99, v99, v34
v_mul_f32 v100, v100, v34
ds_write_b128 v7, v[236:239] offset:9216
v_mfma_f32_16x16x32_bf16 v[164:167], a[232:235], a[244:247], v[164:167]
s_waitcnt lgkmcnt(0)
s_barrier
ds_read_b128 a[240:243], v1
v_mul_f32 v101, v101, v34
v_mfma_f32_16x16x32_bf16 v[172:175], a[236:239], a[244:247], v[172:175]
buffer_load_dwordx4 v14, s[16:19], s35 offen offset:2048 nt lds
v_mul_f32 v102, v102, v34
v_mul_f32 v103, v103, v34
v_accvgpr_read_b32 v244, a32
v_accvgpr_read_b32 v245, a33
v_mfma_f32_16x16x32_bf16 v[160:163], a[200:203], a[244:247], v[160:163]
v_mul_f32 v104, v104, v34
v_mul_f32 v105, v105, v34
v_mul_f32 v106, v106, v34
v_accvgpr_read_b32 v246, a34
v_mfma_f32_16x16x32_bf16 v[168:171], a[204:207], a[244:247], v[168:171]
v_mul_f32 v107, v107, v34
v_mul_f32 v108, v108, v34
v_mul_f32 v109, v109, v34
v_accvgpr_read_b32 v247, a35
v_accvgpr_read_b32 v240, a36
v_mfma_f32_16x16x32_bf16 v[180:183], a[232:235], a[248:251], v[180:183]
ds_read_b128 a[244:247], v1 offset:1024
v_mul_f32 v110, v110, v34
v_mul_f32 v111, v111, v34
v_accvgpr_read_b32 v241, a37
v_mfma_f32_16x16x32_bf16 v[188:191], a[236:239], a[248:251], v[188:191]
buffer_load_dwordx4 v15, s[16:19], s35 offen offset:3072 nt lds
v_accvgpr_read_b32 v46, a212
v_mul_f32 v112, v112, v46
v_mul_f32 v113, v113, v46
v_accvgpr_read_b32 v242, a38
v_mfma_f32_16x16x32_bf16 v[176:179], a[200:203], a[248:251], v[176:179]
v_mul_f32 v114, v114, v46
v_mul_f32 v115, v115, v46
v_mul_f32 v116, v116, v46
v_accvgpr_read_b32 v243, a39
v_fma_f32 v244, v244, s28, v24
v_mfma_f32_16x16x32_bf16 v[184:187], a[204:207], a[248:251], v[184:187]
v_mul_f32 v117, v117, v46
v_mul_f32 v118, v118, v46
v_mul_f32 v119, v119, v46
v_mul_f32 v120, v120, v46
v_mfma_f32_16x16x32_bf16 v[196:199], a[232:235], a[252:255], v[196:199]
ds_read_b128 a[248:251], v1 offset:2048
v_mul_f32 v121, v121, v46
v_mul_f32 v122, v122, v46
v_fma_f32 v245, v245, s28, v24
v_fma_f32 v246, v246, s28, v24
v_mfma_f32_16x16x32_bf16 v[204:207], a[236:239], a[252:255], v[204:207]
s_mov_b32 m0, s49
s_add_u32 s38, s38, s39
v_mul_f32 v123, v123, v46
v_mul_f32 v124, v124, v46
v_mul_f32 v125, v125, v46
v_mfma_f32_16x16x32_bf16 v[192:195], a[200:203], a[252:255], v[192:195]
s_sub_u32 s36, s38, s39
buffer_load_dwordx4 v0, s[8:11], s36 offen lds
v_mul_f32 v126, v126, v46
v_mul_f32 v127, v127, v46
v_fma_f32 v247, v247, s28, v24
v_fma_f32 v240, v240, s28, v24
v_mfma_f32_16x16x32_bf16 v[200:203], a[204:207], a[252:255], v[200:203]
s_waitcnt lgkmcnt(2)
v_accvgpr_read_b32 v47, a213
v_mul_f32 v132, v132, v47
v_mul_f32 v133, v133, v47
v_fma_f32 v241, v241, s28, v24
v_fma_f32 v242, v242, s28, v24
v_mfma_f32_16x16x32_bf16 v[48:51], a[216:219], a[240:243], v[48:51]
ds_read_b128 a[252:255], v1 offset:3072
v_mul_f32 v134, v134, v47
v_mul_f32 v135, v135, v47
v_fma_f32 v243, v243, s28, v24
v_mfma_f32_16x16x32_bf16 v[52:55], a[220:223], a[240:243], v[52:55]
s_waitcnt vmcnt(14)
ds_read_b64_tr_b16 a[232:233], v8 offset:4096
v_mul_f32 v140, v140, v47
v_mul_f32 v141, v141, v47
v_exp_f32 v244, v244
v_mfma_f32_16x16x32_bf16 v[56:59], a[192:195], a[240:243], v[56:59]
ds_read_b64_tr_b16 a[234:235], v8 offset:6144
v_mul_f32 v142, v142, v47
v_mul_f32 v143, v143, v47
v_mul_f32 v128, v128, v47
v_mfma_f32_16x16x32_bf16 v[60:63], a[196:199], a[240:243], v[60:63]
s_waitcnt lgkmcnt(4)
v_mul_f32 v129, v129, v47
v_mul_f32 v130, v130, v47
v_mul_f32 v131, v131, v47
v_exp_f32 v245, v245
v_mfma_f32_16x16x32_bf16 v[64:67], a[216:219], a[244:247], v[64:67]
ds_read_b128 a[240:243], v1 offset:4096
v_mul_f32 v136, v136, v47
v_mul_f32 v137, v137, v47
v_mfma_f32_16x16x32_bf16 v[68:71], a[220:223], a[244:247], v[68:71]
ds_read_b64_tr_b16 a[236:237], v9 offset:4096
v_mul_f32 v138, v138, v47
v_mul_f32 v139, v139, v47
v_exp_f32 v246, v246
v_mfma_f32_16x16x32_bf16 v[72:75], a[192:195], a[244:247], v[72:75]
ds_read_b64_tr_b16 a[238:239], v9 offset:6144
v_accvgpr_read_b32 v35, a214
v_mul_f32 v148, v148, v35
v_exp_f32 v247, v247
v_mfma_f32_16x16x32_bf16 v[76:79], a[196:199], a[244:247], v[76:79]
s_waitcnt lgkmcnt(6)
v_mul_f32 v149, v149, v35
v_mul_f32 v150, v150, v35
v_mul_f32 v151, v151, v35
v_exp_f32 v240, v240
v_mfma_f32_16x16x32_bf16 v[80:83], a[216:219], a[248:251], v[80:83]
ds_read_b128 a[244:247], v1 offset:5120
v_mul_f32 v156, v156, v35
v_mul_f32 v157, v157, v35
v_exp_f32 v241, v241
v_mfma_f32_16x16x32_bf16 v[84:87], a[220:223], a[248:251], v[84:87]
ds_read_b64_tr_b16 a[200:201], v10 offset:4096
v_mul_f32 v158, v158, v35
v_mul_f32 v159, v159, v35
v_mul_f32 v144, v144, v35
v_mfma_f32_16x16x32_bf16 v[88:91], a[192:195], a[248:251], v[88:91]
ds_read_b64_tr_b16 a[202:203], v10 offset:6144
v_mul_f32 v145, v145, v35
v_mul_f32 v146, v146, v35
v_exp_f32 v242, v242
v_mfma_f32_16x16x32_bf16 v[92:95], a[196:199], a[248:251], v[92:95]
s_waitcnt lgkmcnt(8)
v_mul_f32 v147, v147, v35
v_mul_f32 v152, v152, v35
v_mul_f32 v153, v153, v35
v_exp_f32 v243, v243
v_mfma_f32_16x16x32_bf16 v[96:99], a[216:219], a[252:255], v[96:99]
ds_read_b128 a[248:251], v1 offset:6144
v_mul_f32 v154, v154, v35
v_mul_f32 v155, v155, v35
v_add_f32 v36, v36, v244
v_mfma_f32_16x16x32_bf16 v[100:103], a[220:223], a[252:255], v[100:103]
ds_read_b64_tr_b16 a[204:205], v11 offset:4096
v_accvgpr_read_b32 v34, a215
v_mul_f32 v164, v164, v34
v_mul_f32 v165, v165, v34
v_add_f32 v36, v36, v245
v_mfma_f32_16x16x32_bf16 v[104:107], a[192:195], a[252:255], v[104:107]
ds_read_b64_tr_b16 a[206:207], v11 offset:6144
v_mul_f32 v166, v166, v34
v_mul_f32 v167, v167, v34
v_add_f32 v36, v36, v246
v_mfma_f32_16x16x32_bf16 v[108:111], a[196:199], a[252:255], v[108:111]
s_waitcnt lgkmcnt(8)
v_mul_f32 v172, v172, v34
v_mul_f32 v173, v173, v34
v_mul_f32 v174, v174, v34
v_add_f32 v36, v36, v247
v_add_f32 v36, v36, v240
v_mfma_f32_16x16x32_bf16 v[112:115], a[216:219], a[240:243], v[112:115]
ds_read_b128 a[252:255], v1 offset:7168
v_mul_f32 v175, v175, v34
v_mul_f32 v160, v160, v34
v_add_f32 v36, v36, v241
v_add_f32 v36, v36, v242
v_mfma_f32_16x16x32_bf16 v[116:119], a[220:223], a[240:243], v[116:119]
v_mul_f32 v161, v161, v34
v_mul_f32 v162, v162, v34
v_mul_f32 v163, v163, v34
v_mul_f32 v168, v168, v34
v_mfma_f32_16x16x32_bf16 v[120:123], a[192:195], a[240:243], v[120:123]
v_mul_f32 v169, v169, v34
v_mul_f32 v170, v170, v34
v_mul_f32 v171, v171, v34
v_add_f32 v36, v36, v243
v_cvt_pk_bf16_f32 v244, v244, v245
v_mfma_f32_16x16x32_bf16 v[124:127], a[196:199], a[240:243], v[124:127]
s_waitcnt lgkmcnt(6)
v_accvgpr_read_b32 v46, a224
v_mul_f32 v180, v180, v46
v_mul_f32 v181, v181, v46
v_cvt_pk_bf16_f32 v245, v246, v247
v_mfma_f32_16x16x32_bf16 v[132:135], a[216:219], a[244:247], v[132:135]
ds_read_b128 a[240:243], v1 offset:8192
v_mul_f32 v182, v182, v46
v_mul_f32 v183, v183, v46
v_cvt_pk_bf16_f32 v246, v240, v241
v_cvt_pk_bf16_f32 v247, v242, v243
v_mfma_f32_16x16x32_bf16 v[140:143], a[220:223], a[244:247], v[140:143]
s_add_u32 m0, s33, 0x1000
s_add_u32 s35, s48, 0x34000
v_mul_f32 v188, v188, v46
v_mul_f32 v189, v189, v46
v_mfma_f32_16x16x32_bf16 v[128:131], a[192:195], a[244:247], v[128:131]
s_waitcnt lgkmcnt(2)
buffer_load_dwordx4 v12, s[16:19], s35 offen nt lds
v_mul_f32 v190, v190, v46
v_mul_f32 v191, v191, v46
v_mul_f32 v176, v176, v46
v_mfma_f32_16x16x32_bf16 v[136:139], a[196:199], a[244:247], v[136:139]
v_mul_f32 v177, v177, v46
v_mul_f32 v178, v178, v46
v_mul_f32 v179, v179, v46
v_mfma_f32_16x16x32_bf16 v[148:151], a[216:219], a[248:251], v[148:151]
ds_read_b128 a[244:247], v1 offset:9216
v_mul_f32 v184, v184, v46
v_mul_f32 v185, v185, v46
v_mfma_f32_16x16x32_bf16 v[156:159], a[220:223], a[248:251], v[156:159]
buffer_load_dwordx4 v13, s[16:19], s35 offen offset:1024 nt lds
v_mul_f32 v186, v186, v46
v_mul_f32 v187, v187, v46
v_mfma_f32_16x16x32_bf16 v[144:147], a[192:195], a[248:251], v[144:147]
v_accvgpr_read_b32 v47, a225
v_mul_f32 v196, v196, v47
v_mul_f32 v197, v197, v47
v_mfma_f32_16x16x32_bf16 v[152:155], a[196:199], a[248:251], v[152:155]
s_waitcnt lgkmcnt(2)
v_mul_f32 v198, v198, v47
v_mul_f32 v199, v199, v47
v_mul_f32 v204, v204, v47
v_mfma_f32_16x16x32_bf16 v[164:167], a[216:219], a[252:255], v[164:167]
ds_read_b128 a[248:251], v1 offset:10240
v_mul_f32 v205, v205, v47
v_mul_f32 v206, v206, v47
v_mfma_f32_16x16x32_bf16 v[172:175], a[220:223], a[252:255], v[172:175]
buffer_load_dwordx4 v14, s[16:19], s35 offen offset:2048 nt lds
v_mul_f32 v207, v207, v47
v_mfma_f32_16x16x32_bf16 v[160:163], a[192:195], a[252:255], v[160:163]
v_mul_f32 v192, v192, v47
v_mul_f32 v193, v193, v47
v_mul_f32 v194, v194, v47
v_mfma_f32_16x16x32_bf16 v[168:171], a[196:199], a[252:255], v[168:171]
s_waitcnt lgkmcnt(2)
v_mul_f32 v195, v195, v47
v_mul_f32 v200, v200, v47
v_mul_f32 v201, v201, v47
v_mfma_f32_16x16x32_bf16 v[180:183], a[216:219], a[240:243], v[180:183]
ds_read_b128 a[252:255], v1 offset:11264
v_mul_f32 v202, v202, v47
v_mul_f32 v203, v203, v47
v_mfma_f32_16x16x32_bf16 v[188:191], a[220:223], a[240:243], v[188:191]
buffer_load_dwordx4 v15, s[16:19], s35 offen offset:3072 nt lds
v_mfma_f32_16x16x32_bf16 v[176:179], a[192:195], a[240:243], v[176:179]
ds_write_b128 v7, v[244:247] offset:40960
v_accvgpr_read_b32 v252, a40
v_accvgpr_read_b32 v253, a41
v_accvgpr_read_b32 v254, a42
v_accvgpr_read_b32 v255, a43
v_accvgpr_read_b32 v248, a44
v_accvgpr_read_b32 v249, a45
v_accvgpr_read_b32 v250, a46
v_accvgpr_read_b32 v251, a47
v_fma_f32 v252, v252, s28, v25
v_fma_f32 v253, v253, s28, v25
v_fma_f32 v254, v254, s28, v25
v_fma_f32 v255, v255, s28, v25
v_fma_f32 v248, v248, s28, v25
v_fma_f32 v249, v249, s28, v25
v_fma_f32 v250, v250, s28, v25
v_fma_f32 v251, v251, s28, v25
v_exp_f32 v252, v252
v_exp_f32 v253, v253
v_exp_f32 v254, v254
v_mfma_f32_16x16x32_bf16 v[184:187], a[196:199], a[240:243], v[184:187]
s_waitcnt lgkmcnt(3)
v_exp_f32 v255, v255
v_exp_f32 v248, v248
v_mfma_f32_16x16x32_bf16 v[196:199], a[216:219], a[244:247], v[196:199]
ds_read_b128 a[240:243], v1 offset:12288
v_exp_f32 v249, v249
v_exp_f32 v250, v250
v_mfma_f32_16x16x32_bf16 v[204:207], a[220:223], a[244:247], v[204:207]
s_mov_b32 m0, s49
s_add_u32 s38, s38, s39
v_exp_f32 v251, v251
v_add_f32 v37, v37, v252
v_add_f32 v37, v37, v253
v_mfma_f32_16x16x32_bf16 v[192:195], a[192:195], a[244:247], v[192:195]
s_sub_u32 s36, s38, s39
buffer_load_dwordx4 v0, s[8:11], s36 offen lds
v_add_f32 v37, v37, v254
v_add_f32 v37, v37, v255
v_add_f32 v37, v37, v248
v_mfma_f32_16x16x32_bf16 v[200:203], a[196:199], a[244:247], v[200:203]
s_waitcnt lgkmcnt(3)
v_add_f32 v37, v37, v249
v_add_f32 v37, v37, v250
v_add_f32 v37, v37, v251
v_cvt_pk_bf16_f32 v252, v252, v253
v_cvt_pk_bf16_f32 v253, v254, v255
v_mfma_f32_16x16x32_bf16 v[48:51], a[232:235], a[248:251], v[48:51]
ds_read_b128 a[244:247], v1 offset:13312
v_cvt_pk_bf16_f32 v254, v248, v249
v_cvt_pk_bf16_f32 v255, v250, v251
v_mfma_f32_16x16x32_bf16 v[52:55], a[236:239], a[248:251], v[52:55]
s_waitcnt vmcnt(15)
ds_read_b64_tr_b16 a[216:217], v8 offset:8192
v_mfma_f32_16x16x32_bf16 v[56:59], a[200:203], a[248:251], v[56:59]
ds_read_b64_tr_b16 a[218:219], v8 offset:10240
v_mfma_f32_16x16x32_bf16 v[60:63], a[204:207], a[248:251], v[60:63]
s_waitcnt lgkmcnt(5)
ds_write_b128 v7, v[252:255] offset:41984
v_accvgpr_read_b32 v208, a48
v_accvgpr_read_b32 v209, a49
v_accvgpr_read_b32 v210, a50
v_accvgpr_read_b32 v211, a51
v_accvgpr_read_b32 v212, a52
v_accvgpr_read_b32 v213, a53
v_accvgpr_read_b32 v214, a54
v_accvgpr_read_b32 v215, a55
v_mfma_f32_16x16x32_bf16 v[64:67], a[232:235], a[252:255], v[64:67]
ds_read_b128 a[248:251], v1 offset:14336
v_fma_f32 v208, v208, s28, v26
v_fma_f32 v209, v209, s28, v26
v_fma_f32 v210, v210, s28, v26
v_fma_f32 v211, v211, s28, v26
v_mfma_f32_16x16x32_bf16 v[68:71], a[236:239], a[252:255], v[68:71]
ds_read_b64_tr_b16 a[220:221], v9 offset:8192
v_fma_f32 v212, v212, s28, v26
v_fma_f32 v213, v213, s28, v26
v_fma_f32 v214, v214, s28, v26
v_mfma_f32_16x16x32_bf16 v[72:75], a[200:203], a[252:255], v[72:75]
ds_read_b64_tr_b16 a[222:223], v9 offset:10240
v_fma_f32 v215, v215, s28, v26
v_exp_f32 v208, v208
v_mfma_f32_16x16x32_bf16 v[76:79], a[204:207], a[252:255], v[76:79]
s_waitcnt lgkmcnt(7)
v_exp_f32 v209, v209
v_exp_f32 v210, v210
v_exp_f32 v211, v211
v_mfma_f32_16x16x32_bf16 v[80:83], a[232:235], a[240:243], v[80:83]
ds_read_b128 a[252:255], v1 offset:15360
v_exp_f32 v212, v212
v_mfma_f32_16x16x32_bf16 v[84:87], a[236:239], a[240:243], v[84:87]
ds_read_b64_tr_b16 a[192:193], v10 offset:8192
v_exp_f32 v213, v213
v_exp_f32 v214, v214
v_mfma_f32_16x16x32_bf16 v[88:91], a[200:203], a[240:243], v[88:91]
ds_read_b64_tr_b16 a[194:195], v10 offset:10240
v_exp_f32 v215, v215
v_add_f32 v38, v38, v208
v_add_f32 v38, v38, v209
v_mfma_f32_16x16x32_bf16 v[92:95], a[204:207], a[240:243], v[92:95]
s_waitcnt lgkmcnt(9)
v_add_f32 v38, v38, v210
v_add_f32 v38, v38, v211
v_add_f32 v38, v38, v212
v_add_f32 v38, v38, v213
v_add_f32 v38, v38, v214
v_mfma_f32_16x16x32_bf16 v[96:99], a[232:235], a[244:247], v[96:99]
ds_read_b128 a[240:243], v1 offset:16384
v_add_f32 v38, v38, v215
v_cvt_pk_bf16_f32 v208, v208, v209
v_cvt_pk_bf16_f32 v209, v210, v211
v_mfma_f32_16x16x32_bf16 v[100:103], a[236:239], a[244:247], v[100:103]
ds_read_b64_tr_b16 a[196:197], v11 offset:8192
v_cvt_pk_bf16_f32 v210, v212, v213
v_cvt_pk_bf16_f32 v211, v214, v215
v_mfma_f32_16x16x32_bf16 v[104:107], a[200:203], a[244:247], v[104:107]
ds_read_b64_tr_b16 a[198:199], v11 offset:10240
v_mfma_f32_16x16x32_bf16 v[108:111], a[204:207], a[244:247], v[108:111]
s_waitcnt lgkmcnt(8)
ds_write_b128 v7, v[208:211] offset:43008
v_accvgpr_read_b32 v216, a56
v_accvgpr_read_b32 v217, a57
v_accvgpr_read_b32 v218, a58
v_accvgpr_read_b32 v219, a59
v_accvgpr_read_b32 v220, a60
v_mfma_f32_16x16x32_bf16 v[112:115], a[232:235], a[248:251], v[112:115]
ds_read_b128 a[244:247], v1 offset:17408
v_accvgpr_read_b32 v221, a61
v_accvgpr_read_b32 v222, a62
v_accvgpr_read_b32 v223, a63
v_fma_f32 v216, v216, s28, v27
v_mfma_f32_16x16x32_bf16 v[116:119], a[236:239], a[248:251], v[116:119]
v_fma_f32 v217, v217, s28, v27
v_fma_f32 v218, v218, s28, v27
v_fma_f32 v219, v219, s28, v27
v_fma_f32 v220, v220, s28, v27
v_mfma_f32_16x16x32_bf16 v[120:123], a[200:203], a[248:251], v[120:123]
v_fma_f32 v221, v221, s28, v27
v_fma_f32 v222, v222, s28, v27
v_fma_f32 v223, v223, s28, v27
v_exp_f32 v216, v216
v_mfma_f32_16x16x32_bf16 v[124:127], a[204:207], a[248:251], v[124:127]
s_waitcnt lgkmcnt(7)
v_exp_f32 v217, v217
v_exp_f32 v218, v218
v_mfma_f32_16x16x32_bf16 v[132:135], a[232:235], a[252:255], v[132:135]
ds_read_b128 a[248:251], v1 offset:18432
v_exp_f32 v219, v219
v_exp_f32 v220, v220
v_mfma_f32_16x16x32_bf16 v[140:143], a[236:239], a[252:255], v[140:143]
s_add_u32 m0, s33, 0x2000
s_add_u32 s35, s48, 0x38000
v_exp_f32 v221, v221
v_exp_f32 v222, v222
v_mfma_f32_16x16x32_bf16 v[128:131], a[200:203], a[252:255], v[128:131]
s_waitcnt lgkmcnt(3)
buffer_load_dwordx4 v12, s[16:19], s35 offen nt lds
v_exp_f32 v223, v223
v_add_f32 v39, v39, v216
v_mfma_f32_16x16x32_bf16 v[136:139], a[204:207], a[252:255], v[136:139]
v_add_f32 v39, v39, v217
v_add_f32 v39, v39, v218
v_add_f32 v39, v39, v219
v_add_f32 v39, v39, v220
v_add_f32 v39, v39, v221
v_mfma_f32_16x16x32_bf16 v[148:151], a[232:235], a[240:243], v[148:151]
ds_read_b128 a[252:255], v1 offset:19456
v_add_f32 v39, v39, v222
v_add_f32 v39, v39, v223
v_cvt_pk_bf16_f32 v216, v216, v217
v_mfma_f32_16x16x32_bf16 v[156:159], a[236:239], a[240:243], v[156:159]
buffer_load_dwordx4 v13, s[16:19], s35 offen offset:1024 nt lds
v_cvt_pk_bf16_f32 v217, v218, v219
v_cvt_pk_bf16_f32 v218, v220, v221
v_cvt_pk_bf16_f32 v219, v222, v223
v_mfma_f32_16x16x32_bf16 v[144:147], a[200:203], a[240:243], v[144:147]
ds_write_b128 v7, v[216:219] offset:44032
v_accvgpr_read_b32 v224, a64
v_mfma_f32_16x16x32_bf16 v[152:155], a[204:207], a[240:243], v[152:155]
s_waitcnt lgkmcnt(3)
v_accvgpr_read_b32 v225, a65
v_accvgpr_read_b32 v226, a66
v_accvgpr_read_b32 v227, a67
v_accvgpr_read_b32 v228, a68
v_mfma_f32_16x16x32_bf16 v[164:167], a[232:235], a[244:247], v[164:167]
ds_read_b128 a[240:243], v1 offset:20480
v_accvgpr_read_b32 v229, a69
v_accvgpr_read_b32 v230, a70
v_accvgpr_read_b32 v231, a71
v_fma_f32 v224, v224, s28, v28
v_mfma_f32_16x16x32_bf16 v[172:175], a[236:239], a[244:247], v[172:175]
buffer_load_dwordx4 v14, s[16:19], s35 offen offset:2048 nt lds
v_fma_f32 v225, v225, s28, v28
v_fma_f32 v226, v226, s28, v28
v_fma_f32 v227, v227, s28, v28
v_mfma_f32_16x16x32_bf16 v[160:163], a[200:203], a[244:247], v[160:163]
v_fma_f32 v228, v228, s28, v28
v_fma_f32 v229, v229, s28, v28
v_fma_f32 v230, v230, s28, v28
v_fma_f32 v231, v231, s28, v28
v_mfma_f32_16x16x32_bf16 v[168:171], a[204:207], a[244:247], v[168:171]
s_waitcnt lgkmcnt(3)
v_exp_f32 v224, v224
v_exp_f32 v225, v225
v_mfma_f32_16x16x32_bf16 v[180:183], a[232:235], a[248:251], v[180:183]
ds_read_b128 a[244:247], v1 offset:21504
v_exp_f32 v226, v226
v_exp_f32 v227, v227
v_mfma_f32_16x16x32_bf16 v[188:191], a[236:239], a[248:251], v[188:191]
buffer_load_dwordx4 v15, s[16:19], s35 offen offset:3072 nt lds
v_exp_f32 v228, v228
v_exp_f32 v229, v229
v_mfma_f32_16x16x32_bf16 v[176:179], a[200:203], a[248:251], v[176:179]
v_exp_f32 v230, v230
v_exp_f32 v231, v231
v_add_f32 v40, v40, v224
v_mfma_f32_16x16x32_bf16 v[184:187], a[204:207], a[248:251], v[184:187]
s_waitcnt lgkmcnt(3)
v_add_f32 v40, v40, v225
v_add_f32 v40, v40, v226
v_add_f32 v40, v40, v227
v_add_f32 v40, v40, v228
v_add_f32 v40, v40, v229
v_mfma_f32_16x16x32_bf16 v[196:199], a[232:235], a[252:255], v[196:199]
ds_read_b128 a[248:251], v1 offset:22528
v_add_f32 v40, v40, v230
v_add_f32 v40, v40, v231
v_cvt_pk_bf16_f32 v224, v224, v225
v_mfma_f32_16x16x32_bf16 v[204:207], a[236:239], a[252:255], v[204:207]
s_mov_b32 m0, s49
s_add_u32 s38, s38, s39
v_cvt_pk_bf16_f32 v225, v226, v227
v_cvt_pk_bf16_f32 v226, v228, v229
v_cvt_pk_bf16_f32 v227, v230, v231
v_mfma_f32_16x16x32_bf16 v[192:195], a[200:203], a[252:255], v[192:195]
s_sub_u32 s36, s38, s39
buffer_load_dwordx4 v0, s[8:11], s36 offen lds
v_mfma_f32_16x16x32_bf16 v[200:203], a[204:207], a[252:255], v[200:203]
s_waitcnt lgkmcnt(2)
ds_write_b128 v7, v[224:227] offset:45056
v_accvgpr_read_b32 v232, a72
v_accvgpr_read_b32 v233, a73
v_accvgpr_read_b32 v234, a74
v_accvgpr_read_b32 v235, a75
v_mfma_f32_16x16x32_bf16 v[48:51], a[216:219], a[240:243], v[48:51]
ds_read_b128 a[252:255], v1 offset:23552
v_accvgpr_read_b32 v236, a76
v_accvgpr_read_b32 v237, a77
v_accvgpr_read_b32 v238, a78
v_accvgpr_read_b32 v239, a79
v_mfma_f32_16x16x32_bf16 v[52:55], a[220:223], a[240:243], v[52:55]
s_waitcnt vmcnt(16)
ds_read_b64_tr_b16 a[232:233], v8 offset:12288
v_fma_f32 v232, v232, s28, v29
v_fma_f32 v233, v233, s28, v29
v_fma_f32 v234, v234, s28, v29
v_mfma_f32_16x16x32_bf16 v[56:59], a[192:195], a[240:243], v[56:59]
ds_read_b64_tr_b16 a[234:235], v8 offset:14336
v_fma_f32 v235, v235, s28, v29
v_fma_f32 v236, v236, s28, v29
v_fma_f32 v237, v237, s28, v29
v_fma_f32 v238, v238, s28, v29
v_mfma_f32_16x16x32_bf16 v[60:63], a[196:199], a[240:243], v[60:63]
s_waitcnt lgkmcnt(5)
v_fma_f32 v239, v239, s28, v29
v_exp_f32 v232, v232
v_mfma_f32_16x16x32_bf16 v[64:67], a[216:219], a[244:247], v[64:67]
ds_read_b128 a[240:243], v1 offset:24576
v_exp_f32 v233, v233
v_exp_f32 v234, v234
v_mfma_f32_16x16x32_bf16 v[68:71], a[220:223], a[244:247], v[68:71]
ds_read_b64_tr_b16 a[236:237], v9 offset:12288
v_exp_f32 v235, v235
v_exp_f32 v236, v236
v_mfma_f32_16x16x32_bf16 v[72:75], a[192:195], a[244:247], v[72:75]
ds_read_b64_tr_b16 a[238:239], v9 offset:14336
v_exp_f32 v237, v237
v_exp_f32 v238, v238
v_mfma_f32_16x16x32_bf16 v[76:79], a[196:199], a[244:247], v[76:79]
s_waitcnt lgkmcnt(7)
v_exp_f32 v239, v239
v_add_f32 v41, v41, v232
v_add_f32 v41, v41, v233
v_add_f32 v41, v41, v234
v_mfma_f32_16x16x32_bf16 v[80:83], a[216:219], a[248:251], v[80:83]
ds_read_b128 a[244:247], v1 offset:25600
v_add_f32 v41, v41, v235
v_add_f32 v41, v41, v236
v_add_f32 v41, v41, v237
v_mfma_f32_16x16x32_bf16 v[84:87], a[220:223], a[248:251], v[84:87]
ds_read_b64_tr_b16 a[200:201], v10 offset:12288
v_add_f32 v41, v41, v238
v_add_f32 v41, v41, v239
v_cvt_pk_bf16_f32 v232, v232, v233
v_cvt_pk_bf16_f32 v233, v234, v235
v_mfma_f32_16x16x32_bf16 v[88:91], a[192:195], a[248:251], v[88:91]
ds_read_b64_tr_b16 a[202:203], v10 offset:14336
v_cvt_pk_bf16_f32 v234, v236, v237
v_cvt_pk_bf16_f32 v235, v238, v239
v_mfma_f32_16x16x32_bf16 v[92:95], a[196:199], a[248:251], v[92:95]
s_waitcnt lgkmcnt(8)
ds_write_b128 v7, v[232:235] offset:46080
v_accvgpr_read_b32 v240, a80
v_mfma_f32_16x16x32_bf16 v[96:99], a[216:219], a[252:255], v[96:99]
ds_read_b128 a[248:251], v1 offset:26624
v_accvgpr_read_b32 v241, a81
v_accvgpr_read_b32 v242, a82
v_accvgpr_read_b32 v243, a83
v_mfma_f32_16x16x32_bf16 v[100:103], a[220:223], a[252:255], v[100:103]
ds_read_b64_tr_b16 a[204:205], v11 offset:12288
v_accvgpr_read_b32 v244, a84
v_accvgpr_read_b32 v245, a85
v_accvgpr_read_b32 v246, a86
v_accvgpr_read_b32 v247, a87
v_mfma_f32_16x16x32_bf16 v[104:107], a[192:195], a[252:255], v[104:107]
ds_read_b64_tr_b16 a[206:207], v11 offset:14336
v_fma_f32 v240, v240, s28, v30
v_fma_f32 v241, v241, s28, v30
v_fma_f32 v242, v242, s28, v30
v_fma_f32 v243, v243, s28, v30
v_mfma_f32_16x16x32_bf16 v[108:111], a[196:199], a[252:255], v[108:111]
s_waitcnt lgkmcnt(9)
v_fma_f32 v244, v244, s28, v30
v_fma_f32 v245, v245, s28, v30
v_fma_f32 v246, v246, s28, v30
v_fma_f32 v247, v247, s28, v30
v_mfma_f32_16x16x32_bf16 v[112:115], a[216:219], a[240:243], v[112:115]
ds_read_b128 a[252:255], v1 offset:27648
v_exp_f32 v240, v240
v_exp_f32 v241, v241
v_mfma_f32_16x16x32_bf16 v[116:119], a[220:223], a[240:243], v[116:119]
v_exp_f32 v242, v242
v_exp_f32 v243, v243
v_mfma_f32_16x16x32_bf16 v[120:123], a[192:195], a[240:243], v[120:123]
v_exp_f32 v244, v244
v_exp_f32 v245, v245
v_mfma_f32_16x16x32_bf16 v[124:127], a[196:199], a[240:243], v[124:127]
s_waitcnt lgkmcnt(7)
v_exp_f32 v246, v246
v_exp_f32 v247, v247
v_add_f32 v42, v42, v240
v_mfma_f32_16x16x32_bf16 v[132:135], a[216:219], a[244:247], v[132:135]
ds_read_b128 a[240:243], v1 offset:28672
v_add_f32 v42, v42, v241
v_add_f32 v42, v42, v242
v_add_f32 v42, v42, v243
v_add_f32 v42, v42, v244
v_mfma_f32_16x16x32_bf16 v[140:143], a[220:223], a[244:247], v[140:143]
s_add_u32 m0, s33, 0x3000
s_add_u32 s35, s48, 0x3c000
v_add_f32 v42, v42, v245
v_add_f32 v42, v42, v246
v_add_f32 v42, v42, v247
v_cvt_pk_bf16_f32 v240, v240, v241
v_mfma_f32_16x16x32_bf16 v[128:131], a[192:195], a[244:247], v[128:131]
s_waitcnt lgkmcnt(2)
buffer_load_dwordx4 v12, s[16:19], s35 offen nt lds
v_cvt_pk_bf16_f32 v241, v242, v243
v_cvt_pk_bf16_f32 v242, v244, v245
v_cvt_pk_bf16_f32 v243, v246, v247
v_mfma_f32_16x16x32_bf16 v[136:139], a[196:199], a[244:247], v[136:139]
ds_write_b128 v7, v[240:243] offset:47104
v_mfma_f32_16x16x32_bf16 v[148:151], a[216:219], a[248:251], v[148:151]
ds_read_b128 a[244:247], v1 offset:29696
v_accvgpr_read_b32 v248, a88
v_accvgpr_read_b32 v249, a89
v_accvgpr_read_b32 v250, a90
v_mfma_f32_16x16x32_bf16 v[156:159], a[220:223], a[248:251], v[156:159]
buffer_load_dwordx4 v13, s[16:19], s35 offen offset:1024 nt lds
v_accvgpr_read_b32 v251, a91
v_accvgpr_read_b32 v252, a92
v_accvgpr_read_b32 v253, a93
v_accvgpr_read_b32 v254, a94
v_mfma_f32_16x16x32_bf16 v[144:147], a[192:195], a[248:251], v[144:147]
v_accvgpr_read_b32 v255, a95
v_fma_f32 v248, v248, s28, v31
v_fma_f32 v249, v249, s28, v31
v_fma_f32 v250, v250, s28, v31
v_mfma_f32_16x16x32_bf16 v[152:155], a[196:199], a[248:251], v[152:155]
s_waitcnt lgkmcnt(3)
v_fma_f32 v251, v251, s28, v31
v_fma_f32 v252, v252, s28, v31
v_fma_f32 v253, v253, s28, v31
v_fma_f32 v254, v254, s28, v31
v_fma_f32 v255, v255, s28, v31
v_mfma_f32_16x16x32_bf16 v[164:167], a[216:219], a[252:255], v[164:167]
ds_read_b128 a[248:251], v1 offset:30720
v_exp_f32 v248, v248
v_exp_f32 v249, v249
v_mfma_f32_16x16x32_bf16 v[172:175], a[220:223], a[252:255], v[172:175]
buffer_load_dwordx4 v14, s[16:19], s35 offen offset:2048 nt lds
v_exp_f32 v250, v250
v_mfma_f32_16x16x32_bf16 v[160:163], a[192:195], a[252:255], v[160:163]
v_exp_f32 v251, v251
v_exp_f32 v252, v252
v_exp_f32 v253, v253
v_mfma_f32_16x16x32_bf16 v[168:171], a[196:199], a[252:255], v[168:171]
s_waitcnt lgkmcnt(3)
v_exp_f32 v254, v254
v_exp_f32 v255, v255
v_mfma_f32_16x16x32_bf16 v[180:183], a[216:219], a[240:243], v[180:183]
ds_read_b128 a[252:255], v1 offset:31744
v_add_f32 v43, v43, v248
v_add_f32 v43, v43, v249
v_add_f32 v43, v43, v250
v_add_f32 v43, v43, v251
v_mfma_f32_16x16x32_bf16 v[188:191], a[220:223], a[240:243], v[188:191]
buffer_load_dwordx4 v15, s[16:19], s35 offen offset:3072 nt lds
v_add_f32 v43, v43, v252
v_add_f32 v43, v43, v253
v_add_f32 v43, v43, v254
v_mfma_f32_16x16x32_bf16 v[176:179], a[192:195], a[240:243], v[176:179]
v_add_f32 v43, v43, v255
v_cvt_pk_bf16_f32 v248, v248, v249
v_cvt_pk_bf16_f32 v249, v250, v251
v_cvt_pk_bf16_f32 v250, v252, v253
v_cvt_pk_bf16_f32 v251, v254, v255
v_mfma_f32_16x16x32_bf16 v[184:187], a[196:199], a[240:243], v[184:187]
s_waitcnt lgkmcnt(2)
ds_write_b128 v7, v[248:251] offset:48128
v_mfma_f32_16x16x32_bf16 v[196:199], a[216:219], a[244:247], v[196:199]
ds_read_b128 a[240:243], v1 offset:32768
v_accvgpr_read_b32 v212, a96
v_accvgpr_read_b32 v213, a97
v_accvgpr_read_b32 v214, a98
v_mfma_f32_16x16x32_bf16 v[204:207], a[220:223], a[244:247], v[204:207]
s_mov_b32 m0, s49
s_add_u32 s38, s38, s39
v_accvgpr_read_b32 v215, a99
v_accvgpr_read_b32 v208, a100
v_accvgpr_read_b32 v209, a101
v_accvgpr_read_b32 v210, a102
v_mfma_f32_16x16x32_bf16 v[192:195], a[192:195], a[244:247], v[192:195]
s_sub_u32 s36, s38, s39
buffer_load_dwordx4 v0, s[8:11], s36 offen lds
v_accvgpr_read_b32 v211, a103
v_fma_f32 v212, v212, s28, v32
v_fma_f32 v213, v213, s28, v32
v_mfma_f32_16x16x32_bf16 v[200:203], a[196:199], a[244:247], v[200:203]
s_waitcnt lgkmcnt(3)
v_fma_f32 v214, v214, s28, v32
v_fma_f32 v215, v215, s28, v32
v_fma_f32 v208, v208, s28, v32
v_fma_f32 v209, v209, s28, v32
v_fma_f32 v210, v210, s28, v32
v_mfma_f32_16x16x32_bf16 v[48:51], a[232:235], a[248:251], v[48:51]
ds_read_b128 a[244:247], v1 offset:33792
v_fma_f32 v211, v211, s28, v32
v_exp_f32 v212, v212
v_mfma_f32_16x16x32_bf16 v[52:55], a[236:239], a[248:251], v[52:55]
s_waitcnt vmcnt(16)
ds_read_b64_tr_b16 a[216:217], v8
v_exp_f32 v213, v213
v_exp_f32 v214, v214
v_mfma_f32_16x16x32_bf16 v[56:59], a[200:203], a[248:251], v[56:59]
ds_read_b64_tr_b16 a[218:219], v8 offset:2048
v_exp_f32 v215, v215
v_exp_f32 v208, v208
v_mfma_f32_16x16x32_bf16 v[60:63], a[204:207], a[248:251], v[60:63]
s_waitcnt lgkmcnt(5)
v_exp_f32 v209, v209
v_exp_f32 v210, v210
v_mfma_f32_16x16x32_bf16 v[64:67], a[232:235], a[252:255], v[64:67]
ds_read_b128 a[248:251], v1 offset:34816
v_exp_f32 v211, v211
v_add_f32 v44, v44, v212
v_add_f32 v44, v44, v213
v_mfma_f32_16x16x32_bf16 v[68:71], a[236:239], a[252:255], v[68:71]
ds_read_b64_tr_b16 a[220:221], v9
v_add_f32 v44, v44, v214
v_add_f32 v44, v44, v215
v_add_f32 v44, v44, v208
v_mfma_f32_16x16x32_bf16 v[72:75], a[200:203], a[252:255], v[72:75]
ds_read_b64_tr_b16 a[222:223], v9 offset:2048
v_add_f32 v44, v44, v209
v_add_f32 v44, v44, v210
v_add_f32 v44, v44, v211
v_cvt_pk_bf16_f32 v212, v212, v213
v_mfma_f32_16x16x32_bf16 v[76:79], a[204:207], a[252:255], v[76:79]
s_waitcnt lgkmcnt(6)
v_cvt_pk_bf16_f32 v213, v214, v215
v_cvt_pk_bf16_f32 v214, v208, v209
v_cvt_pk_bf16_f32 v215, v210, v211
v_mfma_f32_16x16x32_bf16 v[80:83], a[232:235], a[240:243], v[80:83]
ds_read_b128 a[252:255], v1 offset:35840
v_mfma_f32_16x16x32_bf16 v[84:87], a[236:239], a[240:243], v[84:87]
ds_read_b64_tr_b16 a[192:193], v10
v_mfma_f32_16x16x32_bf16 v[88:91], a[200:203], a[240:243], v[88:91]
ds_read_b64_tr_b16 a[194:195], v10 offset:2048
v_mfma_f32_16x16x32_bf16 v[92:95], a[204:207], a[240:243], v[92:95]
s_waitcnt lgkmcnt(8)
ds_write_b128 v7, v[212:215] offset:49152
v_accvgpr_read_b32 v220, a104
v_accvgpr_read_b32 v221, a105
v_accvgpr_read_b32 v222, a106
v_accvgpr_read_b32 v223, a107
v_accvgpr_read_b32 v216, a108
v_accvgpr_read_b32 v217, a109
v_accvgpr_read_b32 v218, a110
v_accvgpr_read_b32 v219, a111
v_fma_f32 v220, v220, s28, v33
v_fma_f32 v221, v221, s28, v33
v_fma_f32 v222, v222, s28, v33
v_fma_f32 v223, v223, s28, v33
v_mfma_f32_16x16x32_bf16 v[96:99], a[232:235], a[244:247], v[96:99]
ds_read_b128 a[240:243], v1 offset:36864
v_fma_f32 v216, v216, s28, v33
v_fma_f32 v217, v217, s28, v33
v_fma_f32 v218, v218, s28, v33
v_mfma_f32_16x16x32_bf16 v[100:103], a[236:239], a[244:247], v[100:103]
ds_read_b64_tr_b16 a[196:197], v11
v_fma_f32 v219, v219, s28, v33
v_exp_f32 v220, v220
v_mfma_f32_16x16x32_bf16 v[104:107], a[200:203], a[244:247], v[104:107]
ds_read_b64_tr_b16 a[198:199], v11 offset:2048
v_exp_f32 v221, v221
v_exp_f32 v222, v222
v_mfma_f32_16x16x32_bf16 v[108:111], a[204:207], a[244:247], v[108:111]
s_waitcnt lgkmcnt(9)
v_mov_b32 v12, v18
v_exp_f32 v223, v223
v_exp_f32 v216, v216
v_mfma_f32_16x16x32_bf16 v[112:115], a[232:235], a[248:251], v[112:115]
ds_read_b128 a[244:247], v1 offset:37888
v_add_u32 v13, s57, v18
v_exp_f32 v217, v217
v_mfma_f32_16x16x32_bf16 v[116:119], a[236:239], a[248:251], v[116:119]
v_add_u32 v14, s58, v18
v_exp_f32 v218, v218
v_exp_f32 v219, v219
v_mfma_f32_16x16x32_bf16 v[120:123], a[200:203], a[248:251], v[120:123]
v_add_u32 v15, s59, v18
v_add_f32 v45, v45, v220
v_add_f32 v45, v45, v221
v_add_f32 v45, v45, v222
v_add_f32 v45, v45, v223
v_mfma_f32_16x16x32_bf16 v[124:127], a[204:207], a[248:251], v[124:127]
s_waitcnt lgkmcnt(7)
v_add_f32 v45, v45, v216
v_add_f32 v45, v45, v217
v_add_f32 v45, v45, v218
v_add_f32 v45, v45, v219
v_mfma_f32_16x16x32_bf16 v[132:135], a[232:235], a[252:255], v[132:135]
ds_read_b128 a[248:251], v1 offset:38912
v_cvt_pk_bf16_f32 v220, v220, v221
v_cvt_pk_bf16_f32 v221, v222, v223
v_cvt_pk_bf16_f32 v222, v216, v217
v_cvt_pk_bf16_f32 v223, v218, v219
v_mfma_f32_16x16x32_bf16 v[140:143], a[236:239], a[252:255], v[140:143]
s_add_u32 m0, s33, 0
ds_write_b128 v7, v[220:223] offset:50176
v_mfma_f32_16x16x32_bf16 v[128:131], a[200:203], a[252:255], v[128:131]
s_waitcnt lgkmcnt(3)
buffer_load_dwordx4 v12, s[8:11], s44 offen nt lds
v_permlane32_swap_b32 v36, v37
v_permlane32_swap_b32 v38, v39
v_permlane32_swap_b32 v40, v41
v_mfma_f32_16x16x32_bf16 v[136:139], a[204:207], a[252:255], v[136:139]
v_permlane32_swap_b32 v42, v43
v_permlane32_swap_b32 v44, v45
v_add_f32 v36, v36, v37
v_add_f32 v38, v38, v39
v_add_f32 v40, v40, v41
v_mfma_f32_16x16x32_bf16 v[148:151], a[232:235], a[240:243], v[148:151]
ds_read_b128 a[252:255], v1 offset:39936
v_add_f32 v42, v42, v43
v_add_f32 v44, v44, v45
v_permlane16_swap_b32 v36, v38
v_mfma_f32_16x16x32_bf16 v[156:159], a[236:239], a[240:243], v[156:159]
buffer_load_dwordx4 v13, s[8:11], s44 offen offset:1024 nt lds
v_permlane16_swap_b32 v40, v42
v_permlane16_swap_b32 v44, v46
v_add_f32 v36, v36, v38
v_add_f32 v40, v40, v42
v_mfma_f32_16x16x32_bf16 v[144:147], a[200:203], a[240:243], v[144:147]
v_add_f32 v44, v44, v46
s_mul_i32 s36, s32, 0x300
v_add_u32 v37, s36, v20
v_mfma_f32_16x16x32_bf16 v[152:155], a[204:207], a[240:243], v[152:155]
s_waitcnt lgkmcnt(3)
ds_write_b32 v37, v36 offset:1024
ds_write_b32 v37, v40 offset:1040
ds_write_b32 v37, v44 offset:1056
v_mfma_f32_16x16x32_bf16 v[164:167], a[232:235], a[244:247], v[164:167]
s_waitcnt lgkmcnt(0)
s_barrier
ds_read_b128 a[240:243], v2
v_mfma_f32_16x16x32_bf16 v[172:175], a[236:239], a[244:247], v[172:175]
buffer_load_dwordx4 v14, s[8:11], s44 offen offset:2048 nt lds
v_mfma_f32_16x16x32_bf16 v[160:163], a[200:203], a[244:247], v[160:163]
v_add_u32 v35, s96, v7
v_mfma_f32_16x16x32_bf16 v[168:171], a[204:207], a[244:247], v[168:171]
ds_write_b128 v35, a[112:115]
v_mfma_f32_16x16x32_bf16 v[180:183], a[232:235], a[248:251], v[180:183]
ds_read_b128 a[244:247], v2 offset:1024
v_mfma_f32_16x16x32_bf16 v[188:191], a[236:239], a[248:251], v[188:191]
buffer_load_dwordx4 v15, s[8:11], s44 offen offset:3072 nt lds
v_mfma_f32_16x16x32_bf16 v[176:179], a[200:203], a[248:251], v[176:179]
ds_read_b128 v[208:211], v21 offset:1024
v_mfma_f32_16x16x32_bf16 v[184:187], a[204:207], a[248:251], v[184:187]
ds_write_b128 v35, a[116:119] offset:1024
v_mfma_f32_16x16x32_bf16 v[196:199], a[232:235], a[252:255], v[196:199]
ds_read_b128 a[248:251], v2 offset:2048
v_mfma_f32_16x16x32_bf16 v[204:207], a[236:239], a[252:255], v[204:207]
s_mov_b32 m0, s49
s_add_u32 s38, s38, s39
ds_read_b128 v[212:215], v21 offset:1040
v_mfma_f32_16x16x32_bf16 v[192:195], a[200:203], a[252:255], v[192:195]
s_sub_u32 s36, s38, s39
buffer_load_dwordx4 v0, s[8:11], s36 offen lds
v_mfma_f32_16x16x32_bf16 v[200:203], a[204:207], a[252:255], v[200:203]
s_waitcnt lgkmcnt(6)
ds_write_b128 v35, a[120:123] offset:2048
v_mfma_f32_16x16x32_bf16 v[48:51], a[216:219], a[240:243], v[48:51]
ds_read_b128 a[252:255], v2 offset:3072
v_mfma_f32_16x16x32_bf16 v[52:55], a[220:223], a[240:243], v[52:55]
s_waitcnt vmcnt(16)
ds_read_b64_tr_b16 a[232:233], v8 offset:4096
v_mfma_f32_16x16x32_bf16 v[56:59], a[192:195], a[240:243], v[56:59]
ds_read_b64_tr_b16 a[234:235], v8 offset:6144
v_mfma_f32_16x16x32_bf16 v[60:63], a[196:199], a[240:243], v[60:63]
s_waitcnt lgkmcnt(8)
s_add_u32 m0, s53, 0
s_mov_b32 s36, 0
buffer_load_dwordx4 v22, s[4:7], s36 offen lds
v_mfma_f32_16x16x32_bf16 v[64:67], a[216:219], a[244:247], v[64:67]
ds_read_b128 a[240:243], v2 offset:4096
v_mfma_f32_16x16x32_bf16 v[68:71], a[220:223], a[244:247], v[68:71]
ds_read_b64_tr_b16 a[236:237], v9 offset:4096
v_mfma_f32_16x16x32_bf16 v[72:75], a[192:195], a[244:247], v[72:75]
ds_read_b64_tr_b16 a[238:239], v9 offset:6144
v_mfma_f32_16x16x32_bf16 v[76:79], a[196:199], a[244:247], v[76:79]
s_waitcnt lgkmcnt(8)
s_add_u32 m0, s53, 0x1000
s_mov_b32 s36, 0x7000
buffer_load_dwordx4 v22, s[4:7], s36 offen lds
v_mfma_f32_16x16x32_bf16 v[80:83], a[216:219], a[248:251], v[80:83]
ds_read_b128 a[244:247], v2 offset:5120
v_mfma_f32_16x16x32_bf16 v[84:87], a[220:223], a[248:251], v[84:87]
ds_read_b64_tr_b16 a[200:201], v10 offset:4096
v_mfma_f32_16x16x32_bf16 v[88:91], a[192:195], a[248:251], v[88:91]
ds_read_b64_tr_b16 a[202:203], v10 offset:6144
v_mfma_f32_16x16x32_bf16 v[92:95], a[196:199], a[248:251], v[92:95]
s_waitcnt lgkmcnt(8)
s_add_u32 m0, s53, 0x2000
s_mov_b32 s36, 0xe000
buffer_load_dwordx4 v22, s[4:7], s36 offen lds
v_mfma_f32_16x16x32_bf16 v[96:99], a[216:219], a[252:255], v[96:99]
ds_read_b128 a[248:251], v2 offset:6144
v_mfma_f32_16x16x32_bf16 v[100:103], a[220:223], a[252:255], v[100:103]
ds_read_b64_tr_b16 a[204:205], v11 offset:4096
v_mfma_f32_16x16x32_bf16 v[104:107], a[192:195], a[252:255], v[104:107]
ds_read_b64_tr_b16 a[206:207], v11 offset:6144
v_mfma_f32_16x16x32_bf16 v[108:111], a[196:199], a[252:255], v[108:111]
s_waitcnt lgkmcnt(8)
s_add_u32 m0, s53, 0x3000
s_mov_b32 s36, 0x15000
buffer_load_dwordx4 v22, s[4:7], s36 offen lds
v_mfma_f32_16x16x32_bf16 v[112:115], a[216:219], a[240:243], v[112:115]
ds_read_b128 a[252:255], v2 offset:7168
v_mfma_f32_16x16x32_bf16 v[116:119], a[220:223], a[240:243], v[116:119]
ds_write_b128 v35, a[124:127] offset:3072
v_mfma_f32_16x16x32_bf16 v[120:123], a[192:195], a[240:243], v[120:123]
ds_write_b128 v35, a[128:131] offset:4096
v_mfma_f32_16x16x32_bf16 v[124:127], a[196:199], a[240:243], v[124:127]
s_waitcnt lgkmcnt(8)
s_add_u32 m0, s53, 0x4000
s_mov_b32 s36, 0x1c000
buffer_load_dwordx4 v22, s[4:7], s36 offen lds
v_mfma_f32_16x16x32_bf16 v[132:135], a[216:219], a[244:247], v[132:135]
ds_read_b128 a[240:243], v2 offset:8192
v_mfma_f32_16x16x32_bf16 v[140:143], a[220:223], a[244:247], v[140:143]
s_add_u32 m0, s33, 0x1000
ds_write_b128 v35, a[132:135] offset:5120
v_mfma_f32_16x16x32_bf16 v[128:131], a[192:195], a[244:247], v[128:131]
s_waitcnt lgkmcnt(5)
buffer_load_dwordx4 v12, s[8:11], s45 offen nt lds
v_mfma_f32_16x16x32_bf16 v[136:139], a[196:199], a[244:247], v[136:139]
ds_write_b128 v35, a[136:139] offset:6144
v_mfma_f32_16x16x32_bf16 v[148:151], a[216:219], a[248:251], v[148:151]
ds_read_b128 a[244:247], v2 offset:9216
v_mfma_f32_16x16x32_bf16 v[156:159], a[220:223], a[248:251], v[156:159]
buffer_load_dwordx4 v13, s[8:11], s45 offen offset:1024 nt lds
v_mfma_f32_16x16x32_bf16 v[144:147], a[192:195], a[248:251], v[144:147]
ds_read_b128 v[216:219], v21 offset:1056
v_mfma_f32_16x16x32_bf16 v[152:155], a[196:199], a[248:251], v[152:155]
s_waitcnt lgkmcnt(7)
ds_write_b128 v35, a[140:143] offset:7168
v_mfma_f32_16x16x32_bf16 v[164:167], a[216:219], a[252:255], v[164:167]
ds_read_b128 a[248:251], v2 offset:10240
v_mfma_f32_16x16x32_bf16 v[172:175], a[220:223], a[252:255], v[172:175]
buffer_load_dwordx4 v14, s[8:11], s45 offen offset:2048 nt lds
v_mfma_f32_16x16x32_bf16 v[160:163], a[192:195], a[252:255], v[160:163]
ds_read_b128 v[220:223], v21 offset:1792
v_mfma_f32_16x16x32_bf16 v[168:171], a[196:199], a[252:255], v[168:171]
s_waitcnt lgkmcnt(7)
ds_write_b128 v35, a[144:147] offset:8192
v_mfma_f32_16x16x32_bf16 v[180:183], a[216:219], a[240:243], v[180:183]
ds_read_b128 a[252:255], v2 offset:11264
v_mfma_f32_16x16x32_bf16 v[188:191], a[220:223], a[240:243], v[188:191]
buffer_load_dwordx4 v15, s[8:11], s45 offen offset:3072 nt lds
v_mfma_f32_16x16x32_bf16 v[176:179], a[192:195], a[240:243], v[176:179]
ds_read_b128 v[224:227], v21 offset:1808
v_mfma_f32_16x16x32_bf16 v[184:187], a[196:199], a[240:243], v[184:187]
s_waitcnt lgkmcnt(7)
ds_write_b128 v35, a[148:151] offset:9216
v_mfma_f32_16x16x32_bf16 v[196:199], a[216:219], a[244:247], v[196:199]
ds_read_b128 a[240:243], v2 offset:12288
v_mfma_f32_16x16x32_bf16 v[204:207], a[220:223], a[244:247], v[204:207]
s_mov_b32 m0, s49
s_add_u32 s38, s38, s39
ds_read_b128 v[228:231], v21 offset:1824
v_mfma_f32_16x16x32_bf16 v[192:195], a[192:195], a[244:247], v[192:195]
s_sub_u32 s36, s38, s39
buffer_load_dwordx4 v0, s[8:11], s36 offen lds
v_mfma_f32_16x16x32_bf16 v[200:203], a[196:199], a[244:247], v[200:203]
s_waitcnt lgkmcnt(7)
ds_read_b128 v[232:235], v21 offset:2560
v_mfma_f32_16x16x32_bf16 v[48:51], a[232:235], a[248:251], v[48:51]
ds_read_b128 a[244:247], v2 offset:13312
v_mfma_f32_16x16x32_bf16 v[52:55], a[236:239], a[248:251], v[52:55]
s_waitcnt vmcnt(21)
ds_read_b64_tr_b16 a[216:217], v8 offset:8192
v_mfma_f32_16x16x32_bf16 v[56:59], a[200:203], a[248:251], v[56:59]
ds_read_b64_tr_b16 a[218:219], v8 offset:10240
v_mfma_f32_16x16x32_bf16 v[60:63], a[204:207], a[248:251], v[60:63]
s_waitcnt lgkmcnt(8)
ds_read_b64_tr_b16 a[220:221], v9 offset:8192
v_mfma_f32_16x16x32_bf16 v[64:67], a[232:235], a[252:255], v[64:67]
ds_read_b128 a[248:251], v2 offset:14336
v_mfma_f32_16x16x32_bf16 v[68:71], a[236:239], a[252:255], v[68:71]
ds_read_b64_tr_b16 a[222:223], v9 offset:10240
v_mfma_f32_16x16x32_bf16 v[72:75], a[200:203], a[252:255], v[72:75]
ds_read_b64_tr_b16 a[192:193], v10 offset:8192
v_mfma_f32_16x16x32_bf16 v[76:79], a[204:207], a[252:255], v[76:79]
s_waitcnt lgkmcnt(9)
ds_read_b64_tr_b16 a[194:195], v10 offset:10240
v_mfma_f32_16x16x32_bf16 v[80:83], a[232:235], a[240:243], v[80:83]
ds_read_b128 a[252:255], v2 offset:15360
v_mfma_f32_16x16x32_bf16 v[84:87], a[236:239], a[240:243], v[84:87]
ds_read_b64_tr_b16 a[196:197], v11 offset:8192
v_mfma_f32_16x16x32_bf16 v[88:91], a[200:203], a[240:243], v[88:91]
ds_read_b64_tr_b16 a[198:199], v11 offset:10240
v_mfma_f32_16x16x32_bf16 v[92:95], a[204:207], a[240:243], v[92:95]
s_waitcnt lgkmcnt(10)
ds_read_b128 v[236:239], v21 offset:2576
v_mfma_f32_16x16x32_bf16 v[96:99], a[232:235], a[244:247], v[96:99]
ds_read_b128 a[240:243], v2 offset:16384
v_mfma_f32_16x16x32_bf16 v[100:103], a[236:239], a[244:247], v[100:103]
ds_read_b128 v[240:243], v21 offset:2592
v_mfma_f32_16x16x32_bf16 v[104:107], a[200:203], a[244:247], v[104:107]
s_add_u32 m0, s33, 0x2000
ds_read_b128 v[244:247], v21 offset:3328
v_mfma_f32_16x16x32_bf16 v[108:111], a[204:207], a[244:247], v[108:111]
s_waitcnt lgkmcnt(10)
s_waitcnt lgkmcnt(4)
buffer_load_dwordx4 v12, s[8:11], s46 offen nt lds
v_mfma_f32_16x16x32_bf16 v[112:115], a[232:235], a[248:251], v[112:115]
ds_read_b128 a[244:247], v2 offset:17408
v_mfma_f32_16x16x32_bf16 v[116:119], a[236:239], a[248:251], v[116:119]
buffer_load_dwordx4 v13, s[8:11], s46 offen offset:1024 nt lds
v_mfma_f32_16x16x32_bf16 v[120:123], a[200:203], a[248:251], v[120:123]
buffer_load_dwordx4 v14, s[8:11], s46 offen offset:2048 nt lds
v_mfma_f32_16x16x32_bf16 v[124:127], a[204:207], a[248:251], v[124:127]
buffer_load_dwordx4 v15, s[8:11], s46 offen offset:3072 nt lds
v_mfma_f32_16x16x32_bf16 v[132:135], a[232:235], a[252:255], v[132:135]
ds_read_b128 a[248:251], v2 offset:18432
v_mfma_f32_16x16x32_bf16 v[140:143], a[236:239], a[252:255], v[140:143]
s_waitcnt vmcnt(20)
ds_read_b64_tr_b16 a[208:209], v8 offset:12288
v_mfma_f32_16x16x32_bf16 v[128:131], a[200:203], a[252:255], v[128:131]
ds_read_b64_tr_b16 a[210:211], v8 offset:14336
v_mfma_f32_16x16x32_bf16 v[136:139], a[204:207], a[252:255], v[136:139]
s_waitcnt lgkmcnt(6)
ds_read_b64_tr_b16 a[212:213], v9 offset:12288
v_mfma_f32_16x16x32_bf16 v[148:151], a[232:235], a[240:243], v[148:151]
ds_read_b128 a[252:255], v2 offset:19456
v_mfma_f32_16x16x32_bf16 v[156:159], a[236:239], a[240:243], v[156:159]
ds_read_b64_tr_b16 a[214:215], v9 offset:14336
v_mfma_f32_16x16x32_bf16 v[144:147], a[200:203], a[240:243], v[144:147]
ds_read_b64_tr_b16 a[224:225], v10 offset:12288
v_mfma_f32_16x16x32_bf16 v[152:155], a[204:207], a[240:243], v[152:155]
s_waitcnt lgkmcnt(7)
ds_read_b64_tr_b16 a[226:227], v10 offset:14336
v_mfma_f32_16x16x32_bf16 v[164:167], a[232:235], a[244:247], v[164:167]
ds_read_b128 a[240:243], v2 offset:20480
v_mfma_f32_16x16x32_bf16 v[172:175], a[236:239], a[244:247], v[172:175]
ds_read_b64_tr_b16 a[228:229], v11 offset:12288
v_mfma_f32_16x16x32_bf16 v[160:163], a[200:203], a[244:247], v[160:163]
ds_read_b64_tr_b16 a[230:231], v11 offset:14336
v_mfma_f32_16x16x32_bf16 v[168:171], a[204:207], a[244:247], v[168:171]
s_waitcnt lgkmcnt(10)
ds_read_b128 v[248:251], v21 offset:3344
v_mfma_f32_16x16x32_bf16 v[180:183], a[232:235], a[248:251], v[180:183]
ds_read_b128 a[244:247], v2 offset:30720
v_mfma_f32_16x16x32_bf16 v[188:191], a[236:239], a[248:251], v[188:191]
ds_read_b128 v[252:255], v21 offset:3360
v_subrev_u32 v36, s33, v3
v_subrev_u32 v37, s33, v4
v_add_u32 v38, 0x25000, v36
v_add_u32 v39, 0x25000, v37
v_xor_b32 v40, 64, v23
v_add_u32 v41, s55, v1
v_add_f32 v208, v208, v220
v_add_f32 v232, v232, v244
v_add_f32 v208, v208, v232
v_mfma_f32_16x16x32_bf16 v[176:179], a[200:203], a[248:251], v[176:179]
s_add_u32 m0, s33, 0x3000
v_rcp_f32 v24, v208
v_add_f32 v209, v209, v221
v_add_f32 v233, v233, v245
v_add_f32 v209, v209, v233
v_rcp_f32 v25, v209
v_add_f32 v210, v210, v222
v_add_f32 v234, v234, v246
v_add_f32 v210, v210, v234
v_rcp_f32 v26, v210
v_add_f32 v211, v211, v223
v_add_f32 v235, v235, v247
v_add_f32 v211, v211, v235
v_rcp_f32 v27, v211
v_add_f32 v212, v212, v224
s_waitcnt lgkmcnt(2)
v_add_f32 v236, v236, v248
v_add_f32 v212, v212, v236
v_rcp_f32 v28, v212
v_add_f32 v213, v213, v225
v_add_f32 v237, v237, v249
v_add_f32 v213, v213, v237
v_rcp_f32 v29, v213
v_add_f32 v214, v214, v226
v_add_f32 v238, v238, v250
v_add_f32 v214, v214, v238
v_rcp_f32 v30, v214
v_add_f32 v215, v215, v227
v_add_f32 v239, v239, v251
v_add_f32 v215, v215, v239
v_rcp_f32 v31, v215
v_add_f32 v216, v216, v228
s_waitcnt lgkmcnt(0)
v_add_f32 v240, v240, v252
v_add_f32 v216, v216, v240
v_rcp_f32 v32, v216
v_add_f32 v217, v217, v229
v_add_f32 v241, v241, v253
v_add_f32 v217, v217, v241
v_mfma_f32_16x16x32_bf16 v[184:187], a[204:207], a[248:251], v[184:187]
buffer_load_dwordx4 v12, s[8:11], s47 offen nt lds
v_mfma_f32_16x16x32_bf16 v[196:199], a[232:235], a[252:255], v[196:199]
ds_read_b128 a[248:251], v2 offset:21504
v_rcp_f32 v33, v217
v_mfma_f32_16x16x32_bf16 v[204:207], a[236:239], a[252:255], v[204:207]
buffer_load_dwordx4 v13, s[8:11], s47 offen offset:1024 nt lds
v_mfma_f32_16x16x32_bf16 v[192:195], a[200:203], a[252:255], v[192:195]
buffer_load_dwordx4 v14, s[8:11], s47 offen offset:2048 nt lds
v_mfma_f32_16x16x32_bf16 v[200:203], a[204:207], a[252:255], v[200:203]
buffer_load_dwordx4 v15, s[8:11], s47 offen offset:3072 nt lds
v_mfma_f32_16x16x32_bf16 v[48:51], a[216:219], a[240:243], v[48:51]
ds_read_b128 a[252:255], v2 offset:31744
v_mfma_f32_16x16x32_bf16 v[52:55], a[220:223], a[240:243], v[52:55]
v_mfma_f32_16x16x32_bf16 v[56:59], a[192:195], a[240:243], v[56:59]
v_mfma_f32_16x16x32_bf16 v[60:63], a[196:199], a[240:243], v[60:63]
s_add_u32 m0, s53, 0x5000
s_mov_b32 s36, 0x80
buffer_load_dwordx4 v22, s[4:7], s36 offen lds
v_mfma_f32_16x16x32_bf16 v[48:51], a[208:211], a[244:247], v[48:51]
ds_read_b128 a[240:243], v2 offset:22528
v_mfma_f32_16x16x32_bf16 v[52:55], a[212:215], a[244:247], v[52:55]
v_mfma_f32_16x16x32_bf16 v[56:59], a[224:227], a[244:247], v[56:59]
v_mfma_f32_16x16x32_bf16 v[60:63], a[228:231], a[244:247], v[60:63]
s_waitcnt lgkmcnt(2)
s_add_u32 m0, s53, 0x6000
s_mov_b32 s36, 0x7080
buffer_load_dwordx4 v22, s[4:7], s36 offen lds
v_mfma_f32_16x16x32_bf16 v[64:67], a[216:219], a[248:251], v[64:67]
ds_read_b128 a[244:247], v2 offset:32768
v_mfma_f32_16x16x32_bf16 v[68:71], a[220:223], a[248:251], v[68:71]
v_mul_f32 v48, v48, v24
v_mul_f32 v49, v49, v24
v_mul_f32 v50, v50, v24
v_mul_f32 v51, v51, v24
v_mfma_f32_16x16x32_bf16 v[72:75], a[192:195], a[248:251], v[72:75]
v_mul_f32 v52, v52, v24
v_mul_f32 v53, v53, v24
v_mul_f32 v54, v54, v24
v_mfma_f32_16x16x32_bf16 v[76:79], a[196:199], a[248:251], v[76:79]
s_waitcnt lgkmcnt(2)
s_add_u32 m0, s53, 0x7000
s_mov_b32 s36, 0xe080
buffer_load_dwordx4 v22, s[4:7], s36 offen lds
v_mul_f32 v55, v55, v24
v_cvt_pk_bf16_f32 v48, v48, v49
v_mfma_f32_16x16x32_bf16 v[64:67], a[208:211], a[252:255], v[64:67]
ds_read_b128 a[248:251], v2 offset:23552
v_cvt_pk_bf16_f32 v49, v50, v51
v_cvt_pk_bf16_f32 v50, v52, v53
v_cvt_pk_bf16_f32 v51, v54, v55
v_mfma_f32_16x16x32_bf16 v[68:71], a[212:215], a[252:255], v[68:71]
v_mul_f32 v56, v56, v24
v_mul_f32 v57, v57, v24
v_mul_f32 v58, v58, v24
v_mul_f32 v59, v59, v24
v_mfma_f32_16x16x32_bf16 v[72:75], a[224:227], a[252:255], v[72:75]
v_mul_f32 v60, v60, v24
v_mul_f32 v61, v61, v24
v_mul_f32 v62, v62, v24
v_mfma_f32_16x16x32_bf16 v[76:79], a[228:231], a[252:255], v[76:79]
s_waitcnt lgkmcnt(2)
s_add_u32 m0, s53, 0x8000
s_mov_b32 s36, 0x15080
buffer_load_dwordx4 v22, s[4:7], s36 offen lds
v_mul_f32 v63, v63, v24
v_cvt_pk_bf16_f32 v56, v56, v57
v_mfma_f32_16x16x32_bf16 v[80:83], a[216:219], a[240:243], v[80:83]
ds_read_b128 a[252:255], v2 offset:33792
v_cvt_pk_bf16_f32 v57, v58, v59
v_cvt_pk_bf16_f32 v58, v60, v61
v_cvt_pk_bf16_f32 v59, v62, v63
v_mfma_f32_16x16x32_bf16 v[84:87], a[220:223], a[240:243], v[84:87]
v_mul_f32 v64, v64, v25
v_mul_f32 v65, v65, v25
v_mul_f32 v66, v66, v25
v_mul_f32 v67, v67, v25
v_mfma_f32_16x16x32_bf16 v[88:91], a[192:195], a[240:243], v[88:91]
v_mul_f32 v68, v68, v25
v_mul_f32 v69, v69, v25
v_mul_f32 v70, v70, v25
v_mfma_f32_16x16x32_bf16 v[92:95], a[196:199], a[240:243], v[92:95]
s_waitcnt lgkmcnt(2)
s_add_u32 m0, s53, 0x9000
s_mov_b32 s36, 0x1c080
buffer_load_dwordx4 v22, s[4:7], s36 offen lds
v_mul_f32 v71, v71, v25
v_cvt_pk_bf16_f32 v64, v64, v65
v_mfma_f32_16x16x32_bf16 v[80:83], a[208:211], a[244:247], v[80:83]
ds_read_b128 a[240:243], v2 offset:24576
v_cvt_pk_bf16_f32 v65, v66, v67
v_cvt_pk_bf16_f32 v66, v68, v69
v_mfma_f32_16x16x32_bf16 v[84:87], a[212:215], a[244:247], v[84:87]
v_cvt_pk_bf16_f32 v67, v70, v71
v_mul_f32 v72, v72, v25
v_mul_f32 v73, v73, v25
v_mul_f32 v74, v74, v25
v_mfma_f32_16x16x32_bf16 v[88:91], a[224:227], a[244:247], v[88:91]
v_mul_f32 v75, v75, v25
v_mul_f32 v76, v76, v25
v_mul_f32 v77, v77, v25
v_mfma_f32_16x16x32_bf16 v[92:95], a[228:231], a[244:247], v[92:95]
s_waitcnt lgkmcnt(2)
v_mul_f32 v78, v78, v25
v_mul_f32 v79, v79, v25
v_cvt_pk_bf16_f32 v72, v72, v73
v_cvt_pk_bf16_f32 v73, v74, v75
v_mfma_f32_16x16x32_bf16 v[96:99], a[216:219], a[248:251], v[96:99]
ds_read_b128 a[244:247], v2 offset:34816
v_cvt_pk_bf16_f32 v74, v76, v77
v_cvt_pk_bf16_f32 v75, v78, v79
v_mfma_f32_16x16x32_bf16 v[100:103], a[220:223], a[248:251], v[100:103]
v_mul_f32 v80, v80, v26
v_mul_f32 v81, v81, v26
v_mul_f32 v82, v82, v26
v_mfma_f32_16x16x32_bf16 v[104:107], a[192:195], a[248:251], v[104:107]
v_mul_f32 v83, v83, v26
v_mul_f32 v84, v84, v26
v_mul_f32 v85, v85, v26
v_mfma_f32_16x16x32_bf16 v[108:111], a[196:199], a[248:251], v[108:111]
s_waitcnt lgkmcnt(2)
v_mul_f32 v86, v86, v26
v_mul_f32 v87, v87, v26
v_cvt_pk_bf16_f32 v80, v80, v81
v_cvt_pk_bf16_f32 v81, v82, v83
v_mfma_f32_16x16x32_bf16 v[96:99], a[208:211], a[252:255], v[96:99]
ds_read_b128 a[248:251], v2 offset:25600
v_cvt_pk_bf16_f32 v82, v84, v85
v_cvt_pk_bf16_f32 v83, v86, v87
v_mfma_f32_16x16x32_bf16 v[100:103], a[212:215], a[252:255], v[100:103]
v_mul_f32 v88, v88, v26
v_mul_f32 v89, v89, v26
v_mul_f32 v90, v90, v26
v_mfma_f32_16x16x32_bf16 v[104:107], a[224:227], a[252:255], v[104:107]
v_mul_f32 v91, v91, v26
v_mul_f32 v92, v92, v26
v_mul_f32 v93, v93, v26
v_mfma_f32_16x16x32_bf16 v[108:111], a[228:231], a[252:255], v[108:111]
s_waitcnt lgkmcnt(2)
v_mul_f32 v94, v94, v26
v_mul_f32 v95, v95, v26
v_cvt_pk_bf16_f32 v88, v88, v89
v_cvt_pk_bf16_f32 v89, v90, v91
v_mfma_f32_16x16x32_bf16 v[112:115], a[216:219], a[240:243], v[112:115]
ds_read_b128 a[252:255], v2 offset:35840
v_cvt_pk_bf16_f32 v90, v92, v93
v_cvt_pk_bf16_f32 v91, v94, v95
v_mfma_f32_16x16x32_bf16 v[116:119], a[220:223], a[240:243], v[116:119]
v_mul_f32 v96, v96, v27
v_mul_f32 v97, v97, v27
v_mul_f32 v98, v98, v27
v_mfma_f32_16x16x32_bf16 v[120:123], a[192:195], a[240:243], v[120:123]
v_mul_f32 v99, v99, v27
v_mul_f32 v100, v100, v27
v_mul_f32 v101, v101, v27
v_mfma_f32_16x16x32_bf16 v[124:127], a[196:199], a[240:243], v[124:127]
s_waitcnt lgkmcnt(2)
v_mul_f32 v102, v102, v27
v_mul_f32 v103, v103, v27
v_cvt_pk_bf16_f32 v96, v96, v97
v_cvt_pk_bf16_f32 v97, v98, v99
v_mfma_f32_16x16x32_bf16 v[112:115], a[208:211], a[244:247], v[112:115]
ds_read_b128 a[240:243], v2 offset:26624
v_cvt_pk_bf16_f32 v98, v100, v101
v_cvt_pk_bf16_f32 v99, v102, v103
v_mfma_f32_16x16x32_bf16 v[116:119], a[212:215], a[244:247], v[116:119]
v_mul_f32 v104, v104, v27
v_mul_f32 v105, v105, v27
v_mul_f32 v106, v106, v27
v_mfma_f32_16x16x32_bf16 v[120:123], a[224:227], a[244:247], v[120:123]
v_mul_f32 v107, v107, v27
v_mul_f32 v108, v108, v27
v_mul_f32 v109, v109, v27
v_mfma_f32_16x16x32_bf16 v[124:127], a[228:231], a[244:247], v[124:127]
s_waitcnt lgkmcnt(2)
v_mul_f32 v110, v110, v27
v_mul_f32 v111, v111, v27
v_cvt_pk_bf16_f32 v104, v104, v105
v_cvt_pk_bf16_f32 v105, v106, v107
v_mfma_f32_16x16x32_bf16 v[132:135], a[216:219], a[248:251], v[132:135]
ds_read_b128 a[244:247], v2 offset:36864
v_cvt_pk_bf16_f32 v106, v108, v109
v_cvt_pk_bf16_f32 v107, v110, v111
v_mfma_f32_16x16x32_bf16 v[140:143], a[220:223], a[248:251], v[140:143]
v_mul_f32 v112, v112, v28
v_mul_f32 v113, v113, v28
v_mul_f32 v114, v114, v28
v_mfma_f32_16x16x32_bf16 v[128:131], a[192:195], a[248:251], v[128:131]
v_mul_f32 v115, v115, v28
v_mul_f32 v116, v116, v28
v_mul_f32 v117, v117, v28
v_mfma_f32_16x16x32_bf16 v[136:139], a[196:199], a[248:251], v[136:139]
s_waitcnt lgkmcnt(2)
v_mul_f32 v118, v118, v28
v_mul_f32 v119, v119, v28
v_cvt_pk_bf16_f32 v112, v112, v113
v_cvt_pk_bf16_f32 v113, v114, v115
v_mfma_f32_16x16x32_bf16 v[132:135], a[208:211], a[252:255], v[132:135]
ds_read_b128 a[248:251], v2 offset:27648
v_cvt_pk_bf16_f32 v114, v116, v117
v_cvt_pk_bf16_f32 v115, v118, v119
v_mfma_f32_16x16x32_bf16 v[140:143], a[212:215], a[252:255], v[140:143]
v_mul_f32 v120, v120, v28
v_mul_f32 v121, v121, v28
v_mul_f32 v122, v122, v28
v_mfma_f32_16x16x32_bf16 v[128:131], a[224:227], a[252:255], v[128:131]
v_mul_f32 v123, v123, v28
v_mul_f32 v124, v124, v28
v_mul_f32 v125, v125, v28
v_mfma_f32_16x16x32_bf16 v[136:139], a[228:231], a[252:255], v[136:139]
s_waitcnt lgkmcnt(2)
v_mul_f32 v126, v126, v28
v_mul_f32 v127, v127, v28
v_cvt_pk_bf16_f32 v120, v120, v121
v_cvt_pk_bf16_f32 v121, v122, v123
v_mfma_f32_16x16x32_bf16 v[148:151], a[216:219], a[240:243], v[148:151]
ds_read_b128 a[252:255], v2 offset:37888
v_cvt_pk_bf16_f32 v122, v124, v125
v_cvt_pk_bf16_f32 v123, v126, v127
v_mfma_f32_16x16x32_bf16 v[156:159], a[220:223], a[240:243], v[156:159]
v_mul_f32 v132, v132, v29
v_mul_f32 v133, v133, v29
v_mul_f32 v134, v134, v29
v_mfma_f32_16x16x32_bf16 v[144:147], a[192:195], a[240:243], v[144:147]
v_mul_f32 v135, v135, v29
v_mul_f32 v140, v140, v29
v_mul_f32 v141, v141, v29
v_mfma_f32_16x16x32_bf16 v[152:155], a[196:199], a[240:243], v[152:155]
s_waitcnt lgkmcnt(2)
v_mul_f32 v142, v142, v29
v_mul_f32 v143, v143, v29
v_cvt_pk_bf16_f32 v132, v132, v133
v_cvt_pk_bf16_f32 v133, v134, v135
v_mfma_f32_16x16x32_bf16 v[148:151], a[208:211], a[244:247], v[148:151]
ds_read_b128 a[240:243], v2 offset:28672
v_cvt_pk_bf16_f32 v134, v140, v141
v_cvt_pk_bf16_f32 v135, v142, v143
v_mfma_f32_16x16x32_bf16 v[156:159], a[212:215], a[244:247], v[156:159]
v_mul_f32 v128, v128, v29
v_mul_f32 v129, v129, v29
v_mul_f32 v130, v130, v29
v_mfma_f32_16x16x32_bf16 v[144:147], a[224:227], a[244:247], v[144:147]
v_mul_f32 v131, v131, v29
v_mul_f32 v136, v136, v29
v_mul_f32 v137, v137, v29
v_mfma_f32_16x16x32_bf16 v[152:155], a[228:231], a[244:247], v[152:155]
s_waitcnt lgkmcnt(2)
v_mul_f32 v138, v138, v29
v_mul_f32 v139, v139, v29
v_cvt_pk_bf16_f32 v128, v128, v129
v_cvt_pk_bf16_f32 v129, v130, v131
v_mfma_f32_16x16x32_bf16 v[164:167], a[216:219], a[248:251], v[164:167]
ds_read_b128 a[244:247], v2 offset:38912
v_cvt_pk_bf16_f32 v130, v136, v137
v_cvt_pk_bf16_f32 v131, v138, v139
v_mfma_f32_16x16x32_bf16 v[172:175], a[220:223], a[248:251], v[172:175]
v_mul_f32 v148, v148, v30
v_mul_f32 v149, v149, v30
v_mul_f32 v150, v150, v30
v_mfma_f32_16x16x32_bf16 v[160:163], a[192:195], a[248:251], v[160:163]
v_mul_f32 v151, v151, v30
v_mul_f32 v156, v156, v30
v_mul_f32 v157, v157, v30
v_mfma_f32_16x16x32_bf16 v[168:171], a[196:199], a[248:251], v[168:171]
s_waitcnt lgkmcnt(2)
v_mul_f32 v158, v158, v30
v_mul_f32 v159, v159, v30
v_cvt_pk_bf16_f32 v148, v148, v149
v_cvt_pk_bf16_f32 v149, v150, v151
v_mfma_f32_16x16x32_bf16 v[164:167], a[208:211], a[252:255], v[164:167]
ds_read_b128 a[248:251], v2 offset:29696
v_cvt_pk_bf16_f32 v150, v156, v157
v_cvt_pk_bf16_f32 v151, v158, v159
v_mfma_f32_16x16x32_bf16 v[172:175], a[212:215], a[252:255], v[172:175]
v_mul_f32 v144, v144, v30
v_mul_f32 v145, v145, v30
v_mul_f32 v146, v146, v30
v_mfma_f32_16x16x32_bf16 v[160:163], a[224:227], a[252:255], v[160:163]
v_mul_f32 v147, v147, v30
v_mul_f32 v152, v152, v30
v_mul_f32 v153, v153, v30
v_mfma_f32_16x16x32_bf16 v[168:171], a[228:231], a[252:255], v[168:171]
s_waitcnt lgkmcnt(2)
v_mul_f32 v154, v154, v30
v_mul_f32 v155, v155, v30
v_cvt_pk_bf16_f32 v144, v144, v145
v_cvt_pk_bf16_f32 v145, v146, v147
v_mfma_f32_16x16x32_bf16 v[180:183], a[216:219], a[240:243], v[180:183]
ds_read_b128 a[252:255], v2 offset:39936
v_cvt_pk_bf16_f32 v146, v152, v153
v_cvt_pk_bf16_f32 v147, v154, v155
v_mfma_f32_16x16x32_bf16 v[188:191], a[220:223], a[240:243], v[188:191]
v_mul_f32 v164, v164, v31
v_mul_f32 v165, v165, v31
v_mul_f32 v166, v166, v31
v_mfma_f32_16x16x32_bf16 v[176:179], a[192:195], a[240:243], v[176:179]
v_mul_f32 v167, v167, v31
v_mul_f32 v172, v172, v31
v_mul_f32 v173, v173, v31
v_mfma_f32_16x16x32_bf16 v[184:187], a[196:199], a[240:243], v[184:187]
s_waitcnt lgkmcnt(2)
v_mul_f32 v174, v174, v31
v_mul_f32 v175, v175, v31
v_cvt_pk_bf16_f32 v164, v164, v165
v_mfma_f32_16x16x32_bf16 v[180:183], a[208:211], a[244:247], v[180:183]
v_cvt_pk_bf16_f32 v165, v166, v167
v_cvt_pk_bf16_f32 v166, v172, v173
v_cvt_pk_bf16_f32 v167, v174, v175
v_mfma_f32_16x16x32_bf16 v[188:191], a[212:215], a[244:247], v[188:191]
v_mul_f32 v160, v160, v31
v_mul_f32 v161, v161, v31
v_mul_f32 v162, v162, v31
v_mfma_f32_16x16x32_bf16 v[176:179], a[224:227], a[244:247], v[176:179]
v_mul_f32 v163, v163, v31
v_mul_f32 v168, v168, v31
v_mul_f32 v169, v169, v31
v_mfma_f32_16x16x32_bf16 v[184:187], a[228:231], a[244:247], v[184:187]
s_waitcnt lgkmcnt(1)
v_mul_f32 v170, v170, v31
v_mul_f32 v171, v171, v31
v_cvt_pk_bf16_f32 v160, v160, v161
v_mfma_f32_16x16x32_bf16 v[196:199], a[216:219], a[248:251], v[196:199]
v_cvt_pk_bf16_f32 v161, v162, v163
v_cvt_pk_bf16_f32 v162, v168, v169
v_cvt_pk_bf16_f32 v163, v170, v171
v_mfma_f32_16x16x32_bf16 v[204:207], a[220:223], a[248:251], v[204:207]
v_mul_f32 v180, v180, v32
v_mul_f32 v181, v181, v32
v_mul_f32 v182, v182, v32
v_mfma_f32_16x16x32_bf16 v[192:195], a[192:195], a[248:251], v[192:195]
v_mul_f32 v183, v183, v32
v_mul_f32 v188, v188, v32
v_mul_f32 v189, v189, v32
v_mul_f32 v190, v190, v32
v_mfma_f32_16x16x32_bf16 v[200:203], a[196:199], a[248:251], v[200:203]
s_waitcnt lgkmcnt(0)
v_mul_f32 v191, v191, v32
v_cvt_pk_bf16_f32 v180, v180, v181
v_cvt_pk_bf16_f32 v181, v182, v183
v_mfma_f32_16x16x32_bf16 v[196:199], a[208:211], a[252:255], v[196:199]
v_cvt_pk_bf16_f32 v182, v188, v189
v_cvt_pk_bf16_f32 v183, v190, v191
v_mul_f32 v176, v176, v32
v_mul_f32 v177, v177, v32
v_mfma_f32_16x16x32_bf16 v[204:207], a[212:215], a[252:255], v[204:207]
v_mul_f32 v178, v178, v32
v_mul_f32 v179, v179, v32
v_mul_f32 v184, v184, v32
v_mfma_f32_16x16x32_bf16 v[192:195], a[224:227], a[252:255], v[192:195]
v_mul_f32 v185, v185, v32
v_mul_f32 v186, v186, v32
v_mul_f32 v187, v187, v32
v_cvt_pk_bf16_f32 v176, v176, v177
v_mfma_f32_16x16x32_bf16 v[200:203], a[228:231], a[252:255], v[200:203]
v_cvt_pk_bf16_f32 v177, v178, v179
v_cvt_pk_bf16_f32 v178, v184, v185
v_cvt_pk_bf16_f32 v179, v186, v187
v_mul_f32 v196, v196, v33
v_mul_f32 v197, v197, v33
v_mul_f32 v198, v198, v33
v_mul_f32 v199, v199, v33
v_mul_f32 v204, v204, v33
v_mul_f32 v205, v205, v33
v_mul_f32 v206, v206, v33
v_mul_f32 v207, v207, v33
v_cvt_pk_bf16_f32 v196, v196, v197
v_cvt_pk_bf16_f32 v197, v198, v199
v_cvt_pk_bf16_f32 v198, v204, v205
v_cvt_pk_bf16_f32 v199, v206, v207
v_mul_f32 v192, v192, v33
v_mul_f32 v193, v193, v33
v_mul_f32 v194, v194, v33
v_mul_f32 v195, v195, v33
v_mul_f32 v200, v200, v33
v_mul_f32 v201, v201, v33
v_mul_f32 v202, v202, v33
v_mul_f32 v203, v203, v33
v_cvt_pk_bf16_f32 v192, v192, v193
v_cvt_pk_bf16_f32 v193, v194, v195
v_cvt_pk_bf16_f32 v194, v200, v201
v_cvt_pk_bf16_f32 v195, v202, v203
s_cmp_eq_u32 s34, 0
s_cbranch_scc0 L_ophase
s_mov_b32 s92, 0x30000
s_mov_b32 s93, 0x30000
s_mov_b32 s34, 1
s_add_u32 s48, s48, 0x40000
s_mov_b32 s37, 0x200
s_add_u32 s40, s40, 0x40000
s_add_u32 s41, s41, 0x40000
s_add_u32 s42, s42, 0x40000
s_add_u32 s43, s43, 0x40000
s_nop 7
s_branch L_head
L_ophase:
s_nop 7
s_barrier
ds_read_b128 a[240:243], v1
ds_read_b128 a[244:247], v1 offset:1024
ds_read_b128 a[248:251], v1 offset:2048
s_waitcnt vmcnt(24)
ds_read_b64_tr_b16 a[216:217], v8
ds_read_b64_tr_b16 a[218:219], v8 offset:2048
ds_read_b64_tr_b16 a[220:221], v9
ds_read_b64_tr_b16 a[222:223], v9 offset:2048
ds_read_b64_tr_b16 a[192:193], v10
ds_read_b64_tr_b16 a[194:195], v10 offset:2048
v_mov_b32 v3, 0
buffer_load_dword v22, v3, s[68:71], s95 offen sc1
s_add_u32 m0, s33, 0
s_mov_b32 s35, 0x7000
s_waitcnt lgkmcnt(0)
buffer_load_dwordx4 v12, s[8:11], s35 offen nt lds
buffer_load_dwordx4 v13, s[8:11], s35 offen offset:1024 nt lds
buffer_load_dwordx4 v14, s[8:11], s35 offen offset:2048 nt lds
buffer_load_dwordx4 v15, s[8:11], s35 offen offset:3072 nt lds
v_mfma_f32_16x16x32_bf16 a[0:3], a[216:219], a[240:243], 0
ds_read_b128 a[252:255], v1 offset:3072
v_mfma_f32_16x16x32_bf16 a[40:43], a[220:223], a[240:243], 0
s_waitcnt vmcnt(19)
ds_read_b64_tr_b16 a[232:233], v8 offset:4096
v_mfma_f32_16x16x32_bf16 v[216:219], a[192:195], a[240:243], 0
ds_read_b64_tr_b16 a[234:235], v8 offset:6144
v_mfma_f32_16x16x32_bf16 a[4:7], a[216:219], a[244:247], 0
ds_read_b128 a[240:243], v1 offset:4096
v_mfma_f32_16x16x32_bf16 a[44:47], a[220:223], a[244:247], 0
ds_read_b64_tr_b16 a[236:237], v9 offset:4096
v_mfma_f32_16x16x32_bf16 v[220:223], a[192:195], a[244:247], 0
ds_read_b64_tr_b16 a[238:239], v9 offset:6144
v_mfma_f32_16x16x32_bf16 a[8:11], a[216:219], a[248:251], 0
ds_read_b128 a[244:247], v1 offset:5120
v_mfma_f32_16x16x32_bf16 a[48:51], a[220:223], a[248:251], 0
ds_read_b64_tr_b16 a[200:201], v10 offset:4096
v_mfma_f32_16x16x32_bf16 v[224:227], a[192:195], a[248:251], 0
s_waitcnt lgkmcnt(7)
ds_read_b64_tr_b16 a[202:203], v10 offset:6144
v_mfma_f32_16x16x32_bf16 a[12:15], a[216:219], a[252:255], 0
ds_read_b128 a[248:251], v1 offset:6144
v_mfma_f32_16x16x32_bf16 a[52:55], a[220:223], a[252:255], 0
ds_write_b128 v7, a[152:155] offset:40960
v_mfma_f32_16x16x32_bf16 v[228:231], a[192:195], a[252:255], 0
s_waitcnt lgkmcnt(7)
v_mfma_f32_16x16x32_bf16 a[16:19], a[216:219], a[240:243], 0
ds_read_b128 a[252:255], v1 offset:7168
v_mfma_f32_16x16x32_bf16 a[56:59], a[220:223], a[240:243], 0
v_mfma_f32_16x16x32_bf16 v[232:235], a[192:195], a[240:243], 0
s_waitcnt lgkmcnt(5)
s_add_u32 m0, s33, 0x1000
s_mov_b32 s35, 0x15000
v_mfma_f32_16x16x32_bf16 a[20:23], a[216:219], a[244:247], 0
ds_read_b128 a[240:243], v1 offset:8192
v_mfma_f32_16x16x32_bf16 a[60:63], a[220:223], a[244:247], 0
s_waitcnt lgkmcnt(4)
buffer_load_dwordx4 v12, s[8:11], s35 offen nt lds
v_mfma_f32_16x16x32_bf16 v[236:239], a[192:195], a[244:247], 0
s_waitcnt lgkmcnt(3)
ds_write_b128 v7, a[156:159] offset:41984
v_mfma_f32_16x16x32_bf16 a[24:27], a[216:219], a[248:251], 0
ds_read_b128 a[244:247], v1 offset:9216
v_mfma_f32_16x16x32_bf16 a[64:67], a[220:223], a[248:251], 0
buffer_load_dwordx4 v13, s[8:11], s35 offen offset:1024 nt lds
v_mfma_f32_16x16x32_bf16 v[240:243], a[192:195], a[248:251], 0
s_waitcnt lgkmcnt(3)
v_mfma_f32_16x16x32_bf16 a[28:31], a[216:219], a[252:255], 0
ds_read_b128 a[248:251], v1 offset:10240
v_mfma_f32_16x16x32_bf16 a[68:71], a[220:223], a[252:255], 0
buffer_load_dwordx4 v14, s[8:11], s35 offen offset:2048 nt lds
v_mfma_f32_16x16x32_bf16 v[244:247], a[192:195], a[252:255], 0
s_waitcnt lgkmcnt(3)
v_mfma_f32_16x16x32_bf16 a[32:35], a[216:219], a[240:243], 0
ds_read_b128 a[252:255], v1 offset:11264
v_mfma_f32_16x16x32_bf16 v[208:211], a[220:223], a[240:243], 0
buffer_load_dwordx4 v15, s[8:11], s35 offen offset:3072 nt lds
v_mfma_f32_16x16x32_bf16 v[248:251], a[192:195], a[240:243], 0
s_waitcnt lgkmcnt(2)
ds_write_b128 v7, a[160:163] offset:43008
v_mfma_f32_16x16x32_bf16 a[36:39], a[216:219], a[244:247], 0
ds_read_b128 a[240:243], v1 offset:12288
v_mfma_f32_16x16x32_bf16 v[212:215], a[220:223], a[244:247], 0
v_mfma_f32_16x16x32_bf16 v[252:255], a[192:195], a[244:247], 0
s_waitcnt lgkmcnt(3)
v_mfma_f32_16x16x32_bf16 a[0:3], a[232:235], a[248:251], a[0:3]
ds_read_b128 a[244:247], v1 offset:13312
v_mfma_f32_16x16x32_bf16 a[40:43], a[236:239], a[248:251], a[40:43]
s_waitcnt vmcnt(18)
ds_read_b64_tr_b16 a[216:217], v8 offset:8192
v_mfma_f32_16x16x32_bf16 v[216:219], a[200:203], a[248:251], v[216:219]
s_waitcnt lgkmcnt(4)
ds_read_b64_tr_b16 a[218:219], v8 offset:10240
v_mfma_f32_16x16x32_bf16 a[4:7], a[232:235], a[252:255], a[4:7]
ds_read_b128 a[248:251], v1 offset:14336
v_mfma_f32_16x16x32_bf16 a[44:47], a[236:239], a[252:255], a[44:47]
ds_read_b64_tr_b16 a[220:221], v9 offset:8192
v_mfma_f32_16x16x32_bf16 v[220:223], a[200:203], a[252:255], v[220:223]
s_waitcnt lgkmcnt(5)
ds_read_b64_tr_b16 a[222:223], v9 offset:10240
v_mfma_f32_16x16x32_bf16 a[8:11], a[232:235], a[240:243], a[8:11]
ds_read_b128 a[252:255], v1 offset:15360
v_mfma_f32_16x16x32_bf16 a[48:51], a[236:239], a[240:243], a[48:51]
ds_read_b64_tr_b16 a[192:193], v10 offset:8192
v_mfma_f32_16x16x32_bf16 v[224:227], a[200:203], a[240:243], v[224:227]
s_waitcnt lgkmcnt(7)
ds_read_b64_tr_b16 a[194:195], v10 offset:10240
v_mfma_f32_16x16x32_bf16 a[12:15], a[232:235], a[244:247], a[12:15]
ds_read_b128 a[240:243], v1 offset:16384
v_mfma_f32_16x16x32_bf16 a[52:55], a[236:239], a[244:247], a[52:55]
ds_write_b128 v7, a[164:167] offset:44032
v_mfma_f32_16x16x32_bf16 v[228:231], a[200:203], a[244:247], v[228:231]
s_waitcnt lgkmcnt(7)
v_mfma_f32_16x16x32_bf16 a[16:19], a[232:235], a[248:251], a[16:19]
ds_read_b128 a[244:247], v1 offset:17408
v_mfma_f32_16x16x32_bf16 a[56:59], a[236:239], a[248:251], a[56:59]
v_mfma_f32_16x16x32_bf16 v[232:235], a[200:203], a[248:251], v[232:235]
s_waitcnt lgkmcnt(5)
s_add_u32 m0, s33, 0x2000
s_mov_b32 s35, 0x23000
v_mfma_f32_16x16x32_bf16 a[20:23], a[232:235], a[252:255], a[20:23]
ds_read_b128 a[248:251], v1 offset:18432
v_mfma_f32_16x16x32_bf16 a[60:63], a[236:239], a[252:255], a[60:63]
s_waitcnt lgkmcnt(4)
buffer_load_dwordx4 v12, s[8:11], s35 offen nt lds
v_mfma_f32_16x16x32_bf16 v[236:239], a[200:203], a[252:255], v[236:239]
s_waitcnt lgkmcnt(3)
ds_write_b128 v7, a[168:171] offset:45056
v_mfma_f32_16x16x32_bf16 a[24:27], a[232:235], a[240:243], a[24:27]
ds_read_b128 a[252:255], v1 offset:19456
v_mfma_f32_16x16x32_bf16 a[64:67], a[236:239], a[240:243], a[64:67]
buffer_load_dwordx4 v13, s[8:11], s35 offen offset:1024 nt lds
v_mfma_f32_16x16x32_bf16 v[240:243], a[200:203], a[240:243], v[240:243]
s_waitcnt lgkmcnt(3)
v_mfma_f32_16x16x32_bf16 a[28:31], a[232:235], a[244:247], a[28:31]
ds_read_b128 a[240:243], v1 offset:20480
v_mfma_f32_16x16x32_bf16 a[68:71], a[236:239], a[244:247], a[68:71]
buffer_load_dwordx4 v14, s[8:11], s35 offen offset:2048 nt lds
v_mfma_f32_16x16x32_bf16 v[244:247], a[200:203], a[244:247], v[244:247]
s_waitcnt lgkmcnt(3)
v_mfma_f32_16x16x32_bf16 a[32:35], a[232:235], a[248:251], a[32:35]
ds_read_b128 a[244:247], v1 offset:21504
v_mfma_f32_16x16x32_bf16 v[208:211], a[236:239], a[248:251], v[208:211]
buffer_load_dwordx4 v15, s[8:11], s35 offen offset:3072 nt lds
v_mfma_f32_16x16x32_bf16 v[248:251], a[200:203], a[248:251], v[248:251]
s_waitcnt lgkmcnt(2)
v_mfma_f32_16x16x32_bf16 a[36:39], a[232:235], a[252:255], a[36:39]
ds_read_b128 a[248:251], v1 offset:22528
v_mfma_f32_16x16x32_bf16 v[212:215], a[236:239], a[252:255], v[212:215]
ds_write_b128 v7, a[172:175] offset:46080
v_mfma_f32_16x16x32_bf16 v[252:255], a[200:203], a[252:255], v[252:255]
s_waitcnt lgkmcnt(3)
v_mfma_f32_16x16x32_bf16 a[0:3], a[216:219], a[240:243], a[0:3]
ds_read_b128 a[252:255], v1 offset:23552
v_mfma_f32_16x16x32_bf16 a[40:43], a[220:223], a[240:243], a[40:43]
s_waitcnt vmcnt(18)
ds_read_b64_tr_b16 a[232:233], v8 offset:12288
v_mfma_f32_16x16x32_bf16 v[216:219], a[192:195], a[240:243], v[216:219]
s_waitcnt lgkmcnt(4)
ds_read_b64_tr_b16 a[234:235], v8 offset:14336
v_mfma_f32_16x16x32_bf16 a[4:7], a[216:219], a[244:247], a[4:7]
ds_read_b128 a[240:243], v1 offset:24576
v_mfma_f32_16x16x32_bf16 a[44:47], a[220:223], a[244:247], a[44:47]
ds_read_b64_tr_b16 a[236:237], v9 offset:12288
v_mfma_f32_16x16x32_bf16 v[220:223], a[192:195], a[244:247], v[220:223]
s_waitcnt lgkmcnt(6)
ds_read_b64_tr_b16 a[238:239], v9 offset:14336
v_mfma_f32_16x16x32_bf16 a[8:11], a[216:219], a[248:251], a[8:11]
ds_read_b128 a[244:247], v1 offset:25600
v_mfma_f32_16x16x32_bf16 a[48:51], a[220:223], a[248:251], a[48:51]
ds_read_b64_tr_b16 a[200:201], v10 offset:12288
v_mfma_f32_16x16x32_bf16 v[224:227], a[192:195], a[248:251], v[224:227]
s_waitcnt lgkmcnt(7)
ds_read_b64_tr_b16 a[202:203], v10 offset:14336
v_mfma_f32_16x16x32_bf16 a[12:15], a[216:219], a[252:255], a[12:15]
ds_read_b128 a[248:251], v1 offset:26624
v_mfma_f32_16x16x32_bf16 a[52:55], a[220:223], a[252:255], a[52:55]
ds_write_b128 v7, a[176:179] offset:47104
v_mfma_f32_16x16x32_bf16 v[228:231], a[192:195], a[252:255], v[228:231]
s_waitcnt lgkmcnt(7)
v_mfma_f32_16x16x32_bf16 a[16:19], a[216:219], a[240:243], a[16:19]
ds_read_b128 a[252:255], v1 offset:27648
v_mfma_f32_16x16x32_bf16 a[56:59], a[220:223], a[240:243], a[56:59]
v_mfma_f32_16x16x32_bf16 v[232:235], a[192:195], a[240:243], v[232:235]
s_waitcnt lgkmcnt(5)
s_add_u32 m0, s33, 0x3000
s_mov_b32 s35, 0x31000
v_mfma_f32_16x16x32_bf16 a[20:23], a[216:219], a[244:247], a[20:23]
ds_read_b128 a[240:243], v1 offset:28672
v_mfma_f32_16x16x32_bf16 a[60:63], a[220:223], a[244:247], a[60:63]
s_waitcnt lgkmcnt(4)
buffer_load_dwordx4 v12, s[8:11], s35 offen nt lds
v_mfma_f32_16x16x32_bf16 v[236:239], a[192:195], a[244:247], v[236:239]
s_waitcnt lgkmcnt(3)
v_mfma_f32_16x16x32_bf16 a[24:27], a[216:219], a[248:251], a[24:27]
ds_read_b128 a[244:247], v1 offset:29696
v_mfma_f32_16x16x32_bf16 a[64:67], a[220:223], a[248:251], a[64:67]
buffer_load_dwordx4 v13, s[8:11], s35 offen offset:1024 nt lds
v_mfma_f32_16x16x32_bf16 v[240:243], a[192:195], a[248:251], v[240:243]
s_waitcnt lgkmcnt(2)
ds_write_b128 v7, a[180:183] offset:48128
v_mfma_f32_16x16x32_bf16 a[28:31], a[216:219], a[252:255], a[28:31]
ds_read_b128 a[248:251], v1 offset:30720
v_mfma_f32_16x16x32_bf16 a[68:71], a[220:223], a[252:255], a[68:71]
buffer_load_dwordx4 v14, s[8:11], s35 offen offset:2048 nt lds
v_mfma_f32_16x16x32_bf16 v[244:247], a[192:195], a[252:255], v[244:247]
s_waitcnt lgkmcnt(3)
v_mfma_f32_16x16x32_bf16 a[32:35], a[216:219], a[240:243], a[32:35]
ds_read_b128 a[252:255], v1 offset:31744
v_mfma_f32_16x16x32_bf16 v[208:211], a[220:223], a[240:243], v[208:211]
buffer_load_dwordx4 v15, s[8:11], s35 offen offset:3072 nt lds
v_mfma_f32_16x16x32_bf16 v[248:251], a[192:195], a[240:243], v[248:251]
s_waitcnt lgkmcnt(3)
v_mfma_f32_16x16x32_bf16 a[36:39], a[216:219], a[244:247], a[36:39]
ds_read_b128 a[240:243], v1 offset:32768
v_mfma_f32_16x16x32_bf16 v[212:215], a[220:223], a[244:247], v[212:215]
v_mfma_f32_16x16x32_bf16 v[252:255], a[192:195], a[244:247], v[252:255]
s_waitcnt lgkmcnt(2)
ds_write_b128 v7, a[184:187] offset:49152
v_mfma_f32_16x16x32_bf16 a[0:3], a[232:235], a[248:251], a[0:3]
ds_read_b128 a[244:247], v1 offset:33792
v_mfma_f32_16x16x32_bf16 a[40:43], a[236:239], a[248:251], a[40:43]
s_waitcnt vmcnt(12)
ds_read_b64_tr_b16 a[216:217], v8
v_mfma_f32_16x16x32_bf16 v[216:219], a[200:203], a[248:251], v[216:219]
s_waitcnt lgkmcnt(4)
ds_read_b64_tr_b16 a[218:219], v8 offset:2048
v_mfma_f32_16x16x32_bf16 a[4:7], a[232:235], a[252:255], a[4:7]
ds_read_b128 a[248:251], v1 offset:34816
v_mfma_f32_16x16x32_bf16 a[44:47], a[236:239], a[252:255], a[44:47]
ds_read_b64_tr_b16 a[220:221], v9
v_mfma_f32_16x16x32_bf16 v[220:223], a[200:203], a[252:255], v[220:223]
s_waitcnt lgkmcnt(6)
ds_read_b64_tr_b16 a[222:223], v9 offset:2048
v_mfma_f32_16x16x32_bf16 a[8:11], a[232:235], a[240:243], a[8:11]
ds_read_b128 a[252:255], v1 offset:35840
v_mfma_f32_16x16x32_bf16 a[48:51], a[236:239], a[240:243], a[48:51]
ds_read_b64_tr_b16 a[192:193], v10
v_mfma_f32_16x16x32_bf16 v[224:227], a[200:203], a[240:243], v[224:227]
s_waitcnt lgkmcnt(7)
ds_read_b64_tr_b16 a[194:195], v10 offset:2048
v_mfma_f32_16x16x32_bf16 a[12:15], a[232:235], a[244:247], a[12:15]
ds_read_b128 a[240:243], v1 offset:36864
v_mfma_f32_16x16x32_bf16 a[52:55], a[236:239], a[244:247], a[52:55]
v_mfma_f32_16x16x32_bf16 v[228:231], a[200:203], a[244:247], v[228:231]
s_waitcnt lgkmcnt(6)
ds_write_b128 v7, a[188:191] offset:50176
v_mfma_f32_16x16x32_bf16 a[16:19], a[232:235], a[248:251], a[16:19]
ds_read_b128 a[244:247], v1 offset:37888
v_mfma_f32_16x16x32_bf16 a[56:59], a[236:239], a[248:251], a[56:59]
v_mfma_f32_16x16x32_bf16 v[232:235], a[200:203], a[248:251], v[232:235]
s_waitcnt lgkmcnt(5)
s_add_u32 m0, s33, 0
s_mov_b32 s35, 0x38000
v_mfma_f32_16x16x32_bf16 a[20:23], a[232:235], a[252:255], a[20:23]
ds_read_b128 a[248:251], v1 offset:38912
v_mfma_f32_16x16x32_bf16 a[60:63], a[236:239], a[252:255], a[60:63]
s_waitcnt lgkmcnt(4)
buffer_load_dwordx4 v12, s[8:11], s35 offen nt lds
v_mfma_f32_16x16x32_bf16 v[236:239], a[200:203], a[252:255], v[236:239]
s_waitcnt lgkmcnt(3)
v_mfma_f32_16x16x32_bf16 a[24:27], a[232:235], a[240:243], a[24:27]
ds_read_b128 a[252:255], v1 offset:39936
v_mfma_f32_16x16x32_bf16 a[64:67], a[236:239], a[240:243], a[64:67]
buffer_load_dwordx4 v13, s[8:11], s35 offen offset:1024 nt lds
v_mfma_f32_16x16x32_bf16 v[240:243], a[200:203], a[240:243], v[240:243]
s_waitcnt lgkmcnt(2)
v_mfma_f32_16x16x32_bf16 a[28:31], a[232:235], a[244:247], a[28:31]
s_waitcnt lgkmcnt(0)
s_barrier
ds_read_b128 a[240:243], v2
v_mfma_f32_16x16x32_bf16 a[68:71], a[236:239], a[244:247], a[68:71]
buffer_load_dwordx4 v14, s[8:11], s35 offen offset:2048 nt lds
v_mfma_f32_16x16x32_bf16 v[244:247], a[200:203], a[244:247], v[244:247]
v_mfma_f32_16x16x32_bf16 a[32:35], a[232:235], a[248:251], a[32:35]
ds_read_b128 a[244:247], v2 offset:1024
v_mfma_f32_16x16x32_bf16 v[208:211], a[236:239], a[248:251], v[208:211]
buffer_load_dwordx4 v15, s[8:11], s35 offen offset:3072 nt lds
v_mfma_f32_16x16x32_bf16 v[248:251], a[200:203], a[248:251], v[248:251]
ds_write_b128 v7, v[48:51]
v_mfma_f32_16x16x32_bf16 a[36:39], a[232:235], a[252:255], a[36:39]
ds_read_b128 a[248:251], v2 offset:2048
v_mfma_f32_16x16x32_bf16 v[212:215], a[236:239], a[252:255], v[212:215]
v_mfma_f32_16x16x32_bf16 v[252:255], a[200:203], a[252:255], v[252:255]
s_waitcnt lgkmcnt(3)
v_mfma_f32_16x16x32_bf16 a[0:3], a[216:219], a[240:243], a[0:3]
ds_read_b128 a[252:255], v2 offset:3072
v_mfma_f32_16x16x32_bf16 a[40:43], a[220:223], a[240:243], a[40:43]
s_waitcnt vmcnt(12)
ds_read_b64_tr_b16 a[232:233], v8 offset:4096
v_mfma_f32_16x16x32_bf16 v[216:219], a[192:195], a[240:243], v[216:219]
s_waitcnt lgkmcnt(4)
ds_read_b64_tr_b16 a[234:235], v8 offset:6144
v_mfma_f32_16x16x32_bf16 a[4:7], a[216:219], a[244:247], a[4:7]
ds_read_b128 a[240:243], v2 offset:4096
v_mfma_f32_16x16x32_bf16 a[44:47], a[220:223], a[244:247], a[44:47]
ds_read_b64_tr_b16 a[236:237], v9 offset:4096
v_mfma_f32_16x16x32_bf16 v[220:223], a[192:195], a[244:247], v[220:223]
s_waitcnt lgkmcnt(5)
ds_read_b64_tr_b16 a[238:239], v9 offset:6144
v_mfma_f32_16x16x32_bf16 a[8:11], a[216:219], a[248:251], a[8:11]
ds_read_b128 a[244:247], v2 offset:5120
v_mfma_f32_16x16x32_bf16 a[48:51], a[220:223], a[248:251], a[48:51]
ds_read_b64_tr_b16 a[200:201], v10 offset:4096
v_mfma_f32_16x16x32_bf16 v[224:227], a[192:195], a[248:251], v[224:227]
s_waitcnt lgkmcnt(7)
ds_read_b64_tr_b16 a[202:203], v10 offset:6144
v_mfma_f32_16x16x32_bf16 a[12:15], a[216:219], a[252:255], a[12:15]
ds_read_b128 a[248:251], v2 offset:6144
v_mfma_f32_16x16x32_bf16 a[52:55], a[220:223], a[252:255], a[52:55]
ds_write_b128 v7, v[64:67] offset:1024
v_mfma_f32_16x16x32_bf16 v[228:231], a[192:195], a[252:255], v[228:231]
s_waitcnt lgkmcnt(7)
v_mfma_f32_16x16x32_bf16 a[16:19], a[216:219], a[240:243], a[16:19]
ds_read_b128 a[252:255], v2 offset:7168
v_mfma_f32_16x16x32_bf16 a[56:59], a[220:223], a[240:243], a[56:59]
v_mfma_f32_16x16x32_bf16 v[232:235], a[192:195], a[240:243], v[232:235]
s_waitcnt lgkmcnt(5)
s_add_u32 m0, s33, 0x1000
s_mov_b32 s35, 0x46000
v_mfma_f32_16x16x32_bf16 a[20:23], a[216:219], a[244:247], a[20:23]
ds_read_b128 a[240:243], v2 offset:8192
v_mfma_f32_16x16x32_bf16 a[60:63], a[220:223], a[244:247], a[60:63]
s_waitcnt lgkmcnt(4)
buffer_load_dwordx4 v12, s[8:11], s35 offen nt lds
v_mfma_f32_16x16x32_bf16 v[236:239], a[192:195], a[244:247], v[236:239]
s_waitcnt lgkmcnt(3)
v_mfma_f32_16x16x32_bf16 a[24:27], a[216:219], a[248:251], a[24:27]
ds_read_b128 a[244:247], v2 offset:9216
v_mfma_f32_16x16x32_bf16 a[64:67], a[220:223], a[248:251], a[64:67]
buffer_load_dwordx4 v13, s[8:11], s35 offen offset:1024 nt lds
v_mfma_f32_16x16x32_bf16 v[240:243], a[192:195], a[248:251], v[240:243]
s_waitcnt lgkmcnt(2)
ds_write_b128 v7, v[80:83] offset:2048
v_mfma_f32_16x16x32_bf16 a[28:31], a[216:219], a[252:255], a[28:31]
ds_read_b128 a[248:251], v2 offset:10240
v_mfma_f32_16x16x32_bf16 a[68:71], a[220:223], a[252:255], a[68:71]
buffer_load_dwordx4 v14, s[8:11], s35 offen offset:2048 nt lds
v_mfma_f32_16x16x32_bf16 v[244:247], a[192:195], a[252:255], v[244:247]
s_waitcnt lgkmcnt(3)
v_mfma_f32_16x16x32_bf16 a[32:35], a[216:219], a[240:243], a[32:35]
ds_read_b128 a[252:255], v2 offset:11264
v_mfma_f32_16x16x32_bf16 v[208:211], a[220:223], a[240:243], v[208:211]
buffer_load_dwordx4 v15, s[8:11], s35 offen offset:3072 nt lds
v_mfma_f32_16x16x32_bf16 v[248:251], a[192:195], a[240:243], v[248:251]
s_waitcnt lgkmcnt(3)
v_mfma_f32_16x16x32_bf16 a[36:39], a[216:219], a[244:247], a[36:39]
ds_read_b128 a[240:243], v2 offset:12288
v_mfma_f32_16x16x32_bf16 v[212:215], a[220:223], a[244:247], v[212:215]
v_mfma_f32_16x16x32_bf16 v[252:255], a[192:195], a[244:247], v[252:255]
s_waitcnt lgkmcnt(2)
ds_write_b128 v7, v[96:99] offset:3072
v_mfma_f32_16x16x32_bf16 a[0:3], a[232:235], a[248:251], a[0:3]
ds_read_b128 a[244:247], v2 offset:13312
v_mfma_f32_16x16x32_bf16 a[40:43], a[236:239], a[248:251], a[40:43]
s_waitcnt vmcnt(12)
ds_read_b64_tr_b16 a[216:217], v8 offset:8192
v_mfma_f32_16x16x32_bf16 v[216:219], a[200:203], a[248:251], v[216:219]
s_waitcnt lgkmcnt(4)
ds_read_b64_tr_b16 a[218:219], v8 offset:10240
v_mfma_f32_16x16x32_bf16 a[4:7], a[232:235], a[252:255], a[4:7]
ds_read_b128 a[248:251], v2 offset:14336
v_mfma_f32_16x16x32_bf16 a[44:47], a[236:239], a[252:255], a[44:47]
ds_read_b64_tr_b16 a[220:221], v9 offset:8192
v_mfma_f32_16x16x32_bf16 v[220:223], a[200:203], a[252:255], v[220:223]
s_waitcnt lgkmcnt(6)
ds_read_b64_tr_b16 a[222:223], v9 offset:10240
v_mfma_f32_16x16x32_bf16 a[8:11], a[232:235], a[240:243], a[8:11]
ds_read_b128 a[252:255], v2 offset:15360
v_mfma_f32_16x16x32_bf16 a[48:51], a[236:239], a[240:243], a[48:51]
ds_read_b64_tr_b16 a[192:193], v10 offset:8192
v_mfma_f32_16x16x32_bf16 v[224:227], a[200:203], a[240:243], v[224:227]
s_waitcnt lgkmcnt(7)
ds_read_b64_tr_b16 a[194:195], v10 offset:10240
v_mfma_f32_16x16x32_bf16 a[12:15], a[232:235], a[244:247], a[12:15]
ds_read_b128 a[240:243], v2 offset:16384
v_mfma_f32_16x16x32_bf16 a[52:55], a[236:239], a[244:247], a[52:55]
v_mfma_f32_16x16x32_bf16 v[228:231], a[200:203], a[244:247], v[228:231]
s_waitcnt lgkmcnt(6)
ds_write_b128 v7, v[112:115] offset:4096
v_mfma_f32_16x16x32_bf16 a[16:19], a[232:235], a[248:251], a[16:19]
ds_read_b128 a[244:247], v2 offset:17408
v_mfma_f32_16x16x32_bf16 a[56:59], a[236:239], a[248:251], a[56:59]
v_mfma_f32_16x16x32_bf16 v[232:235], a[200:203], a[248:251], v[232:235]
s_waitcnt lgkmcnt(5)
s_add_u32 m0, s33, 0x2000
s_mov_b32 s35, 0x54000
v_mfma_f32_16x16x32_bf16 a[20:23], a[232:235], a[252:255], a[20:23]
ds_read_b128 a[248:251], v2 offset:18432
v_mfma_f32_16x16x32_bf16 a[60:63], a[236:239], a[252:255], a[60:63]
s_waitcnt lgkmcnt(4)
buffer_load_dwordx4 v12, s[8:11], s35 offen nt lds
v_mfma_f32_16x16x32_bf16 v[236:239], a[200:203], a[252:255], v[236:239]
s_waitcnt lgkmcnt(3)
v_mfma_f32_16x16x32_bf16 a[24:27], a[232:235], a[240:243], a[24:27]
ds_read_b128 a[252:255], v2 offset:19456
v_mfma_f32_16x16x32_bf16 a[64:67], a[236:239], a[240:243], a[64:67]
buffer_load_dwordx4 v13, s[8:11], s35 offen offset:1024 nt lds
v_mfma_f32_16x16x32_bf16 v[240:243], a[200:203], a[240:243], v[240:243]
s_waitcnt lgkmcnt(2)
v_mfma_f32_16x16x32_bf16 a[28:31], a[232:235], a[244:247], a[28:31]
ds_read_b128 a[240:243], v2 offset:20480
v_mfma_f32_16x16x32_bf16 a[68:71], a[236:239], a[244:247], a[68:71]
buffer_load_dwordx4 v14, s[8:11], s35 offen offset:2048 nt lds
v_mfma_f32_16x16x32_bf16 v[244:247], a[200:203], a[244:247], v[244:247]
s_waitcnt lgkmcnt(2)
ds_write_b128 v7, v[132:135] offset:5120
v_mfma_f32_16x16x32_bf16 a[32:35], a[232:235], a[248:251], a[32:35]
ds_read_b128 a[244:247], v2 offset:21504
v_mfma_f32_16x16x32_bf16 v[208:211], a[236:239], a[248:251], v[208:211]
buffer_load_dwordx4 v15, s[8:11], s35 offen offset:3072 nt lds
v_mfma_f32_16x16x32_bf16 v[248:251], a[200:203], a[248:251], v[248:251]
s_waitcnt lgkmcnt(3)
v_mfma_f32_16x16x32_bf16 a[36:39], a[232:235], a[252:255], a[36:39]
ds_read_b128 a[248:251], v2 offset:22528
v_mfma_f32_16x16x32_bf16 v[212:215], a[236:239], a[252:255], v[212:215]
v_mfma_f32_16x16x32_bf16 v[252:255], a[200:203], a[252:255], v[252:255]
s_waitcnt lgkmcnt(3)
v_mfma_f32_16x16x32_bf16 a[0:3], a[216:219], a[240:243], a[0:3]
ds_read_b128 a[252:255], v2 offset:23552
v_mfma_f32_16x16x32_bf16 a[40:43], a[220:223], a[240:243], a[40:43]
s_waitcnt vmcnt(12)
ds_read_b64_tr_b16 a[232:233], v8 offset:12288
v_mfma_f32_16x16x32_bf16 v[216:219], a[192:195], a[240:243], v[216:219]
s_waitcnt lgkmcnt(3)
ds_read_b64_tr_b16 a[234:235], v8 offset:14336
v_mfma_f32_16x16x32_bf16 a[4:7], a[216:219], a[244:247], a[4:7]
ds_read_b128 a[240:243], v2 offset:24576
v_mfma_f32_16x16x32_bf16 a[44:47], a[220:223], a[244:247], a[44:47]
ds_read_b64_tr_b16 a[236:237], v9 offset:12288
v_mfma_f32_16x16x32_bf16 v[220:223], a[192:195], a[244:247], v[220:223]
s_waitcnt lgkmcnt(5)
ds_read_b64_tr_b16 a[238:239], v9 offset:14336
v_mfma_f32_16x16x32_bf16 a[8:11], a[216:219], a[248:251], a[8:11]
ds_read_b128 a[244:247], v2 offset:25600
v_mfma_f32_16x16x32_bf16 a[48:51], a[220:223], a[248:251], a[48:51]
ds_read_b64_tr_b16 a[200:201], v10 offset:12288
v_mfma_f32_16x16x32_bf16 v[224:227], a[192:195], a[248:251], v[224:227]
s_waitcnt lgkmcnt(7)
ds_read_b64_tr_b16 a[202:203], v10 offset:14336
v_mfma_f32_16x16x32_bf16 a[12:15], a[216:219], a[252:255], a[12:15]
ds_read_b128 a[248:251], v2 offset:26624
v_mfma_f32_16x16x32_bf16 a[52:55], a[220:223], a[252:255], a[52:55]
ds_write_b128 v7, v[148:151] offset:6144
v_mfma_f32_16x16x32_bf16 v[228:231], a[192:195], a[252:255], v[228:231]
s_waitcnt lgkmcnt(7)
v_mfma_f32_16x16x32_bf16 a[16:19], a[216:219], a[240:243], a[16:19]
ds_read_b128 a[252:255], v2 offset:27648
v_mfma_f32_16x16x32_bf16 a[56:59], a[220:223], a[240:243], a[56:59]
v_mfma_f32_16x16x32_bf16 v[232:235], a[192:195], a[240:243], v[232:235]
s_waitcnt lgkmcnt(5)
s_add_u32 m0, s33, 0x3000
s_mov_b32 s35, 0x62000
v_mfma_f32_16x16x32_bf16 a[20:23], a[216:219], a[244:247], a[20:23]
ds_read_b128 a[240:243], v2 offset:28672
v_mfma_f32_16x16x32_bf16 a[60:63], a[220:223], a[244:247], a[60:63]
s_waitcnt lgkmcnt(4)
buffer_load_dwordx4 v12, s[8:11], s35 offen nt lds
v_mfma_f32_16x16x32_bf16 v[236:239], a[192:195], a[244:247], v[236:239]
s_waitcnt lgkmcnt(3)
ds_write_b128 v7, v[164:167] offset:7168
v_mfma_f32_16x16x32_bf16 a[24:27], a[216:219], a[248:251], a[24:27]
ds_read_b128 a[244:247], v2 offset:29696
v_mfma_f32_16x16x32_bf16 a[64:67], a[220:223], a[248:251], a[64:67]
buffer_load_dwordx4 v13, s[8:11], s35 offen offset:1024 nt lds
v_mfma_f32_16x16x32_bf16 v[240:243], a[192:195], a[248:251], v[240:243]
s_waitcnt lgkmcnt(3)
v_mfma_f32_16x16x32_bf16 a[28:31], a[216:219], a[252:255], a[28:31]
ds_read_b128 a[248:251], v2 offset:30720
v_mfma_f32_16x16x32_bf16 a[68:71], a[220:223], a[252:255], a[68:71]
buffer_load_dwordx4 v14, s[8:11], s35 offen offset:2048 nt lds
v_mfma_f32_16x16x32_bf16 v[244:247], a[192:195], a[252:255], v[244:247]
s_waitcnt lgkmcnt(3)
v_mfma_f32_16x16x32_bf16 a[32:35], a[216:219], a[240:243], a[32:35]
ds_read_b128 a[252:255], v2 offset:31744
v_mfma_f32_16x16x32_bf16 v[208:211], a[220:223], a[240:243], v[208:211]
buffer_load_dwordx4 v15, s[8:11], s35 offen offset:3072 nt lds
v_mfma_f32_16x16x32_bf16 v[248:251], a[192:195], a[240:243], v[248:251]
s_waitcnt lgkmcnt(2)
ds_write_b128 v7, v[180:183] offset:8192
v_mfma_f32_16x16x32_bf16 a[36:39], a[216:219], a[244:247], a[36:39]
ds_read_b128 a[240:243], v2 offset:32768
v_mfma_f32_16x16x32_bf16 v[212:215], a[220:223], a[244:247], v[212:215]
v_mfma_f32_16x16x32_bf16 v[252:255], a[192:195], a[244:247], v[252:255]
s_waitcnt lgkmcnt(3)
v_mfma_f32_16x16x32_bf16 a[0:3], a[232:235], a[248:251], a[0:3]
ds_read_b128 a[244:247], v2 offset:33792
v_mfma_f32_16x16x32_bf16 a[40:43], a[236:239], a[248:251], a[40:43]
s_waitcnt vmcnt(12)
ds_read_b64_tr_b16 a[216:217], v8
v_mfma_f32_16x16x32_bf16 v[216:219], a[200:203], a[248:251], v[216:219]
s_waitcnt lgkmcnt(4)
ds_read_b64_tr_b16 a[218:219], v8 offset:2048
v_mfma_f32_16x16x32_bf16 a[4:7], a[232:235], a[252:255], a[4:7]
ds_read_b128 a[248:251], v2 offset:34816
v_mfma_f32_16x16x32_bf16 a[44:47], a[236:239], a[252:255], a[44:47]
ds_read_b64_tr_b16 a[220:221], v9
v_mfma_f32_16x16x32_bf16 v[220:223], a[200:203], a[252:255], v[220:223]
s_waitcnt lgkmcnt(5)
ds_read_b64_tr_b16 a[222:223], v9 offset:2048
v_mfma_f32_16x16x32_bf16 a[8:11], a[232:235], a[240:243], a[8:11]
ds_read_b128 a[252:255], v2 offset:35840
v_mfma_f32_16x16x32_bf16 a[48:51], a[236:239], a[240:243], a[48:51]
ds_read_b64_tr_b16 a[192:193], v10
v_mfma_f32_16x16x32_bf16 v[224:227], a[200:203], a[240:243], v[224:227]
s_waitcnt lgkmcnt(7)
ds_read_b64_tr_b16 a[194:195], v10 offset:2048
v_mfma_f32_16x16x32_bf16 a[12:15], a[232:235], a[244:247], a[12:15]
ds_read_b128 a[240:243], v2 offset:36864
v_mfma_f32_16x16x32_bf16 a[52:55], a[236:239], a[244:247], a[52:55]
ds_write_b128 v7, v[196:199] offset:9216
v_mfma_f32_16x16x32_bf16 v[228:231], a[200:203], a[244:247], v[228:231]
s_waitcnt lgkmcnt(7)
v_mfma_f32_16x16x32_bf16 a[16:19], a[232:235], a[248:251], a[16:19]
ds_read_b128 a[244:247], v2 offset:37888
v_mfma_f32_16x16x32_bf16 a[56:59], a[236:239], a[248:251], a[56:59]
v_mfma_f32_16x16x32_bf16 v[232:235], a[200:203], a[248:251], v[232:235]
s_waitcnt lgkmcnt(5)
s_add_u32 m0, s33, 0
s_mov_b32 s35, 0x3f000
v_mfma_f32_16x16x32_bf16 a[20:23], a[232:235], a[252:255], a[20:23]
ds_read_b128 a[248:251], v2 offset:38912
v_mfma_f32_16x16x32_bf16 a[60:63], a[236:239], a[252:255], a[60:63]
s_waitcnt lgkmcnt(4)
buffer_load_dwordx4 v12, s[8:11], s35 offen nt lds
v_mfma_f32_16x16x32_bf16 v[236:239], a[200:203], a[252:255], v[236:239]
s_waitcnt lgkmcnt(3)
v_mfma_f32_16x16x32_bf16 a[24:27], a[232:235], a[240:243], a[24:27]
ds_read_b128 a[252:255], v2 offset:39936
v_mfma_f32_16x16x32_bf16 a[64:67], a[236:239], a[240:243], a[64:67]
buffer_load_dwordx4 v13, s[8:11], s35 offen offset:1024 nt lds
v_mfma_f32_16x16x32_bf16 v[240:243], a[200:203], a[240:243], v[240:243]
s_waitcnt lgkmcnt(2)
v_mfma_f32_16x16x32_bf16 a[28:31], a[232:235], a[244:247], a[28:31]
s_waitcnt lgkmcnt(0)
s_barrier
ds_read_b128 a[240:243], v1
v_mfma_f32_16x16x32_bf16 a[68:71], a[236:239], a[244:247], a[68:71]
buffer_load_dwordx4 v14, s[8:11], s35 offen offset:2048 nt lds
v_mfma_f32_16x16x32_bf16 v[244:247], a[200:203], a[244:247], v[244:247]
v_mfma_f32_16x16x32_bf16 a[32:35], a[232:235], a[248:251], a[32:35]
ds_read_b128 a[244:247], v1 offset:1024
v_mfma_f32_16x16x32_bf16 v[208:211], a[236:239], a[248:251], v[208:211]
buffer_load_dwordx4 v15, s[8:11], s35 offen offset:3072 nt lds
v_mfma_f32_16x16x32_bf16 v[248:251], a[200:203], a[248:251], v[248:251]
ds_write_b128 v7, v[56:59] offset:40960
v_mfma_f32_16x16x32_bf16 a[36:39], a[232:235], a[252:255], a[36:39]
ds_read_b128 a[248:251], v1 offset:2048
v_mfma_f32_16x16x32_bf16 v[212:215], a[236:239], a[252:255], v[212:215]
v_mfma_f32_16x16x32_bf16 v[252:255], a[200:203], a[252:255], v[252:255]
s_waitcnt lgkmcnt(3)
v_mfma_f32_16x16x32_bf16 a[0:3], a[216:219], a[240:243], a[0:3]
ds_read_b128 a[252:255], v1 offset:3072
v_mfma_f32_16x16x32_bf16 a[40:43], a[220:223], a[240:243], a[40:43]
s_waitcnt vmcnt(12)
ds_read_b64_tr_b16 a[232:233], v8 offset:4096
v_mfma_f32_16x16x32_bf16 v[216:219], a[192:195], a[240:243], v[216:219]
s_waitcnt lgkmcnt(4)
ds_read_b64_tr_b16 a[234:235], v8 offset:6144
v_mfma_f32_16x16x32_bf16 a[4:7], a[216:219], a[244:247], a[4:7]
ds_read_b128 a[240:243], v1 offset:4096
v_mfma_f32_16x16x32_bf16 a[44:47], a[220:223], a[244:247], a[44:47]
ds_read_b64_tr_b16 a[236:237], v9 offset:4096
v_mfma_f32_16x16x32_bf16 v[220:223], a[192:195], a[244:247], v[220:223]
s_waitcnt lgkmcnt(5)
ds_read_b64_tr_b16 a[238:239], v9 offset:6144
v_mfma_f32_16x16x32_bf16 a[8:11], a[216:219], a[248:251], a[8:11]
ds_read_b128 a[244:247], v1 offset:5120
v_mfma_f32_16x16x32_bf16 a[48:51], a[220:223], a[248:251], a[48:51]
ds_read_b64_tr_b16 a[200:201], v10 offset:4096
v_mfma_f32_16x16x32_bf16 v[224:227], a[192:195], a[248:251], v[224:227]
s_waitcnt lgkmcnt(7)
ds_read_b64_tr_b16 a[202:203], v10 offset:6144
v_mfma_f32_16x16x32_bf16 a[12:15], a[216:219], a[252:255], a[12:15]
ds_read_b128 a[248:251], v1 offset:6144
v_mfma_f32_16x16x32_bf16 a[52:55], a[220:223], a[252:255], a[52:55]
ds_write_b128 v7, v[72:75] offset:41984
v_mfma_f32_16x16x32_bf16 v[228:231], a[192:195], a[252:255], v[228:231]
s_waitcnt lgkmcnt(7)
v_mfma_f32_16x16x32_bf16 a[16:19], a[216:219], a[240:243], a[16:19]
ds_read_b128 a[252:255], v1 offset:7168
v_mfma_f32_16x16x32_bf16 a[56:59], a[220:223], a[240:243], a[56:59]
v_mfma_f32_16x16x32_bf16 v[232:235], a[192:195], a[240:243], v[232:235]
s_waitcnt lgkmcnt(5)
s_add_u32 m0, s33, 0x1000
s_mov_b32 s35, 0x4d000
v_mfma_f32_16x16x32_bf16 a[20:23], a[216:219], a[244:247], a[20:23]
ds_read_b128 a[240:243], v1 offset:8192
v_mfma_f32_16x16x32_bf16 a[60:63], a[220:223], a[244:247], a[60:63]
s_waitcnt lgkmcnt(4)
buffer_load_dwordx4 v12, s[8:11], s35 offen nt lds
v_mfma_f32_16x16x32_bf16 v[236:239], a[192:195], a[244:247], v[236:239]
s_waitcnt lgkmcnt(3)
ds_write_b128 v7, v[88:91] offset:43008
v_mfma_f32_16x16x32_bf16 a[24:27], a[216:219], a[248:251], a[24:27]
ds_read_b128 a[244:247], v1 offset:9216
v_mfma_f32_16x16x32_bf16 a[64:67], a[220:223], a[248:251], a[64:67]
buffer_load_dwordx4 v13, s[8:11], s35 offen offset:1024 nt lds
v_mfma_f32_16x16x32_bf16 v[240:243], a[192:195], a[248:251], v[240:243]
s_waitcnt lgkmcnt(3)
v_mfma_f32_16x16x32_bf16 a[28:31], a[216:219], a[252:255], a[28:31]
ds_read_b128 a[248:251], v1 offset:10240
v_mfma_f32_16x16x32_bf16 a[68:71], a[220:223], a[252:255], a[68:71]
buffer_load_dwordx4 v14, s[8:11], s35 offen offset:2048 nt lds
v_mfma_f32_16x16x32_bf16 v[244:247], a[192:195], a[252:255], v[244:247]
s_waitcnt lgkmcnt(3)
v_mfma_f32_16x16x32_bf16 a[32:35], a[216:219], a[240:243], a[32:35]
ds_read_b128 a[252:255], v1 offset:11264
v_mfma_f32_16x16x32_bf16 v[208:211], a[220:223], a[240:243], v[208:211]
buffer_load_dwordx4 v15, s[8:11], s35 offen offset:3072 nt lds
v_mfma_f32_16x16x32_bf16 v[248:251], a[192:195], a[240:243], v[248:251]
s_waitcnt lgkmcnt(2)
v_mov_b32 v45, s99
v_mfma_f32_16x16x32_bf16 a[36:39], a[216:219], a[244:247], a[36:39]
ds_read_b128 a[240:243], v1 offset:12288
v_add_co_u32 v44, vcc, s98, v1
v_mfma_f32_16x16x32_bf16 v[212:215], a[220:223], a[244:247], v[212:215]
s_nop 0
v_addc_co_u32 v45, vcc, 0, v45, vcc
v_mfma_f32_16x16x32_bf16 v[252:255], a[192:195], a[244:247], v[252:255]
s_waitcnt lgkmcnt(2)
s_mov_b32 m0, s49
s_nop 0
global_load_lds_dwordx4 v[44:45], off
v_mfma_f32_16x16x32_bf16 a[0:3], a[232:235], a[248:251], a[0:3]
ds_read_b128 a[244:247], v1 offset:13312
v_mfma_f32_16x16x32_bf16 a[40:43], a[236:239], a[248:251], a[40:43]
s_waitcnt vmcnt(13)
ds_read_b64_tr_b16 a[216:217], v8 offset:8192
v_mfma_f32_16x16x32_bf16 v[216:219], a[200:203], a[248:251], v[216:219]
s_waitcnt lgkmcnt(3)
ds_read_b64_tr_b16 a[218:219], v8 offset:10240
v_mfma_f32_16x16x32_bf16 a[4:7], a[232:235], a[252:255], a[4:7]
ds_read_b128 a[248:251], v1 offset:14336
v_mfma_f32_16x16x32_bf16 a[44:47], a[236:239], a[252:255], a[44:47]
ds_read_b64_tr_b16 a[220:221], v9 offset:8192
v_mfma_f32_16x16x32_bf16 v[220:223], a[200:203], a[252:255], v[220:223]
s_waitcnt lgkmcnt(5)
ds_read_b64_tr_b16 a[222:223], v9 offset:10240
v_mfma_f32_16x16x32_bf16 a[8:11], a[232:235], a[240:243], a[8:11]
ds_read_b128 a[252:255], v1 offset:15360
v_mfma_f32_16x16x32_bf16 a[48:51], a[236:239], a[240:243], a[48:51]
ds_read_b64_tr_b16 a[192:193], v10 offset:8192
v_mfma_f32_16x16x32_bf16 v[224:227], a[200:203], a[240:243], v[224:227]
s_waitcnt lgkmcnt(7)
ds_read_b64_tr_b16 a[194:195], v10 offset:10240
v_mfma_f32_16x16x32_bf16 a[12:15], a[232:235], a[244:247], a[12:15]
ds_read_b128 a[240:243], v1 offset:16384
v_mfma_f32_16x16x32_bf16 a[52:55], a[236:239], a[244:247], a[52:55]
ds_write_b128 v7, v[104:107] offset:44032
v_mfma_f32_16x16x32_bf16 v[228:231], a[200:203], a[244:247], v[228:231]
s_waitcnt lgkmcnt(7)
ds_write_b128 v7, v[120:123] offset:45056
v_mfma_f32_16x16x32_bf16 a[16:19], a[232:235], a[248:251], a[16:19]
ds_read_b128 a[244:247], v1 offset:17408
v_mfma_f32_16x16x32_bf16 a[56:59], a[236:239], a[248:251], a[56:59]
v_mfma_f32_16x16x32_bf16 v[232:235], a[200:203], a[248:251], v[232:235]
s_waitcnt lgkmcnt(6)
s_add_u32 m0, s33, 0x2000
s_mov_b32 s35, 0x5b000
v_mfma_f32_16x16x32_bf16 a[20:23], a[232:235], a[252:255], a[20:23]
ds_read_b128 a[248:251], v1 offset:18432
v_mfma_f32_16x16x32_bf16 a[60:63], a[236:239], a[252:255], a[60:63]
s_waitcnt lgkmcnt(5)
buffer_load_dwordx4 v12, s[8:11], s35 offen nt lds
v_mfma_f32_16x16x32_bf16 v[236:239], a[200:203], a[252:255], v[236:239]
s_waitcnt lgkmcnt(4)
v_mfma_f32_16x16x32_bf16 a[24:27], a[232:235], a[240:243], a[24:27]
ds_read_b128 a[252:255], v1 offset:19456
v_mfma_f32_16x16x32_bf16 a[64:67], a[236:239], a[240:243], a[64:67]
buffer_load_dwordx4 v13, s[8:11], s35 offen offset:1024 nt lds
v_mfma_f32_16x16x32_bf16 v[240:243], a[200:203], a[240:243], v[240:243]
s_waitcnt lgkmcnt(2)
v_mfma_f32_16x16x32_bf16 a[28:31], a[232:235], a[244:247], a[28:31]
ds_read_b128 a[240:243], v1 offset:20480
v_mfma_f32_16x16x32_bf16 a[68:71], a[236:239], a[244:247], a[68:71]
buffer_load_dwordx4 v14, s[8:11], s35 offen offset:2048 nt lds
v_mfma_f32_16x16x32_bf16 v[244:247], a[200:203], a[244:247], v[244:247]
s_waitcnt lgkmcnt(2)
ds_write_b128 v7, v[128:131] offset:46080
v_mfma_f32_16x16x32_bf16 a[32:35], a[232:235], a[248:251], a[32:35]
ds_read_b128 a[244:247], v1 offset:21504
v_mfma_f32_16x16x32_bf16 v[208:211], a[236:239], a[248:251], v[208:211]
buffer_load_dwordx4 v15, s[8:11], s35 offen offset:3072 nt lds
v_mfma_f32_16x16x32_bf16 v[248:251], a[200:203], a[248:251], v[248:251]
s_waitcnt lgkmcnt(3)
v_mfma_f32_16x16x32_bf16 a[36:39], a[232:235], a[252:255], a[36:39]
ds_read_b128 a[248:251], v1 offset:22528
v_mfma_f32_16x16x32_bf16 v[212:215], a[236:239], a[252:255], v[212:215]
v_mfma_f32_16x16x32_bf16 v[252:255], a[200:203], a[252:255], v[252:255]
s_waitcnt lgkmcnt(3)
v_mfma_f32_16x16x32_bf16 a[0:3], a[216:219], a[240:243], a[0:3]
ds_read_b128 a[252:255], v1 offset:23552
v_mfma_f32_16x16x32_bf16 a[40:43], a[220:223], a[240:243], a[40:43]
s_waitcnt vmcnt(13)
ds_read_b64_tr_b16 a[232:233], v8 offset:12288
v_mfma_f32_16x16x32_bf16 v[216:219], a[192:195], a[240:243], v[216:219]
s_waitcnt lgkmcnt(3)
ds_read_b64_tr_b16 a[234:235], v8 offset:14336
v_mfma_f32_16x16x32_bf16 a[4:7], a[216:219], a[244:247], a[4:7]
ds_read_b128 a[240:243], v1 offset:24576
v_mfma_f32_16x16x32_bf16 a[44:47], a[220:223], a[244:247], a[44:47]
ds_read_b64_tr_b16 a[236:237], v9 offset:12288
v_mfma_f32_16x16x32_bf16 v[220:223], a[192:195], a[244:247], v[220:223]
s_waitcnt lgkmcnt(5)
ds_read_b64_tr_b16 a[238:239], v9 offset:14336
v_mfma_f32_16x16x32_bf16 a[8:11], a[216:219], a[248:251], a[8:11]
ds_read_b128 a[244:247], v1 offset:25600
v_mfma_f32_16x16x32_bf16 a[48:51], a[220:223], a[248:251], a[48:51]
ds_read_b64_tr_b16 a[200:201], v10 offset:12288
v_mfma_f32_16x16x32_bf16 v[224:227], a[192:195], a[248:251], v[224:227]
s_waitcnt lgkmcnt(7)
ds_read_b64_tr_b16 a[202:203], v10 offset:14336
v_mfma_f32_16x16x32_bf16 a[12:15], a[216:219], a[252:255], a[12:15]
ds_read_b128 a[248:251], v1 offset:26624
v_mfma_f32_16x16x32_bf16 a[52:55], a[220:223], a[252:255], a[52:55]
ds_write_b128 v7, v[144:147] offset:47104
v_mfma_f32_16x16x32_bf16 v[228:231], a[192:195], a[252:255], v[228:231]
s_waitcnt lgkmcnt(7)
v_mfma_f32_16x16x32_bf16 a[16:19], a[216:219], a[240:243], a[16:19]
ds_read_b128 a[252:255], v1 offset:27648
v_mfma_f32_16x16x32_bf16 a[56:59], a[220:223], a[240:243], a[56:59]
ds_write_b128 v7, v[160:163] offset:48128
v_mfma_f32_16x16x32_bf16 v[232:235], a[192:195], a[240:243], v[232:235]
s_waitcnt lgkmcnt(6)
s_add_u32 m0, s33, 0x3000
s_mov_b32 s35, 0x69000
v_mfma_f32_16x16x32_bf16 a[20:23], a[216:219], a[244:247], a[20:23]
ds_read_b128 a[240:243], v1 offset:28672
v_mfma_f32_16x16x32_bf16 a[60:63], a[220:223], a[244:247], a[60:63]
s_waitcnt lgkmcnt(5)
buffer_load_dwordx4 v12, s[8:11], s35 offen nt lds
v_mfma_f32_16x16x32_bf16 v[236:239], a[192:195], a[244:247], v[236:239]
s_waitcnt lgkmcnt(4)
v_mfma_f32_16x16x32_bf16 a[24:27], a[216:219], a[248:251], a[24:27]
ds_read_b128 a[244:247], v1 offset:29696
v_mfma_f32_16x16x32_bf16 a[64:67], a[220:223], a[248:251], a[64:67]
buffer_load_dwordx4 v13, s[8:11], s35 offen offset:1024 nt lds
v_mfma_f32_16x16x32_bf16 v[240:243], a[192:195], a[248:251], v[240:243]
s_waitcnt lgkmcnt(3)
v_mfma_f32_16x16x32_bf16 a[28:31], a[216:219], a[252:255], a[28:31]
ds_read_b128 a[248:251], v1 offset:30720
v_mfma_f32_16x16x32_bf16 a[68:71], a[220:223], a[252:255], a[68:71]
buffer_load_dwordx4 v14, s[8:11], s35 offen offset:2048 nt lds
v_mfma_f32_16x16x32_bf16 v[244:247], a[192:195], a[252:255], v[244:247]
s_waitcnt lgkmcnt(2)
v_mfma_f32_16x16x32_bf16 a[32:35], a[216:219], a[240:243], a[32:35]
ds_read_b128 a[252:255], v1 offset:31744
v_mfma_f32_16x16x32_bf16 v[208:211], a[220:223], a[240:243], v[208:211]
buffer_load_dwordx4 v15, s[8:11], s35 offen offset:3072 nt lds
v_mfma_f32_16x16x32_bf16 v[248:251], a[192:195], a[240:243], v[248:251]
s_waitcnt lgkmcnt(2)
ds_write_b128 v7, v[176:179] offset:49152
v_mfma_f32_16x16x32_bf16 a[36:39], a[216:219], a[244:247], a[36:39]
ds_read_b128 a[240:243], v1 offset:32768
v_mfma_f32_16x16x32_bf16 v[212:215], a[220:223], a[244:247], v[212:215]
v_mfma_f32_16x16x32_bf16 v[252:255], a[192:195], a[244:247], v[252:255]
s_waitcnt lgkmcnt(3)
v_mfma_f32_16x16x32_bf16 a[0:3], a[232:235], a[248:251], a[0:3]
ds_read_b128 a[244:247], v1 offset:33792
v_mfma_f32_16x16x32_bf16 a[40:43], a[236:239], a[248:251], a[40:43]
s_waitcnt vmcnt(13)
ds_read_b64_tr_b16 a[216:217], v8
v_mfma_f32_16x16x32_bf16 v[216:219], a[200:203], a[248:251], v[216:219]
s_waitcnt lgkmcnt(4)
ds_read_b64_tr_b16 a[218:219], v8 offset:2048
v_mfma_f32_16x16x32_bf16 a[4:7], a[232:235], a[252:255], a[4:7]
ds_read_b128 a[248:251], v1 offset:34816
v_mfma_f32_16x16x32_bf16 a[44:47], a[236:239], a[252:255], a[44:47]
ds_read_b64_tr_b16 a[220:221], v9
v_mfma_f32_16x16x32_bf16 v[220:223], a[200:203], a[252:255], v[220:223]
s_waitcnt lgkmcnt(5)
ds_read_b64_tr_b16 a[222:223], v9 offset:2048
v_mfma_f32_16x16x32_bf16 a[8:11], a[232:235], a[240:243], a[8:11]
ds_read_b128 a[252:255], v1 offset:35840
v_mfma_f32_16x16x32_bf16 a[48:51], a[236:239], a[240:243], a[48:51]
ds_read_b64_tr_b16 a[192:193], v10
v_mfma_f32_16x16x32_bf16 v[224:227], a[200:203], a[240:243], v[224:227]
s_waitcnt lgkmcnt(7)
ds_read_b64_tr_b16 a[194:195], v10 offset:2048
v_mov_b32 v12, v19
v_mfma_f32_16x16x32_bf16 a[12:15], a[232:235], a[244:247], a[12:15]
ds_read_b128 a[240:243], v1 offset:36864
v_add_u32 v13, s57, v19
v_mfma_f32_16x16x32_bf16 a[52:55], a[236:239], a[244:247], a[52:55]
v_add_u32 v14, s58, v19
v_mfma_f32_16x16x32_bf16 v[228:231], a[200:203], a[244:247], v[228:231]
s_waitcnt lgkmcnt(6)
v_add_u32 v15, s59, v19
v_mfma_f32_16x16x32_bf16 a[16:19], a[232:235], a[248:251], a[16:19]
ds_read_b128 a[244:247], v1 offset:37888
v_mfma_f32_16x16x32_bf16 a[56:59], a[236:239], a[248:251], a[56:59]
ds_write_b128 v7, v[192:195] offset:50176
v_mfma_f32_16x16x32_bf16 v[232:235], a[200:203], a[248:251], v[232:235]
s_waitcnt lgkmcnt(5)
s_add_u32 m0, s33, 0
s_mov_b32 s35, 0x3f000
v_mfma_f32_16x16x32_bf16 a[20:23], a[232:235], a[252:255], a[20:23]
ds_read_b128 a[248:251], v1 offset:38912
v_mfma_f32_16x16x32_bf16 a[60:63], a[236:239], a[252:255], a[60:63]
s_waitcnt lgkmcnt(4)
buffer_load_dwordx4 v12, s[8:11], s35 offen nt lds
v_mfma_f32_16x16x32_bf16 v[236:239], a[200:203], a[252:255], v[236:239]
s_waitcnt lgkmcnt(3)
v_mfma_f32_16x16x32_bf16 a[24:27], a[232:235], a[240:243], a[24:27]
ds_read_b128 a[252:255], v1 offset:39936
v_mfma_f32_16x16x32_bf16 a[64:67], a[236:239], a[240:243], a[64:67]
buffer_load_dwordx4 v13, s[8:11], s35 offen offset:1024 nt lds
v_mfma_f32_16x16x32_bf16 v[240:243], a[200:203], a[240:243], v[240:243]
s_waitcnt lgkmcnt(3)
v_mfma_f32_16x16x32_bf16 a[28:31], a[232:235], a[244:247], a[28:31]
s_waitcnt lgkmcnt(0)
s_barrier
ds_read_b128 a[240:243], v2
v_mfma_f32_16x16x32_bf16 a[68:71], a[236:239], a[244:247], a[68:71]
buffer_load_dwordx4 v14, s[8:11], s35 offen offset:2048 nt lds
v_mfma_f32_16x16x32_bf16 v[244:247], a[200:203], a[244:247], v[244:247]
v_mfma_f32_16x16x32_bf16 a[32:35], a[232:235], a[248:251], a[32:35]
ds_read_b128 a[244:247], v2 offset:1024
v_mfma_f32_16x16x32_bf16 v[208:211], a[236:239], a[248:251], v[208:211]
buffer_load_dwordx4 v15, s[8:11], s35 offen offset:3072 nt lds
v_mfma_f32_16x16x32_bf16 v[248:251], a[200:203], a[248:251], v[248:251]
v_mfma_f32_16x16x32_bf16 a[36:39], a[232:235], a[252:255], a[36:39]
ds_read_b128 a[248:251], v2 offset:2048
v_mfma_f32_16x16x32_bf16 v[212:215], a[236:239], a[252:255], v[212:215]
v_mfma_f32_16x16x32_bf16 v[252:255], a[200:203], a[252:255], v[252:255]
s_waitcnt lgkmcnt(2)
v_mfma_f32_16x16x32_bf16 a[0:3], a[216:219], a[240:243], a[0:3]
ds_read_b128 a[252:255], v2 offset:3072
v_mfma_f32_16x16x32_bf16 a[40:43], a[220:223], a[240:243], a[40:43]
s_waitcnt vmcnt(13)
ds_read_b64_tr_b16 a[232:233], v8 offset:4096
v_mfma_f32_16x16x32_bf16 v[216:219], a[192:195], a[240:243], v[216:219]
s_waitcnt lgkmcnt(3)
ds_read_b64_tr_b16 a[234:235], v8 offset:6144
v_mfma_f32_16x16x32_bf16 a[4:7], a[216:219], a[244:247], a[4:7]
ds_read_b128 a[240:243], v2 offset:4096
v_mfma_f32_16x16x32_bf16 a[44:47], a[220:223], a[244:247], a[44:47]
ds_read_b64_tr_b16 a[236:237], v9 offset:4096
v_mfma_f32_16x16x32_bf16 v[220:223], a[192:195], a[244:247], v[220:223]
s_waitcnt lgkmcnt(5)
ds_read_b64_tr_b16 a[238:239], v9 offset:6144
v_mfma_f32_16x16x32_bf16 a[8:11], a[216:219], a[248:251], a[8:11]
ds_read_b128 a[244:247], v2 offset:5120
v_mfma_f32_16x16x32_bf16 a[48:51], a[220:223], a[248:251], a[48:51]
ds_read_b64_tr_b16 a[200:201], v10 offset:4096
v_mfma_f32_16x16x32_bf16 v[224:227], a[192:195], a[248:251], v[224:227]
s_waitcnt lgkmcnt(7)
ds_read_b64_tr_b16 a[202:203], v10 offset:6144
v_mfma_f32_16x16x32_bf16 a[12:15], a[216:219], a[252:255], a[12:15]
ds_read_b128 a[248:251], v2 offset:6144
v_mfma_f32_16x16x32_bf16 a[52:55], a[220:223], a[252:255], a[52:55]
v_mfma_f32_16x16x32_bf16 v[228:231], a[192:195], a[252:255], v[228:231]
s_waitcnt lgkmcnt(6)
v_mfma_f32_16x16x32_bf16 a[16:19], a[216:219], a[240:243], a[16:19]
ds_read_b128 a[252:255], v2 offset:7168
v_mfma_f32_16x16x32_bf16 a[56:59], a[220:223], a[240:243], a[56:59]
v_mfma_f32_16x16x32_bf16 v[232:235], a[192:195], a[240:243], v[232:235]
s_waitcnt lgkmcnt(4)
s_add_u32 m0, s33, 0x1000
s_mov_b32 s35, 0x4d000
v_mfma_f32_16x16x32_bf16 a[20:23], a[216:219], a[244:247], a[20:23]
ds_read_b128 a[240:243], v2 offset:8192
v_mfma_f32_16x16x32_bf16 a[60:63], a[220:223], a[244:247], a[60:63]
s_waitcnt lgkmcnt(3)
buffer_load_dwordx4 v12, s[8:11], s35 offen nt lds
v_mfma_f32_16x16x32_bf16 v[236:239], a[192:195], a[244:247], v[236:239]
s_waitcnt lgkmcnt(2)
v_mfma_f32_16x16x32_bf16 a[24:27], a[216:219], a[248:251], a[24:27]
ds_read_b128 a[244:247], v2 offset:9216
v_mfma_f32_16x16x32_bf16 a[64:67], a[220:223], a[248:251], a[64:67]
buffer_load_dwordx4 v13, s[8:11], s35 offen offset:1024 nt lds
v_mfma_f32_16x16x32_bf16 v[240:243], a[192:195], a[248:251], v[240:243]
s_waitcnt lgkmcnt(2)
v_mfma_f32_16x16x32_bf16 a[28:31], a[216:219], a[252:255], a[28:31]
ds_read_b128 a[248:251], v2 offset:10240
v_mfma_f32_16x16x32_bf16 a[68:71], a[220:223], a[252:255], a[68:71]
buffer_load_dwordx4 v14, s[8:11], s35 offen offset:2048 nt lds
v_mfma_f32_16x16x32_bf16 v[244:247], a[192:195], a[252:255], v[244:247]
s_waitcnt lgkmcnt(2)
v_mfma_f32_16x16x32_bf16 a[32:35], a[216:219], a[240:243], a[32:35]
ds_read_b128 a[252:255], v2 offset:11264
v_mfma_f32_16x16x32_bf16 v[208:211], a[220:223], a[240:243], v[208:211]
buffer_load_dwordx4 v15, s[8:11], s35 offen offset:3072 nt lds
v_mfma_f32_16x16x32_bf16 v[248:251], a[192:195], a[240:243], v[248:251]
s_waitcnt lgkmcnt(2)
v_mfma_f32_16x16x32_bf16 a[36:39], a[216:219], a[244:247], a[36:39]
ds_read_b128 a[240:243], v2 offset:12288
v_mfma_f32_16x16x32_bf16 v[212:215], a[220:223], a[244:247], v[212:215]
v_mfma_f32_16x16x32_bf16 v[252:255], a[192:195], a[244:247], v[252:255]
s_waitcnt lgkmcnt(2)
v_readfirstlane_b32 s30, v22
s_mov_b32 s92, 0x10000
s_nop 1
L_tag:
s_cmp_lg_u32 s30, 0
s_cbranch_scc1 L_tag_ok
s_sub_u32 s92, s92, 1
s_cbranch_scc1 L_tag_ok
s_sleep 8
buffer_load_dword v22, v3, s[68:71], s95 offen sc1
s_waitcnt vmcnt(0)
v_readfirstlane_b32 s30, v22
s_nop 3
s_branch L_tag
L_tag_ok:
v_lshrrev_b32 v0, 4, v1
v_and_b32 v3, 7, v0
v_lshlrev_b32 v3, 2, v3
s_cmp_eq_u32 s32, 0
s_cselect_b32 s36, s73, 0x7f000000
v_lshlrev_b32 v4, 29, v0
v_and_b32 v5, 56, v0
v_lshlrev_b32 v5, 26, v5
v_or_b32 v4, v4, v5
v_lshrrev_b32 v4, 1, v4
v_add_u32 v4, s36, v4
v_and_b32 v6, 15, v0
v_mul_u32_u24 v6, 0x700, v6
v_lshrrev_b32 v5, 4, v0
v_lshl_add_u32 v6, v5, 3, v6
v_mfma_f32_16x16x32_bf16 a[0:3], a[232:235], a[248:251], a[0:3]
ds_read_b128 a[244:247], v2 offset:13312
v_mfma_f32_16x16x32_bf16 a[40:43], a[236:239], a[248:251], a[40:43]
s_waitcnt vmcnt(12)
ds_read_b64_tr_b16 a[216:217], v8 offset:8192
v_mfma_f32_16x16x32_bf16 v[216:219], a[200:203], a[248:251], v[216:219]
s_waitcnt lgkmcnt(3)
ds_read_b64_tr_b16 a[218:219], v8 offset:10240
v_mfma_f32_16x16x32_bf16 a[4:7], a[232:235], a[252:255], a[4:7]
ds_read_b128 a[248:251], v2 offset:14336
v_mfma_f32_16x16x32_bf16 a[44:47], a[236:239], a[252:255], a[44:47]
ds_read_b64_tr_b16 a[220:221], v9 offset:8192
v_mfma_f32_16x16x32_bf16 v[220:223], a[200:203], a[252:255], v[220:223]
s_waitcnt lgkmcnt(5)
ds_read_b64_tr_b16 a[222:223], v9 offset:10240
v_mfma_f32_16x16x32_bf16 a[8:11], a[232:235], a[240:243], a[8:11]
ds_read_b128 a[252:255], v2 offset:15360
v_mfma_f32_16x16x32_bf16 a[48:51], a[236:239], a[240:243], a[48:51]
ds_read_b64_tr_b16 a[192:193], v10 offset:8192
v_mfma_f32_16x16x32_bf16 v[224:227], a[200:203], a[240:243], v[224:227]
s_waitcnt lgkmcnt(7)
ds_read_b64_tr_b16 a[194:195], v10 offset:10240
v_mfma_f32_16x16x32_bf16 a[12:15], a[232:235], a[244:247], a[12:15]
ds_read_b128 a[240:243], v2 offset:16384
v_mfma_f32_16x16x32_bf16 a[52:55], a[236:239], a[244:247], a[52:55]
v_mfma_f32_16x16x32_bf16 v[228:231], a[200:203], a[244:247], v[228:231]
s_waitcnt lgkmcnt(6)
v_mfma_f32_16x16x32_bf16 a[16:19], a[232:235], a[248:251], a[16:19]
ds_read_b128 a[244:247], v2 offset:17408
v_mfma_f32_16x16x32_bf16 a[56:59], a[236:239], a[248:251], a[56:59]
v_mfma_f32_16x16x32_bf16 v[232:235], a[200:203], a[248:251], v[232:235]
s_waitcnt lgkmcnt(4)
s_add_u32 m0, s33, 0x2000
s_mov_b32 s35, 0x5b000
v_mfma_f32_16x16x32_bf16 a[20:23], a[232:235], a[252:255], a[20:23]
ds_read_b128 a[248:251], v2 offset:18432
v_mfma_f32_16x16x32_bf16 a[60:63], a[236:239], a[252:255], a[60:63]
s_waitcnt lgkmcnt(3)
buffer_load_dwordx4 v12, s[8:11], s35 offen nt lds
v_mfma_f32_16x16x32_bf16 v[236:239], a[200:203], a[252:255], v[236:239]
s_waitcnt lgkmcnt(2)
v_mfma_f32_16x16x32_bf16 a[24:27], a[232:235], a[240:243], a[24:27]
ds_read_b128 a[252:255], v2 offset:19456
v_mfma_f32_16x16x32_bf16 a[64:67], a[236:239], a[240:243], a[64:67]
buffer_load_dwordx4 v13, s[8:11], s35 offen offset:1024 nt lds
v_mfma_f32_16x16x32_bf16 v[240:243], a[200:203], a[240:243], v[240:243]
s_waitcnt lgkmcnt(2)
v_mfma_f32_16x16x32_bf16 a[28:31], a[232:235], a[244:247], a[28:31]
ds_read_b128 a[240:243], v2 offset:20480
v_mfma_f32_16x16x32_bf16 a[68:71], a[236:239], a[244:247], a[68:71]
buffer_load_dwordx4 v14, s[8:11], s35 offen offset:2048 nt lds
v_mfma_f32_16x16x32_bf16 v[244:247], a[200:203], a[244:247], v[244:247]
s_waitcnt lgkmcnt(2)
v_mfma_f32_16x16x32_bf16 a[32:35], a[232:235], a[248:251], a[32:35]
ds_read_b128 a[244:247], v2 offset:21504
v_mfma_f32_16x16x32_bf16 v[208:211], a[236:239], a[248:251], v[208:211]
buffer_load_dwordx4 v15, s[8:11], s35 offen offset:3072 nt lds
v_mfma_f32_16x16x32_bf16 v[248:251], a[200:203], a[248:251], v[248:251]
s_waitcnt lgkmcnt(2)
v_mfma_f32_16x16x32_bf16 a[36:39], a[232:235], a[252:255], a[36:39]
ds_read_b128 a[248:251], v2 offset:22528
v_mfma_f32_16x16x32_bf16 v[212:215], a[236:239], a[252:255], v[212:215]
v_mfma_f32_16x16x32_bf16 v[252:255], a[200:203], a[252:255], v[252:255]
s_waitcnt lgkmcnt(2)
v_mfma_f32_16x16x32_bf16 a[0:3], a[216:219], a[240:243], a[0:3]
ds_read_b128 a[252:255], v2 offset:23552
v_mfma_f32_16x16x32_bf16 a[40:43], a[220:223], a[240:243], a[40:43]
s_waitcnt vmcnt(12)
ds_read_b64_tr_b16 a[232:233], v8 offset:12288
v_mfma_f32_16x16x32_bf16 v[216:219], a[192:195], a[240:243], v[216:219]
s_waitcnt lgkmcnt(3)
ds_read_b64_tr_b16 a[234:235], v8 offset:14336
v_mfma_f32_16x16x32_bf16 a[4:7], a[216:219], a[244:247], a[4:7]
ds_read_b128 a[240:243], v2 offset:24576
v_mfma_f32_16x16x32_bf16 a[44:47], a[220:223], a[244:247], a[44:47]
ds_read_b64_tr_b16 a[236:237], v9 offset:12288
v_mfma_f32_16x16x32_bf16 v[220:223], a[192:195], a[244:247], v[220:223]
s_waitcnt lgkmcnt(5)
ds_read_b64_tr_b16 a[238:239], v9 offset:14336
v_mfma_f32_16x16x32_bf16 a[8:11], a[216:219], a[248:251], a[8:11]
ds_read_b128 a[244:247], v2 offset:25600
v_mfma_f32_16x16x32_bf16 a[48:51], a[220:223], a[248:251], a[48:51]
ds_read_b64_tr_b16 a[200:201], v10 offset:12288
v_mfma_f32_16x16x32_bf16 v[224:227], a[192:195], a[248:251], v[224:227]
s_waitcnt lgkmcnt(7)
ds_read_b64_tr_b16 a[202:203], v10 offset:14336
v_mfma_f32_16x16x32_bf16 a[12:15], a[216:219], a[252:255], a[12:15]
ds_read_b128 a[248:251], v2 offset:26624
v_mfma_f32_16x16x32_bf16 a[52:55], a[220:223], a[252:255], a[52:55]
v_mfma_f32_16x16x32_bf16 v[228:231], a[192:195], a[252:255], v[228:231]
s_waitcnt lgkmcnt(6)
v_mfma_f32_16x16x32_bf16 a[16:19], a[216:219], a[240:243], a[16:19]
ds_read_b128 a[252:255], v2 offset:27648
v_mfma_f32_16x16x32_bf16 a[56:59], a[220:223], a[240:243], a[56:59]
v_mfma_f32_16x16x32_bf16 v[232:235], a[192:195], a[240:243], v[232:235]
s_waitcnt lgkmcnt(4)
s_add_u32 m0, s33, 0x3000
s_mov_b32 s35, 0x69000
v_mfma_f32_16x16x32_bf16 a[20:23], a[216:219], a[244:247], a[20:23]
ds_read_b128 a[240:243], v2 offset:28672
v_mfma_f32_16x16x32_bf16 a[60:63], a[220:223], a[244:247], a[60:63]
s_waitcnt lgkmcnt(3)
buffer_load_dwordx4 v12, s[8:11], s35 offen nt lds
v_mfma_f32_16x16x32_bf16 v[236:239], a[192:195], a[244:247], v[236:239]
s_waitcnt lgkmcnt(2)
v_mfma_f32_16x16x32_bf16 a[24:27], a[216:219], a[248:251], a[24:27]
ds_read_b128 a[244:247], v2 offset:29696
v_mfma_f32_16x16x32_bf16 a[64:67], a[220:223], a[248:251], a[64:67]
buffer_load_dwordx4 v13, s[8:11], s35 offen offset:1024 nt lds
v_mfma_f32_16x16x32_bf16 v[240:243], a[192:195], a[248:251], v[240:243]
s_waitcnt lgkmcnt(2)
v_mfma_f32_16x16x32_bf16 a[28:31], a[216:219], a[252:255], a[28:31]
ds_read_b128 a[248:251], v2 offset:30720
v_mfma_f32_16x16x32_bf16 a[68:71], a[220:223], a[252:255], a[68:71]
buffer_load_dwordx4 v14, s[8:11], s35 offen offset:2048 nt lds
v_mfma_f32_16x16x32_bf16 v[244:247], a[192:195], a[252:255], v[244:247]
s_waitcnt lgkmcnt(2)
v_mfma_f32_16x16x32_bf16 a[32:35], a[216:219], a[240:243], a[32:35]
ds_read_b128 a[252:255], v2 offset:31744
v_mfma_f32_16x16x32_bf16 v[208:211], a[220:223], a[240:243], v[208:211]
buffer_load_dwordx4 v15, s[8:11], s35 offen offset:3072 nt lds
v_mfma_f32_16x16x32_bf16 v[248:251], a[192:195], a[240:243], v[248:251]
s_waitcnt lgkmcnt(2)
v_mfma_f32_16x16x32_bf16 a[36:39], a[216:219], a[244:247], a[36:39]
ds_read_b128 a[240:243], v2 offset:32768
v_mfma_f32_16x16x32_bf16 v[212:215], a[220:223], a[244:247], v[212:215]
v_mfma_f32_16x16x32_bf16 v[252:255], a[192:195], a[244:247], v[252:255]
s_waitcnt lgkmcnt(2)
v_mfma_f32_16x16x32_bf16 a[0:3], a[232:235], a[248:251], a[0:3]
ds_read_b128 a[244:247], v2 offset:33792
v_mfma_f32_16x16x32_bf16 a[40:43], a[236:239], a[248:251], a[40:43]
s_waitcnt vmcnt(12)
ds_read_b64_tr_b16 a[216:217], v8
v_mfma_f32_16x16x32_bf16 v[216:219], a[200:203], a[248:251], v[216:219]
s_waitcnt lgkmcnt(3)
ds_read_b64_tr_b16 a[218:219], v8 offset:2048
v_mfma_f32_16x16x32_bf16 a[4:7], a[232:235], a[252:255], a[4:7]
ds_read_b128 a[248:251], v2 offset:34816
v_mfma_f32_16x16x32_bf16 a[44:47], a[236:239], a[252:255], a[44:47]
ds_read_b64_tr_b16 a[220:221], v9
v_mfma_f32_16x16x32_bf16 v[220:223], a[200:203], a[252:255], v[220:223]
s_waitcnt lgkmcnt(5)
ds_read_b64_tr_b16 a[222:223], v9 offset:2048
v_mfma_f32_16x16x32_bf16 a[8:11], a[232:235], a[240:243], a[8:11]
ds_read_b128 a[252:255], v2 offset:35840
v_mfma_f32_16x16x32_bf16 a[48:51], a[236:239], a[240:243], a[48:51]
ds_read_b64_tr_b16 a[192:193], v10
v_mfma_f32_16x16x32_bf16 v[224:227], a[200:203], a[240:243], v[224:227]
s_waitcnt lgkmcnt(7)
ds_read_b64_tr_b16 a[194:195], v10 offset:2048
v_mfma_f32_16x16x32_bf16 a[12:15], a[232:235], a[244:247], a[12:15]
ds_read_b128 a[240:243], v2 offset:36864
v_mfma_f32_16x16x32_bf16 a[52:55], a[236:239], a[244:247], a[52:55]
ds_read_b64_tr_b16 a[196:197], v11
v_mfma_f32_16x16x32_bf16 v[228:231], a[200:203], a[244:247], v[228:231]
s_waitcnt lgkmcnt(7)
ds_read_b64_tr_b16 a[198:199], v11 offset:2048
v_mfma_f32_16x16x32_bf16 a[16:19], a[232:235], a[248:251], a[16:19]
ds_read_b128 a[244:247], v2 offset:37888
v_mfma_f32_16x16x32_bf16 a[56:59], a[236:239], a[248:251], a[56:59]
v_mfma_f32_16x16x32_bf16 v[232:235], a[200:203], a[248:251], v[232:235]
s_waitcnt lgkmcnt(6)
s_add_u32 m0, s33, 0
s_mov_b32 s35, 0x38000
v_mfma_f32_16x16x32_bf16 a[20:23], a[232:235], a[252:255], a[20:23]
ds_read_b128 a[248:251], v2 offset:38912
v_mfma_f32_16x16x32_bf16 a[60:63], a[236:239], a[252:255], a[60:63]
s_waitcnt lgkmcnt(2)
buffer_load_dwordx4 v12, s[8:11], s35 offen nt lds
v_mfma_f32_16x16x32_bf16 v[236:239], a[200:203], a[252:255], v[236:239]
v_mfma_f32_16x16x32_bf16 a[24:27], a[232:235], a[240:243], a[24:27]
ds_read_b128 a[252:255], v2 offset:39936
v_mfma_f32_16x16x32_bf16 a[64:67], a[236:239], a[240:243], a[64:67]
buffer_load_dwordx4 v13, s[8:11], s35 offen offset:1024 nt lds
v_mfma_f32_16x16x32_bf16 v[240:243], a[200:203], a[240:243], v[240:243]
s_waitcnt lgkmcnt(2)
v_mfma_f32_16x16x32_bf16 a[28:31], a[232:235], a[244:247], a[28:31]
ds_read_b128 a[240:243], v2
v_mfma_f32_16x16x32_bf16 a[68:71], a[236:239], a[244:247], a[68:71]
buffer_load_dwordx4 v14, s[8:11], s35 offen offset:2048 nt lds
v_mfma_f32_16x16x32_bf16 v[244:247], a[200:203], a[244:247], v[244:247]
s_waitcnt lgkmcnt(2)
v_mfma_f32_16x16x32_bf16 a[32:35], a[232:235], a[248:251], a[32:35]
ds_read_b128 a[244:247], v2 offset:1024
v_mfma_f32_16x16x32_bf16 v[208:211], a[236:239], a[248:251], v[208:211]
buffer_load_dwordx4 v15, s[8:11], s35 offen offset:3072 nt lds
v_mfma_f32_16x16x32_bf16 v[248:251], a[200:203], a[248:251], v[248:251]
s_waitcnt lgkmcnt(2)
v_mfma_f32_16x16x32_bf16 a[36:39], a[232:235], a[252:255], a[36:39]
ds_read_b128 a[248:251], v2 offset:2048
v_mfma_f32_16x16x32_bf16 v[212:215], a[236:239], a[252:255], v[212:215]
v_mfma_f32_16x16x32_bf16 v[252:255], a[200:203], a[252:255], v[252:255]
s_waitcnt lgkmcnt(2)
v_mfma_f32_16x16x32_bf16 v[48:51], a[216:219], a[240:243], 0
ds_read_b128 a[252:255], v2 offset:3072
v_mfma_f32_16x16x32_bf16 v[88:91], a[220:223], a[240:243], 0
s_waitcnt vmcnt(12)
ds_read_b64_tr_b16 a[232:233], v8 offset:4096
v_mfma_f32_16x16x32_bf16 v[128:131], a[192:195], a[240:243], 0
ds_read_b64_tr_b16 a[234:235], v8 offset:6144
v_mfma_f32_16x16x32_bf16 v[168:171], a[196:199], a[240:243], 0
s_waitcnt lgkmcnt(4)
v_mfma_f32_16x16x32_bf16 v[52:55], a[216:219], a[244:247], 0
ds_read_b128 a[240:243], v2 offset:4096
s_mul_i32 s93, s32, 0x3c00
v_mfma_f32_16x16x32_bf16 v[92:95], a[220:223], a[244:247], 0
ds_read_b64_tr_b16 a[236:237], v9 offset:4096
s_add_u32 s93, s93, 0x14000
v_mfma_f32_16x16x32_bf16 v[132:135], a[192:195], a[244:247], 0
ds_read_b64_tr_b16 a[238:239], v9 offset:6144
s_add_u32 s93, s93, s51
v_mfma_f32_16x16x32_bf16 v[172:175], a[196:199], a[244:247], 0
s_waitcnt lgkmcnt(6)
v_accvgpr_read_b32 v24, a0
v_accvgpr_read_b32 v25, a1
v_mfma_f32_16x16x32_bf16 v[56:59], a[216:219], a[248:251], 0
ds_read_b128 a[244:247], v2 offset:5120
v_accvgpr_read_b32 v26, a2
v_mfma_f32_16x16x32_bf16 v[96:99], a[220:223], a[248:251], 0
ds_read_b64_tr_b16 a[200:201], v10 offset:4096
v_accvgpr_read_b32 v27, a3
v_mfma_f32_16x16x32_bf16 v[136:139], a[192:195], a[248:251], 0
ds_read_b64_tr_b16 a[202:203], v10 offset:6144
v_accvgpr_read_b32 v28, a4
v_mfma_f32_16x16x32_bf16 v[176:179], a[196:199], a[248:251], 0
s_waitcnt lgkmcnt(8)
v_accvgpr_read_b32 v29, a5
v_accvgpr_read_b32 v30, a6
v_mfma_f32_16x16x32_bf16 v[60:63], a[216:219], a[252:255], 0
ds_read_b128 a[248:251], v2 offset:6144
v_accvgpr_read_b32 v31, a7
v_cvt_pk_bf16_f32 v24, v24, v25
v_mfma_f32_16x16x32_bf16 v[100:103], a[220:223], a[252:255], 0
ds_read_b64_tr_b16 a[204:205], v11 offset:4096
v_cvt_pk_bf16_f32 v25, v26, v27
v_mfma_f32_16x16x32_bf16 v[140:143], a[192:195], a[252:255], 0
ds_read_b64_tr_b16 a[206:207], v11 offset:6144
v_cvt_pk_bf16_f32 v26, v28, v29
v_mfma_f32_16x16x32_bf16 v[180:183], a[196:199], a[252:255], 0
s_waitcnt lgkmcnt(8)
v_cvt_pk_bf16_f32 v27, v30, v31
s_add_u32 s94, s93, 0
v_mfma_f32_16x16x32_bf16 v[64:67], a[216:219], a[240:243], 0
ds_read_b128 a[252:255], v2 offset:7168
v_mfma_f32_16x16x32_bf16 v[104:107], a[220:223], a[240:243], 0
buffer_store_dwordx4 v[24:27], v1, s[24:27], s94 offen sc1
v_mfma_f32_16x16x32_bf16 v[144:147], a[192:195], a[240:243], 0
v_accvgpr_read_b32 v32, a8
v_mfma_f32_16x16x32_bf16 v[184:187], a[196:199], a[240:243], 0
s_waitcnt lgkmcnt(6)
v_accvgpr_read_b32 v33, a9
v_accvgpr_read_b32 v34, a10
v_mfma_f32_16x16x32_bf16 v[68:71], a[216:219], a[244:247], 0
ds_read_b128 a[240:243], v2 offset:8192
v_accvgpr_read_b32 v35, a11
v_mfma_f32_16x16x32_bf16 v[108:111], a[220:223], a[244:247], 0
s_add_u32 m0, s33, 0x1000
s_mov_b32 s35, 0x46000
v_accvgpr_read_b32 v36, a12
v_mfma_f32_16x16x32_bf16 v[148:151], a[192:195], a[244:247], 0
s_waitcnt lgkmcnt(2)
buffer_load_dwordx4 v12, s[8:11], s35 offen nt lds
v_accvgpr_read_b32 v37, a13
v_mfma_f32_16x16x32_bf16 v[188:191], a[196:199], a[244:247], 0
v_accvgpr_read_b32 v38, a14
v_accvgpr_read_b32 v39, a15
v_mfma_f32_16x16x32_bf16 v[72:75], a[216:219], a[248:251], 0
ds_read_b128 a[244:247], v2 offset:9216
v_cvt_pk_bf16_f32 v32, v32, v33
v_mfma_f32_16x16x32_bf16 v[112:115], a[220:223], a[248:251], 0
buffer_load_dwordx4 v13, s[8:11], s35 offen offset:1024 nt lds
v_cvt_pk_bf16_f32 v33, v34, v35
v_mfma_f32_16x16x32_bf16 v[152:155], a[192:195], a[248:251], 0
v_cvt_pk_bf16_f32 v34, v36, v37
v_cvt_pk_bf16_f32 v35, v38, v39
v_mfma_f32_16x16x32_bf16 v[192:195], a[196:199], a[248:251], 0
s_waitcnt lgkmcnt(2)
s_add_u32 s94, s93, 0x400
v_mfma_f32_16x16x32_bf16 v[76:79], a[216:219], a[252:255], 0
ds_read_b128 a[248:251], v2 offset:10240
v_mfma_f32_16x16x32_bf16 v[116:119], a[220:223], a[252:255], 0
buffer_load_dwordx4 v14, s[8:11], s35 offen offset:2048 nt lds
v_mfma_f32_16x16x32_bf16 v[156:159], a[192:195], a[252:255], 0
buffer_store_dwordx4 v[32:35], v1, s[24:27], s94 offen sc1
v_accvgpr_read_b32 v40, a16
v_accvgpr_read_b32 v41, a17
v_mfma_f32_16x16x32_bf16 v[196:199], a[196:199], a[252:255], 0
s_waitcnt lgkmcnt(2)
v_accvgpr_read_b32 v42, a18
v_accvgpr_read_b32 v43, a19
v_mfma_f32_16x16x32_bf16 v[80:83], a[216:219], a[240:243], 0
ds_read_b128 a[252:255], v2 offset:11264
v_accvgpr_read_b32 v44, a20
v_mfma_f32_16x16x32_bf16 v[120:123], a[220:223], a[240:243], 0
buffer_load_dwordx4 v15, s[8:11], s35 offen offset:3072 nt lds
v_accvgpr_read_b32 v45, a21
v_mfma_f32_16x16x32_bf16 v[160:163], a[192:195], a[240:243], 0
v_accvgpr_read_b32 v46, a22
v_accvgpr_read_b32 v47, a23
v_mfma_f32_16x16x32_bf16 v[200:203], a[196:199], a[240:243], 0
s_waitcnt lgkmcnt(2)
v_cvt_pk_bf16_f32 v40, v40, v41
v_cvt_pk_bf16_f32 v41, v42, v43
v_mfma_f32_16x16x32_bf16 v[84:87], a[216:219], a[244:247], 0
ds_read_b128 a[240:243], v2 offset:12288
v_cvt_pk_bf16_f32 v42, v44, v45
v_mfma_f32_16x16x32_bf16 v[124:127], a[220:223], a[244:247], 0
v_cvt_pk_bf16_f32 v43, v46, v47
s_add_u32 s94, s93, 0x800
v_mfma_f32_16x16x32_bf16 v[164:167], a[192:195], a[244:247], 0
buffer_store_dwordx4 v[40:43], v1, s[24:27], s94 offen sc1
v_mfma_f32_16x16x32_bf16 v[204:207], a[196:199], a[244:247], 0
s_waitcnt lgkmcnt(2)
v_mfma_f32_16x16x32_bf16 v[48:51], a[232:235], a[248:251], v[48:51]
ds_read_b128 a[244:247], v2 offset:13312
v_accvgpr_read_b32 v24, a24
v_mfma_f32_16x16x32_bf16 v[88:91], a[236:239], a[248:251], v[88:91]
s_waitcnt vmcnt(15)
ds_read_b64_tr_b16 a[216:217], v8 offset:8192
v_accvgpr_read_b32 v25, a25
v_mfma_f32_16x16x32_bf16 v[128:131], a[200:203], a[248:251], v[128:131]
ds_read_b64_tr_b16 a[218:219], v8 offset:10240
v_accvgpr_read_b32 v26, a26
v_mfma_f32_16x16x32_bf16 v[168:171], a[204:207], a[248:251], v[168:171]
s_waitcnt lgkmcnt(4)
v_accvgpr_read_b32 v27, a27
v_accvgpr_read_b32 v28, a28
v_mfma_f32_16x16x32_bf16 v[52:55], a[232:235], a[252:255], v[52:55]
ds_read_b128 a[248:251], v2 offset:14336
v_accvgpr_read_b32 v29, a29
v_mfma_f32_16x16x32_bf16 v[92:95], a[236:239], a[252:255], v[92:95]
ds_read_b64_tr_b16 a[220:221], v9 offset:8192
v_accvgpr_read_b32 v30, a30
v_mfma_f32_16x16x32_bf16 v[132:135], a[200:203], a[252:255], v[132:135]
ds_read_b64_tr_b16 a[222:223], v9 offset:10240
v_accvgpr_read_b32 v31, a31
v_mfma_f32_16x16x32_bf16 v[172:175], a[204:207], a[252:255], v[172:175]
s_waitcnt lgkmcnt(6)
v_cvt_pk_bf16_f32 v24, v24, v25
v_cvt_pk_bf16_f32 v25, v26, v27
v_mfma_f32_16x16x32_bf16 v[56:59], a[232:235], a[240:243], v[56:59]
ds_read_b128 a[252:255], v2 offset:15360
v_cvt_pk_bf16_f32 v26, v28, v29
v_cvt_pk_bf16_f32 v27, v30, v31
v_mfma_f32_16x16x32_bf16 v[96:99], a[236:239], a[240:243], v[96:99]
ds_read_b64_tr_b16 a[192:193], v10 offset:8192
s_add_u32 s94, s93, 0xc00
v_mfma_f32_16x16x32_bf16 v[136:139], a[200:203], a[240:243], v[136:139]
ds_read_b64_tr_b16 a[194:195], v10 offset:10240
v_mfma_f32_16x16x32_bf16 v[176:179], a[204:207], a[240:243], v[176:179]
s_waitcnt lgkmcnt(8)
buffer_store_dwordx4 v[24:27], v1, s[24:27], s94 offen sc1
v_mfma_f32_16x16x32_bf16 v[60:63], a[232:235], a[244:247], v[60:63]
ds_read_b128 a[240:243], v2 offset:16384
v_mfma_f32_16x16x32_bf16 v[100:103], a[236:239], a[244:247], v[100:103]
ds_read_b64_tr_b16 a[196:197], v11 offset:8192
v_accvgpr_read_b32 v32, a32
v_mfma_f32_16x16x32_bf16 v[140:143], a[200:203], a[244:247], v[140:143]
ds_read_b64_tr_b16 a[198:199], v11 offset:10240
v_accvgpr_read_b32 v33, a33
v_mfma_f32_16x16x32_bf16 v[180:183], a[204:207], a[244:247], v[180:183]
s_waitcnt lgkmcnt(8)
v_accvgpr_read_b32 v34, a34
v_accvgpr_read_b32 v35, a35
v_mfma_f32_16x16x32_bf16 v[64:67], a[232:235], a[248:251], v[64:67]
ds_read_b128 a[244:247], v2 offset:17408
v_accvgpr_read_b32 v36, a36
v_mfma_f32_16x16x32_bf16 v[104:107], a[236:239], a[248:251], v[104:107]
v_accvgpr_read_b32 v37, a37
v_accvgpr_read_b32 v38, a38
v_mfma_f32_16x16x32_bf16 v[144:147], a[200:203], a[248:251], v[144:147]
v_accvgpr_read_b32 v39, a39
v_cvt_pk_bf16_f32 v32, v32, v33
v_mfma_f32_16x16x32_bf16 v[184:187], a[204:207], a[248:251], v[184:187]
s_waitcnt lgkmcnt(6)
v_cvt_pk_bf16_f32 v33, v34, v35
v_cvt_pk_bf16_f32 v34, v36, v37
v_mfma_f32_16x16x32_bf16 v[68:71], a[232:235], a[252:255], v[68:71]
ds_read_b128 a[248:251], v2 offset:18432
v_cvt_pk_bf16_f32 v35, v38, v39
v_mfma_f32_16x16x32_bf16 v[108:111], a[236:239], a[252:255], v[108:111]
s_add_u32 m0, s33, 0x2000
s_mov_b32 s35, 0x54000
s_add_u32 s94, s93, 0x1000
v_mfma_f32_16x16x32_bf16 v[148:151], a[200:203], a[252:255], v[148:151]
s_waitcnt lgkmcnt(2)
buffer_load_dwordx4 v12, s[8:11], s35 offen nt lds
v_mfma_f32_16x16x32_bf16 v[188:191], a[204:207], a[252:255], v[188:191]
buffer_store_dwordx4 v[32:35], v1, s[24:27], s94 offen sc1
v_mfma_f32_16x16x32_bf16 v[72:75], a[232:235], a[240:243], v[72:75]
ds_read_b128 a[252:255], v2 offset:19456
v_mfma_f32_16x16x32_bf16 v[112:115], a[236:239], a[240:243], v[112:115]
buffer_load_dwordx4 v13, s[8:11], s35 offen offset:1024 nt lds
v_accvgpr_read_b32 v40, a40
v_accvgpr_read_b32 v41, a41
v_mfma_f32_16x16x32_bf16 v[152:155], a[200:203], a[240:243], v[152:155]
v_accvgpr_read_b32 v42, a42
v_accvgpr_read_b32 v43, a43
v_mfma_f32_16x16x32_bf16 v[192:195], a[204:207], a[240:243], v[192:195]
s_waitcnt lgkmcnt(2)
v_accvgpr_read_b32 v44, a44
v_accvgpr_read_b32 v45, a45
v_mfma_f32_16x16x32_bf16 v[76:79], a[232:235], a[244:247], v[76:79]
ds_read_b128 a[240:243], v2 offset:20480
v_accvgpr_read_b32 v46, a46
v_mfma_f32_16x16x32_bf16 v[116:119], a[236:239], a[244:247], v[116:119]
buffer_load_dwordx4 v14, s[8:11], s35 offen offset:2048 nt lds
v_accvgpr_read_b32 v47, a47
v_mfma_f32_16x16x32_bf16 v[156:159], a[200:203], a[244:247], v[156:159]
v_cvt_pk_bf16_f32 v40, v40, v41
v_cvt_pk_bf16_f32 v41, v42, v43
v_mfma_f32_16x16x32_bf16 v[196:199], a[204:207], a[244:247], v[196:199]
s_waitcnt lgkmcnt(2)
v_cvt_pk_bf16_f32 v42, v44, v45
v_cvt_pk_bf16_f32 v43, v46, v47
v_mfma_f32_16x16x32_bf16 v[80:83], a[232:235], a[248:251], v[80:83]
ds_read_b128 a[244:247], v2 offset:21504
s_add_u32 s94, s93, 0x1400
v_mfma_f32_16x16x32_bf16 v[120:123], a[236:239], a[248:251], v[120:123]
buffer_load_dwordx4 v15, s[8:11], s35 offen offset:3072 nt lds
v_mfma_f32_16x16x32_bf16 v[160:163], a[200:203], a[248:251], v[160:163]
buffer_store_dwordx4 v[40:43], v1, s[24:27], s94 offen sc1
v_mfma_f32_16x16x32_bf16 v[200:203], a[204:207], a[248:251], v[200:203]
s_waitcnt lgkmcnt(2)
v_accvgpr_read_b32 v24, a48
v_mfma_f32_16x16x32_bf16 v[84:87], a[232:235], a[252:255], v[84:87]
ds_read_b128 a[248:251], v2 offset:22528
v_accvgpr_read_b32 v25, a49
v_mfma_f32_16x16x32_bf16 v[124:127], a[236:239], a[252:255], v[124:127]
v_accvgpr_read_b32 v26, a50
v_accvgpr_read_b32 v27, a51
v_mfma_f32_16x16x32_bf16 v[164:167], a[200:203], a[252:255], v[164:167]
v_accvgpr_read_b32 v28, a52
v_accvgpr_read_b32 v29, a53
v_mfma_f32_16x16x32_bf16 v[204:207], a[204:207], a[252:255], v[204:207]
s_waitcnt lgkmcnt(2)
v_accvgpr_read_b32 v30, a54
v_accvgpr_read_b32 v31, a55
v_mfma_f32_16x16x32_bf16 v[48:51], a[216:219], a[240:243], v[48:51]
ds_read_b128 a[252:255], v2 offset:23552
v_cvt_pk_bf16_f32 v24, v24, v25
v_mfma_f32_16x16x32_bf16 v[88:91], a[220:223], a[240:243], v[88:91]
s_waitcnt vmcnt(18)
ds_read_b64_tr_b16 a[232:233], v8 offset:12288
v_cvt_pk_bf16_f32 v25, v26, v27
v_mfma_f32_16x16x32_bf16 v[128:131], a[192:195], a[240:243], v[128:131]
ds_read_b64_tr_b16 a[234:235], v8 offset:14336
v_cvt_pk_bf16_f32 v26, v28, v29
v_mfma_f32_16x16x32_bf16 v[168:171], a[196:199], a[240:243], v[168:171]
s_waitcnt lgkmcnt(4)
v_cvt_pk_bf16_f32 v27, v30, v31
s_add_u32 s94, s93, 0x1800
v_mfma_f32_16x16x32_bf16 v[52:55], a[216:219], a[244:247], v[52:55]
ds_read_b128 a[240:243], v2 offset:24576
v_mfma_f32_16x16x32_bf16 v[92:95], a[220:223], a[244:247], v[92:95]
ds_read_b64_tr_b16 a[236:237], v9 offset:12288
v_mfma_f32_16x16x32_bf16 v[132:135], a[192:195], a[244:247], v[132:135]
ds_read_b64_tr_b16 a[238:239], v9 offset:14336
v_mfma_f32_16x16x32_bf16 v[172:175], a[196:199], a[244:247], v[172:175]
s_waitcnt lgkmcnt(6)
buffer_store_dwordx4 v[24:27], v1, s[24:27], s94 offen sc1
v_accvgpr_read_b32 v32, a56
v_accvgpr_read_b32 v33, a57
v_mfma_f32_16x16x32_bf16 v[56:59], a[216:219], a[248:251], v[56:59]
ds_read_b128 a[244:247], v2 offset:25600
v_accvgpr_read_b32 v34, a58
v_mfma_f32_16x16x32_bf16 v[96:99], a[220:223], a[248:251], v[96:99]
ds_read_b64_tr_b16 a[200:201], v10 offset:12288
v_accvgpr_read_b32 v35, a59
v_mfma_f32_16x16x32_bf16 v[136:139], a[192:195], a[248:251], v[136:139]
ds_read_b64_tr_b16 a[202:203], v10 offset:14336
v_accvgpr_read_b32 v36, a60
v_mfma_f32_16x16x32_bf16 v[176:179], a[196:199], a[248:251], v[176:179]
s_waitcnt lgkmcnt(8)
v_accvgpr_read_b32 v37, a61
v_accvgpr_read_b32 v38, a62
v_mfma_f32_16x16x32_bf16 v[60:63], a[216:219], a[252:255], v[60:63]
ds_read_b128 a[248:251], v2 offset:26624
v_accvgpr_read_b32 v39, a63
v_mfma_f32_16x16x32_bf16 v[100:103], a[220:223], a[252:255], v[100:103]
ds_read_b64_tr_b16 a[204:205], v11 offset:12288
v_cvt_pk_bf16_f32 v32, v32, v33
v_mfma_f32_16x16x32_bf16 v[140:143], a[192:195], a[252:255], v[140:143]
ds_read_b64_tr_b16 a[206:207], v11 offset:14336
v_cvt_pk_bf16_f32 v33, v34, v35
v_mfma_f32_16x16x32_bf16 v[180:183], a[196:199], a[252:255], v[180:183]
s_waitcnt lgkmcnt(8)
v_cvt_pk_bf16_f32 v34, v36, v37
v_cvt_pk_bf16_f32 v35, v38, v39
v_mfma_f32_16x16x32_bf16 v[64:67], a[216:219], a[240:243], v[64:67]
ds_read_b128 a[252:255], v2 offset:27648
s_add_u32 s94, s93, 0x1c00
v_mfma_f32_16x16x32_bf16 v[104:107], a[220:223], a[240:243], v[104:107]
buffer_store_dwordx4 v[32:35], v1, s[24:27], s94 offen sc1
v_mfma_f32_16x16x32_bf16 v[144:147], a[192:195], a[240:243], v[144:147]
v_mfma_f32_16x16x32_bf16 v[184:187], a[196:199], a[240:243], v[184:187]
s_waitcnt lgkmcnt(6)
v_accvgpr_read_b32 v40, a64
v_accvgpr_read_b32 v41, a65
v_mfma_f32_16x16x32_bf16 v[68:71], a[216:219], a[244:247], v[68:71]
ds_read_b128 a[240:243], v2 offset:28672
v_accvgpr_read_b32 v42, a66
v_mfma_f32_16x16x32_bf16 v[108:111], a[220:223], a[244:247], v[108:111]
s_add_u32 m0, s33, 0x3000
s_mov_b32 s35, 0x62000
v_accvgpr_read_b32 v43, a67
v_mfma_f32_16x16x32_bf16 v[148:151], a[192:195], a[244:247], v[148:151]
s_waitcnt lgkmcnt(2)
buffer_load_dwordx4 v12, s[8:11], s35 offen nt lds
v_accvgpr_read_b32 v44, a68
v_accvgpr_read_b32 v45, a69
v_mfma_f32_16x16x32_bf16 v[188:191], a[196:199], a[244:247], v[188:191]
v_accvgpr_read_b32 v46, a70
v_accvgpr_read_b32 v47, a71
v_mfma_f32_16x16x32_bf16 v[72:75], a[216:219], a[248:251], v[72:75]
ds_read_b128 a[244:247], v2 offset:29696
v_cvt_pk_bf16_f32 v40, v40, v41
v_mfma_f32_16x16x32_bf16 v[112:115], a[220:223], a[248:251], v[112:115]
buffer_load_dwordx4 v13, s[8:11], s35 offen offset:1024 nt lds
v_cvt_pk_bf16_f32 v41, v42, v43
v_mfma_f32_16x16x32_bf16 v[152:155], a[192:195], a[248:251], v[152:155]
v_cvt_pk_bf16_f32 v42, v44, v45
v_cvt_pk_bf16_f32 v43, v46, v47
v_mfma_f32_16x16x32_bf16 v[192:195], a[196:199], a[248:251], v[192:195]
s_waitcnt lgkmcnt(2)
s_add_u32 s94, s93, 0x2000
v_mfma_f32_16x16x32_bf16 v[76:79], a[216:219], a[252:255], v[76:79]
ds_read_b128 a[248:251], v2 offset:30720
v_mfma_f32_16x16x32_bf16 v[116:119], a[220:223], a[252:255], v[116:119]
buffer_load_dwordx4 v14, s[8:11], s35 offen offset:2048 nt lds
v_mfma_f32_16x16x32_bf16 v[156:159], a[192:195], a[252:255], v[156:159]
buffer_store_dwordx4 v[40:43], v1, s[24:27], s94 offen sc1
v_cvt_pk_bf16_f32 v208, v208, v209
v_mfma_f32_16x16x32_bf16 v[196:199], a[196:199], a[252:255], v[196:199]
s_waitcnt lgkmcnt(2)
v_cvt_pk_bf16_f32 v209, v210, v211
v_cvt_pk_bf16_f32 v210, v212, v213
v_mfma_f32_16x16x32_bf16 v[80:83], a[216:219], a[240:243], v[80:83]
ds_read_b128 a[252:255], v2 offset:31744
v_cvt_pk_bf16_f32 v211, v214, v215
v_mfma_f32_16x16x32_bf16 v[120:123], a[220:223], a[240:243], v[120:123]
buffer_load_dwordx4 v15, s[8:11], s35 offen offset:3072 nt lds
s_add_u32 s94, s93, 0x2400
v_mfma_f32_16x16x32_bf16 v[160:163], a[192:195], a[240:243], v[160:163]
buffer_store_dwordx4 v[208:211], v1, s[24:27], s94 offen sc1
v_mfma_f32_16x16x32_bf16 v[200:203], a[196:199], a[240:243], v[200:203]
s_waitcnt lgkmcnt(2)
v_mfma_f32_16x16x32_bf16 v[84:87], a[216:219], a[244:247], v[84:87]
ds_read_b128 a[240:243], v2 offset:32768
v_cvt_pk_bf16_f32 v216, v216, v217
v_mfma_f32_16x16x32_bf16 v[124:127], a[220:223], a[244:247], v[124:127]
v_cvt_pk_bf16_f32 v217, v218, v219
v_cvt_pk_bf16_f32 v218, v220, v221
v_mfma_f32_16x16x32_bf16 v[164:167], a[192:195], a[244:247], v[164:167]
v_cvt_pk_bf16_f32 v219, v222, v223
s_add_u32 s94, s93, 0x2800
v_mfma_f32_16x16x32_bf16 v[204:207], a[196:199], a[244:247], v[204:207]
s_waitcnt lgkmcnt(2)
buffer_store_dwordx4 v[216:219], v1, s[24:27], s94 offen sc1
v_mfma_f32_16x16x32_bf16 v[48:51], a[232:235], a[248:251], v[48:51]
ds_read_b128 a[244:247], v2 offset:33792
v_mfma_f32_16x16x32_bf16 v[88:91], a[236:239], a[248:251], v[88:91]
s_waitcnt vmcnt(23)
ds_read_b64_tr_b16 a[216:217], v8
v_cvt_pk_bf16_f32 v224, v224, v225
v_mfma_f32_16x16x32_bf16 v[128:131], a[200:203], a[248:251], v[128:131]
ds_read_b64_tr_b16 a[218:219], v8 offset:2048
v_cvt_pk_bf16_f32 v225, v226, v227
v_mfma_f32_16x16x32_bf16 v[168:171], a[204:207], a[248:251], v[168:171]
s_waitcnt lgkmcnt(4)
v_cvt_pk_bf16_f32 v226, v228, v229
v_cvt_pk_bf16_f32 v227, v230, v231
v_mfma_f32_16x16x32_bf16 v[52:55], a[232:235], a[252:255], v[52:55]
ds_read_b128 a[248:251], v2 offset:34816
s_add_u32 s94, s93, 0x2c00
v_mfma_f32_16x16x32_bf16 v[92:95], a[236:239], a[252:255], v[92:95]
ds_read_b64_tr_b16 a[220:221], v9
v_mfma_f32_16x16x32_bf16 v[132:135], a[200:203], a[252:255], v[132:135]
ds_read_b64_tr_b16 a[222:223], v9 offset:2048
v_mfma_f32_16x16x32_bf16 v[172:175], a[204:207], a[252:255], v[172:175]
s_waitcnt lgkmcnt(6)
buffer_store_dwordx4 v[224:227], v1, s[24:27], s94 offen sc1
v_mfma_f32_16x16x32_bf16 v[56:59], a[232:235], a[240:243], v[56:59]
ds_read_b128 a[252:255], v2 offset:35840
v_cvt_pk_bf16_f32 v232, v232, v233
v_mfma_f32_16x16x32_bf16 v[96:99], a[236:239], a[240:243], v[96:99]
ds_read_b64_tr_b16 a[192:193], v10
v_cvt_pk_bf16_f32 v233, v234, v235
v_mfma_f32_16x16x32_bf16 v[136:139], a[200:203], a[240:243], v[136:139]
ds_read_b64_tr_b16 a[194:195], v10 offset:2048
v_cvt_pk_bf16_f32 v234, v236, v237
v_mfma_f32_16x16x32_bf16 v[176:179], a[204:207], a[240:243], v[176:179]
s_waitcnt lgkmcnt(8)
v_cvt_pk_bf16_f32 v235, v238, v239
s_add_u32 s94, s93, 0x3000
v_mfma_f32_16x16x32_bf16 v[60:63], a[232:235], a[244:247], v[60:63]
ds_read_b128 a[240:243], v2 offset:36864
v_mfma_f32_16x16x32_bf16 v[100:103], a[236:239], a[244:247], v[100:103]
ds_read_b64_tr_b16 a[196:197], v11
v_mfma_f32_16x16x32_bf16 v[140:143], a[200:203], a[244:247], v[140:143]
ds_read_b64_tr_b16 a[198:199], v11 offset:2048
v_mfma_f32_16x16x32_bf16 v[180:183], a[204:207], a[244:247], v[180:183]
s_waitcnt lgkmcnt(8)
buffer_store_dwordx4 v[232:235], v1, s[24:27], s94 offen sc1
v_cvt_pk_bf16_f32 v240, v240, v241
v_mfma_f32_16x16x32_bf16 v[64:67], a[232:235], a[248:251], v[64:67]
ds_read_b128 a[244:247], v2 offset:37888
v_cvt_pk_bf16_f32 v241, v242, v243
v_mfma_f32_16x16x32_bf16 v[104:107], a[236:239], a[248:251], v[104:107]
v_cvt_pk_bf16_f32 v242, v244, v245
v_cvt_pk_bf16_f32 v243, v246, v247
s_add_u32 s94, s93, 0x3400
v_mfma_f32_16x16x32_bf16 v[144:147], a[200:203], a[248:251], v[144:147]
buffer_store_dwordx4 v[240:243], v1, s[24:27], s94 offen sc1
v_mfma_f32_16x16x32_bf16 v[184:187], a[204:207], a[248:251], v[184:187]
s_waitcnt lgkmcnt(6)
v_mfma_f32_16x16x32_bf16 v[68:71], a[232:235], a[252:255], v[68:71]
ds_read_b128 a[248:251], v2 offset:38912
v_cvt_pk_bf16_f32 v248, v248, v249
v_mfma_f32_16x16x32_bf16 v[108:111], a[236:239], a[252:255], v[108:111]
s_add_u32 m0, s33, 0
s_mov_b32 s35, 0x7000
v_cvt_pk_bf16_f32 v249, v250, v251
v_mfma_f32_16x16x32_bf16 v[148:151], a[200:203], a[252:255], v[148:151]
s_waitcnt lgkmcnt(2)
buffer_load_dwordx4 v12, s[8:11], s35 offen nt lds
v_cvt_pk_bf16_f32 v250, v252, v253
v_mfma_f32_16x16x32_bf16 v[188:191], a[204:207], a[252:255], v[188:191]
v_cvt_pk_bf16_f32 v251, v254, v255
s_add_u32 s94, s93, 0x3800
v_mfma_f32_16x16x32_bf16 v[72:75], a[232:235], a[240:243], v[72:75]
ds_read_b128 a[252:255], v2 offset:39936
v_mfma_f32_16x16x32_bf16 v[112:115], a[236:239], a[240:243], v[112:115]
buffer_load_dwordx4 v13, s[8:11], s35 offen offset:1024 nt lds
v_mfma_f32_16x16x32_bf16 v[152:155], a[200:203], a[240:243], v[152:155]
buffer_store_dwordx4 v[248:251], v1, s[24:27], s94 offen sc1
v_mfma_f32_16x16x32_bf16 v[192:195], a[204:207], a[240:243], v[192:195]
s_waitcnt lgkmcnt(2)
v_mfma_f32_16x16x32_bf16 v[76:79], a[232:235], a[244:247], v[76:79]
s_waitcnt lgkmcnt(0)
s_barrier
ds_read_b128 a[240:243], v1
v_mfma_f32_16x16x32_bf16 v[116:119], a[236:239], a[244:247], v[116:119]
buffer_load_dwordx4 v14, s[8:11], s35 offen offset:2048 nt lds
v_mfma_f32_16x16x32_bf16 v[156:159], a[200:203], a[244:247], v[156:159]
v_mfma_f32_16x16x32_bf16 v[196:199], a[204:207], a[244:247], v[196:199]
v_mfma_f32_16x16x32_bf16 v[80:83], a[232:235], a[248:251], v[80:83]
ds_read_b128 a[244:247], v1 offset:1024
v_mfma_f32_16x16x32_bf16 v[120:123], a[236:239], a[248:251], v[120:123]
buffer_load_dwordx4 v15, s[8:11], s35 offen offset:3072 nt lds
v_mfma_f32_16x16x32_bf16 v[160:163], a[200:203], a[248:251], v[160:163]
ds_write_b128 v7, a[152:155] offset:40960
v_mfma_f32_16x16x32_bf16 v[200:203], a[204:207], a[248:251], v[200:203]
v_mfma_f32_16x16x32_bf16 v[84:87], a[232:235], a[252:255], v[84:87]
ds_read_b128 a[248:251], v1 offset:2048
v_mfma_f32_16x16x32_bf16 v[124:127], a[236:239], a[252:255], v[124:127]
v_mfma_f32_16x16x32_bf16 v[164:167], a[200:203], a[252:255], v[164:167]
v_mfma_f32_16x16x32_bf16 v[204:207], a[204:207], a[252:255], v[204:207]
s_waitcnt lgkmcnt(3)
v_mfma_f32_16x16x32_bf16 v[48:51], a[216:219], a[240:243], v[48:51]
ds_read_b128 a[252:255], v1 offset:3072
v_mfma_f32_16x16x32_bf16 v[88:91], a[220:223], a[240:243], v[88:91]
s_waitcnt vmcnt(25)
ds_read_b64_tr_b16 a[232:233], v8 offset:4096
v_mfma_f32_16x16x32_bf16 v[128:131], a[192:195], a[240:243], v[128:131]
ds_read_b64_tr_b16 a[234:235], v8 offset:6144
v_mfma_f32_16x16x32_bf16 v[168:171], a[196:199], a[240:243], v[168:171]
s_waitcnt lgkmcnt(5)
s_lshr_b32 s90, s73, 2
s_add_u32 s90, s90, 20
s_mul_i32 s91, s90, 0xcd
s_lshr_b32 s91, s91, 10
s_mul_i32 s76, s91, 5
s_sub_u32 s76, s90, s76
s_mul_i32 s77, s76, 0xe000
s_add_u32 s77, s77, s75
s_lshl_b32 s91, s91, 2
s_add_u32 s91, s91, s32
s_mul_i32 s97, s91, 5
s_add_u32 s76, s76, s97
s_lshl_b32 s76, s76, 10
s_add_u32 s76, s76, s72
s_lshl_b32 s91, s91, 5
s_add_u32 s77, s77, s91
s_cmp_lt_u32 s90, 35
s_cselect_b32 s76, s76, 0x7f000000
s_cselect_b32 s77, s77, 0x7f000000
ds_read_b64_tr_b16 a[236:237], v9 offset:4096
v_mfma_f32_16x16x32_bf16 v[52:55], a[216:219], a[244:247], v[52:55]
ds_read_b128 a[240:243], v1 offset:4096
v_mfma_f32_16x16x32_bf16 v[92:95], a[220:223], a[244:247], v[92:95]
ds_read_b64_tr_b16 a[238:239], v9 offset:6144
v_mfma_f32_16x16x32_bf16 v[132:135], a[192:195], a[244:247], v[132:135]
ds_read_b64_tr_b16 a[200:201], v10 offset:4096
v_mfma_f32_16x16x32_bf16 v[172:175], a[196:199], a[244:247], v[172:175]
s_waitcnt lgkmcnt(7)
ds_read_b64_tr_b16 a[202:203], v10 offset:6144
v_mfma_f32_16x16x32_bf16 v[56:59], a[216:219], a[248:251], v[56:59]
ds_read_b128 a[244:247], v1 offset:5120
v_mfma_f32_16x16x32_bf16 v[96:99], a[220:223], a[248:251], v[96:99]
ds_read_b64_tr_b16 a[204:205], v11 offset:4096
v_mfma_f32_16x16x32_bf16 v[136:139], a[192:195], a[248:251], v[136:139]
ds_read_b64_tr_b16 a[206:207], v11 offset:6144
v_mfma_f32_16x16x32_bf16 v[176:179], a[196:199], a[248:251], v[176:179]
s_waitcnt lgkmcnt(10)
ds_write_b128 v7, a[156:159] offset:41984
v_mfma_f32_16x16x32_bf16 v[60:63], a[216:219], a[252:255], v[60:63]
ds_read_b128 a[248:251], v1 offset:6144
v_mfma_f32_16x16x32_bf16 v[100:103], a[220:223], a[252:255], v[100:103]
v_mfma_f32_16x16x32_bf16 v[140:143], a[192:195], a[252:255], v[140:143]
s_add_u32 m0, s33, 0x1000
s_mov_b32 s35, 0x15000
v_mfma_f32_16x16x32_bf16 v[180:183], a[196:199], a[252:255], v[180:183]
s_waitcnt lgkmcnt(8)
s_waitcnt lgkmcnt(2)
buffer_load_dwordx4 v12, s[8:11], s35 offen nt lds
v_mfma_f32_16x16x32_bf16 v[64:67], a[216:219], a[240:243], v[64:67]
ds_read_b128 a[252:255], v1 offset:7168
v_mfma_f32_16x16x32_bf16 v[104:107], a[220:223], a[240:243], v[104:107]
buffer_load_dwordx4 v13, s[8:11], s35 offen offset:1024 nt lds
v_mfma_f32_16x16x32_bf16 v[144:147], a[192:195], a[240:243], v[144:147]
buffer_load_dwordx4 v14, s[8:11], s35 offen offset:2048 nt lds
v_mfma_f32_16x16x32_bf16 v[184:187], a[196:199], a[240:243], v[184:187]
buffer_load_dwordx4 v15, s[8:11], s35 offen offset:3072 nt lds
v_mfma_f32_16x16x32_bf16 v[68:71], a[216:219], a[244:247], v[68:71]
ds_read_b128 a[240:243], v1 offset:8192
v_mfma_f32_16x16x32_bf16 v[108:111], a[220:223], a[244:247], v[108:111]
s_waitcnt vmcnt(22)
ds_read_b64_tr_b16 a[0:1], v8 offset:8192
v_mfma_f32_16x16x32_bf16 v[148:151], a[192:195], a[244:247], v[148:151]
ds_read_b64_tr_b16 a[2:3], v8 offset:10240
v_mfma_f32_16x16x32_bf16 v[188:191], a[196:199], a[244:247], v[188:191]
s_waitcnt lgkmcnt(4)
ds_read_b64_tr_b16 a[4:5], v9 offset:8192
v_mfma_f32_16x16x32_bf16 v[72:75], a[216:219], a[248:251], v[72:75]
ds_read_b128 a[244:247], v1 offset:9216
v_mfma_f32_16x16x32_bf16 v[112:115], a[220:223], a[248:251], v[112:115]
ds_read_b64_tr_b16 a[6:7], v9 offset:10240
v_mfma_f32_16x16x32_bf16 v[152:155], a[192:195], a[248:251], v[152:155]
ds_read_b64_tr_b16 a[8:9], v10 offset:8192
v_mfma_f32_16x16x32_bf16 v[192:195], a[196:199], a[248:251], v[192:195]
s_waitcnt lgkmcnt(7)
ds_read_b64_tr_b16 a[10:11], v10 offset:10240
v_mfma_f32_16x16x32_bf16 v[76:79], a[216:219], a[252:255], v[76:79]
ds_read_b128 a[248:251], v1 offset:10240
v_mfma_f32_16x16x32_bf16 v[116:119], a[220:223], a[252:255], v[116:119]
ds_read_b64_tr_b16 a[12:13], v11 offset:8192
v_mfma_f32_16x16x32_bf16 v[156:159], a[192:195], a[252:255], v[156:159]
ds_read_b64_tr_b16 a[14:15], v11 offset:10240
v_mfma_f32_16x16x32_bf16 v[196:199], a[196:199], a[252:255], v[196:199]
s_waitcnt lgkmcnt(10)
ds_write_b128 v7, a[160:163] offset:43008
v_mfma_f32_16x16x32_bf16 v[80:83], a[216:219], a[240:243], v[80:83]
ds_read_b128 a[252:255], v1 offset:11264
v_mfma_f32_16x16x32_bf16 v[120:123], a[220:223], a[240:243], v[120:123]
v_mfma_f32_16x16x32_bf16 v[160:163], a[192:195], a[240:243], v[160:163]
s_add_u32 m0, s33, 0x2000
s_mov_b32 s35, 0x23000
v_mfma_f32_16x16x32_bf16 v[200:203], a[196:199], a[240:243], v[200:203]
s_waitcnt lgkmcnt(8)
s_waitcnt lgkmcnt(2)
buffer_load_dwordx4 v12, s[8:11], s35 offen nt lds
v_mfma_f32_16x16x32_bf16 v[84:87], a[216:219], a[244:247], v[84:87]
ds_read_b128 a[240:243], v1 offset:12288
v_mfma_f32_16x16x32_bf16 v[124:127], a[220:223], a[244:247], v[124:127]
buffer_load_dwordx4 v13, s[8:11], s35 offen offset:1024 nt lds
v_mfma_f32_16x16x32_bf16 v[164:167], a[192:195], a[244:247], v[164:167]
buffer_load_dwordx4 v14, s[8:11], s35 offen offset:2048 nt lds
v_mfma_f32_16x16x32_bf16 v[204:207], a[196:199], a[244:247], v[204:207]
buffer_load_dwordx4 v15, s[8:11], s35 offen offset:3072 nt lds
v_mfma_f32_16x16x32_bf16 v[48:51], a[232:235], a[248:251], v[48:51]
ds_read_b128 a[244:247], v1 offset:13312
v_mfma_f32_16x16x32_bf16 v[88:91], a[236:239], a[248:251], v[88:91]
s_waitcnt vmcnt(18)
ds_read_b64_tr_b16 a[16:17], v8 offset:12288
v_mfma_f32_16x16x32_bf16 v[128:131], a[200:203], a[248:251], v[128:131]
ds_read_b64_tr_b16 a[18:19], v8 offset:14336
v_mfma_f32_16x16x32_bf16 v[168:171], a[204:207], a[248:251], v[168:171]
s_waitcnt lgkmcnt(4)
s_lshr_b32 s90, s73, 2
s_add_u32 s90, s90, 28
s_mul_i32 s91, s90, 0xcd
s_lshr_b32 s91, s91, 10
s_mul_i32 s78, s91, 5
s_sub_u32 s78, s90, s78
s_mul_i32 s79, s78, 0xe000
s_add_u32 s79, s79, s75
s_lshl_b32 s91, s91, 2
s_add_u32 s91, s91, s32
s_mul_i32 s97, s91, 5
s_add_u32 s78, s78, s97
s_lshl_b32 s78, s78, 10
s_add_u32 s78, s78, s72
s_lshl_b32 s91, s91, 5
s_add_u32 s79, s79, s91
s_cmp_lt_u32 s90, 35
s_cselect_b32 s78, s78, 0x7f000000
s_cselect_b32 s79, s79, 0x7f000000
ds_write_b128 v7, a[164:167] offset:44032
v_mfma_f32_16x16x32_bf16 v[52:55], a[232:235], a[252:255], v[52:55]
ds_read_b128 a[248:251], v1 offset:14336
v_mfma_f32_16x16x32_bf16 v[92:95], a[236:239], a[252:255], v[92:95]
ds_read_b64_tr_b16 a[20:21], v9 offset:12288
v_mfma_f32_16x16x32_bf16 v[132:135], a[200:203], a[252:255], v[132:135]
ds_read_b64_tr_b16 a[22:23], v9 offset:14336
v_mfma_f32_16x16x32_bf16 v[172:175], a[204:207], a[252:255], v[172:175]
s_waitcnt lgkmcnt(7)
v_mfma_f32_16x16x32_bf16 v[56:59], a[232:235], a[240:243], v[56:59]
ds_read_b128 a[252:255], v1 offset:15360
v_mfma_f32_16x16x32_bf16 v[96:99], a[236:239], a[240:243], v[96:99]
ds_read_b64_tr_b16 a[24:25], v10 offset:12288
v_mfma_f32_16x16x32_bf16 v[136:139], a[200:203], a[240:243], v[136:139]
ds_read_b64_tr_b16 a[26:27], v10 offset:14336
v_mfma_f32_16x16x32_bf16 v[176:179], a[204:207], a[240:243], v[176:179]
s_waitcnt lgkmcnt(9)
v_mfma_f32_16x16x32_bf16 v[60:63], a[232:235], a[244:247], v[60:63]
ds_read_b128 a[240:243], v1 offset:16384
v_mfma_f32_16x16x32_bf16 v[100:103], a[236:239], a[244:247], v[100:103]
ds_read_b64_tr_b16 a[28:29], v11 offset:12288
v_mfma_f32_16x16x32_bf16 v[140:143], a[200:203], a[244:247], v[140:143]
ds_read_b64_tr_b16 a[30:31], v11 offset:14336
v_mfma_f32_16x16x32_bf16 v[180:183], a[204:207], a[244:247], v[180:183]
s_waitcnt lgkmcnt(8)
ds_write_b128 v7, a[168:171] offset:45056
v_mfma_f32_16x16x32_bf16 v[64:67], a[232:235], a[248:251], v[64:67]
ds_read_b128 a[244:247], v1 offset:17408
v_mfma_f32_16x16x32_bf16 v[104:107], a[236:239], a[248:251], v[104:107]
v_mfma_f32_16x16x32_bf16 v[144:147], a[200:203], a[248:251], v[144:147]
v_mfma_f32_16x16x32_bf16 v[184:187], a[204:207], a[248:251], v[184:187]
s_waitcnt lgkmcnt(7)
v_mfma_f32_16x16x32_bf16 v[68:71], a[232:235], a[252:255], v[68:71]
ds_read_b128 a[248:251], v1 offset:18432
v_mfma_f32_16x16x32_bf16 v[108:111], a[236:239], a[252:255], v[108:111]
s_add_u32 m0, s33, 0x3000
s_mov_b32 s35, 0x31000
v_mfma_f32_16x16x32_bf16 v[148:151], a[200:203], a[252:255], v[148:151]
s_waitcnt lgkmcnt(3)
buffer_load_dwordx4 v12, s[8:11], s35 offen nt lds
v_mfma_f32_16x16x32_bf16 v[188:191], a[204:207], a[252:255], v[188:191]
v_mfma_f32_16x16x32_bf16 v[72:75], a[232:235], a[240:243], v[72:75]
ds_read_b128 a[252:255], v1 offset:19456
v_mfma_f32_16x16x32_bf16 v[112:115], a[236:239], a[240:243], v[112:115]
buffer_load_dwordx4 v13, s[8:11], s35 offen offset:1024 nt lds
v_mfma_f32_16x16x32_bf16 v[152:155], a[200:203], a[240:243], v[152:155]
ds_write_b128 v7, a[172:175] offset:46080
v_mfma_f32_16x16x32_bf16 v[192:195], a[204:207], a[240:243], v[192:195]
s_waitcnt lgkmcnt(3)
v_mfma_f32_16x16x32_bf16 v[76:79], a[232:235], a[244:247], v[76:79]
ds_read_b128 a[240:243], v1 offset:20480
v_mfma_f32_16x16x32_bf16 v[116:119], a[236:239], a[244:247], v[116:119]
buffer_load_dwordx4 v14, s[8:11], s35 offen offset:2048 nt lds
v_mfma_f32_16x16x32_bf16 v[156:159], a[200:203], a[244:247], v[156:159]
v_mfma_f32_16x16x32_bf16 v[196:199], a[204:207], a[244:247], v[196:199]
s_waitcnt lgkmcnt(3)
v_mfma_f32_16x16x32_bf16 v[80:83], a[232:235], a[248:251], v[80:83]
ds_read_b128 a[244:247], v1 offset:21504
v_mfma_f32_16x16x32_bf16 v[120:123], a[236:239], a[248:251], v[120:123]
buffer_load_dwordx4 v15, s[8:11], s35 offen offset:3072 nt lds
v_mfma_f32_16x16x32_bf16 v[160:163], a[200:203], a[248:251], v[160:163]
v_mfma_f32_16x16x32_bf16 v[200:203], a[204:207], a[248:251], v[200:203]
s_waitcnt lgkmcnt(3)
ds_write_b128 v7, a[176:179] offset:47104
v_mfma_f32_16x16x32_bf16 v[84:87], a[232:235], a[252:255], v[84:87]
s_waitcnt vmcnt(14)
s_barrier
ds_read_b128 a[248:251], v1 offset:22528
v_mfma_f32_16x16x32_bf16 v[124:127], a[236:239], a[252:255], v[124:127]
buffer_store_dword v22, v4, s[24:27], s74 offen sc1
v_mfma_f32_16x16x32_bf16 v[164:167], a[200:203], a[252:255], v[164:167]
v_mfma_f32_16x16x32_bf16 v[204:207], a[204:207], a[252:255], v[204:207]
s_waitcnt lgkmcnt(3)
v_mfma_f32_16x16x32_bf16 v[48:51], a[0:3], a[240:243], v[48:51]
ds_read_b128 a[252:255], v1 offset:23552
v_mfma_f32_16x16x32_bf16 v[88:91], a[4:7], a[240:243], v[88:91]
s_waitcnt vmcnt(13)
ds_read_b64_tr_b16 a[32:33], v8
v_mfma_f32_16x16x32_bf16 v[128:131], a[8:11], a[240:243], v[128:131]
ds_read_b64_tr_b16 a[34:35], v8 offset:2048
v_mfma_f32_16x16x32_bf16 v[168:171], a[12:15], a[240:243], v[168:171]
s_waitcnt lgkmcnt(5)
s_mul_i32 s93, s32, 0x5000
s_add_u32 s93, s93, s51
ds_read_b64_tr_b16 a[36:37], v9
v_mfma_f32_16x16x32_bf16 v[52:55], a[0:3], a[244:247], v[52:55]
ds_read_b128 a[240:243], v1 offset:24576
v_mfma_f32_16x16x32_bf16 v[92:95], a[4:7], a[244:247], v[92:95]
ds_read_b64_tr_b16 a[38:39], v9 offset:2048
v_mfma_f32_16x16x32_bf16 v[132:135], a[8:11], a[244:247], v[132:135]
ds_read_b64_tr_b16 a[40:41], v10
v_mfma_f32_16x16x32_bf16 v[172:175], a[12:15], a[244:247], v[172:175]
s_waitcnt lgkmcnt(7)
ds_read_b64_tr_b16 a[42:43], v10 offset:2048
v_mfma_f32_16x16x32_bf16 v[56:59], a[0:3], a[248:251], v[56:59]
ds_read_b128 a[244:247], v1 offset:25600
v_mfma_f32_16x16x32_bf16 v[96:99], a[4:7], a[248:251], v[96:99]
ds_read_b64_tr_b16 a[44:45], v11
v_mfma_f32_16x16x32_bf16 v[136:139], a[8:11], a[248:251], v[136:139]
ds_read_b64_tr_b16 a[46:47], v11 offset:2048
v_mfma_f32_16x16x32_bf16 v[176:179], a[12:15], a[248:251], v[176:179]
s_waitcnt lgkmcnt(10)
v_mfma_f32_16x16x32_bf16 v[60:63], a[0:3], a[252:255], v[60:63]
ds_read_b128 a[248:251], v1 offset:26624
v_mfma_f32_16x16x32_bf16 v[100:103], a[4:7], a[252:255], v[100:103]
ds_write_b128 v7, a[180:183] offset:48128
v_mfma_f32_16x16x32_bf16 v[140:143], a[8:11], a[252:255], v[140:143]
s_add_u32 m0, s33, 0
s_mov_b32 s35, 0
v_mfma_f32_16x16x32_bf16 v[180:183], a[12:15], a[252:255], v[180:183]
s_waitcnt lgkmcnt(8)
s_waitcnt lgkmcnt(2)
buffer_load_dwordx4 v12, s[8:11], s35 offen nt lds
v_mfma_f32_16x16x32_bf16 v[64:67], a[0:3], a[240:243], v[64:67]
ds_read_b128 a[252:255], v1 offset:27648
v_mfma_f32_16x16x32_bf16 v[104:107], a[4:7], a[240:243], v[104:107]
buffer_load_dwordx4 v13, s[8:11], s35 offen offset:1024 nt lds
v_mfma_f32_16x16x32_bf16 v[144:147], a[8:11], a[240:243], v[144:147]
buffer_load_dwordx4 v14, s[8:11], s35 offen offset:2048 nt lds
v_mfma_f32_16x16x32_bf16 v[184:187], a[12:15], a[240:243], v[184:187]
buffer_load_dwordx4 v15, s[8:11], s35 offen offset:3072 nt lds
v_mfma_f32_16x16x32_bf16 v[68:71], a[0:3], a[244:247], v[68:71]
ds_read_b128 a[240:243], v1 offset:28672
v_mfma_f32_16x16x32_bf16 v[108:111], a[4:7], a[244:247], v[108:111]
s_waitcnt vmcnt(13)
ds_read_b64_tr_b16 a[48:49], v8 offset:4096
v_mfma_f32_16x16x32_bf16 v[148:151], a[8:11], a[244:247], v[148:151]
ds_read_b64_tr_b16 a[50:51], v8 offset:6144
v_mfma_f32_16x16x32_bf16 v[188:191], a[12:15], a[244:247], v[188:191]
s_waitcnt lgkmcnt(5)
ds_read_b64_tr_b16 a[52:53], v9 offset:4096
v_mfma_f32_16x16x32_bf16 v[72:75], a[0:3], a[248:251], v[72:75]
ds_read_b128 a[244:247], v1 offset:29696
v_mfma_f32_16x16x32_bf16 v[112:115], a[4:7], a[248:251], v[112:115]
ds_read_b64_tr_b16 a[54:55], v9 offset:6144
v_mfma_f32_16x16x32_bf16 v[152:155], a[8:11], a[248:251], v[152:155]
ds_read_b64_tr_b16 a[56:57], v10 offset:4096
v_mfma_f32_16x16x32_bf16 v[192:195], a[12:15], a[248:251], v[192:195]
s_waitcnt lgkmcnt(7)
ds_read_b64_tr_b16 a[58:59], v10 offset:6144
v_mfma_f32_16x16x32_bf16 v[76:79], a[0:3], a[252:255], v[76:79]
ds_read_b128 a[248:251], v1 offset:30720
v_mfma_f32_16x16x32_bf16 v[116:119], a[4:7], a[252:255], v[116:119]
ds_read_b64_tr_b16 a[60:61], v11 offset:4096
v_mfma_f32_16x16x32_bf16 v[156:159], a[8:11], a[252:255], v[156:159]
ds_read_b64_tr_b16 a[62:63], v11 offset:6144
v_mfma_f32_16x16x32_bf16 v[196:199], a[12:15], a[252:255], v[196:199]
s_waitcnt lgkmcnt(10)
ds_write_b128 v7, a[184:187] offset:49152
v_mfma_f32_16x16x32_bf16 v[80:83], a[0:3], a[240:243], v[80:83]
ds_read_b128 a[252:255], v1 offset:31744
v_mfma_f32_16x16x32_bf16 v[120:123], a[4:7], a[240:243], v[120:123]
v_mfma_f32_16x16x32_bf16 v[160:163], a[8:11], a[240:243], v[160:163]
s_add_u32 m0, s33, 0x1000
s_mov_b32 s35, 0xe000
v_mfma_f32_16x16x32_bf16 v[200:203], a[12:15], a[240:243], v[200:203]
s_waitcnt lgkmcnt(8)
s_waitcnt lgkmcnt(2)
buffer_load_dwordx4 v12, s[8:11], s35 offen nt lds
v_mfma_f32_16x16x32_bf16 v[84:87], a[0:3], a[244:247], v[84:87]
ds_read_b128 a[240:243], v1 offset:32768
v_mfma_f32_16x16x32_bf16 v[124:127], a[4:7], a[244:247], v[124:127]
buffer_load_dwordx4 v13, s[8:11], s35 offen offset:1024 nt lds
v_mfma_f32_16x16x32_bf16 v[164:167], a[8:11], a[244:247], v[164:167]
buffer_load_dwordx4 v14, s[8:11], s35 offen offset:2048 nt lds
v_mfma_f32_16x16x32_bf16 v[204:207], a[12:15], a[244:247], v[204:207]
buffer_load_dwordx4 v15, s[8:11], s35 offen offset:3072 nt lds
v_mfma_f32_16x16x32_bf16 v[48:51], a[16:19], a[248:251], v[48:51]
ds_read_b128 a[244:247], v1 offset:33792
v_mfma_f32_16x16x32_bf16 v[88:91], a[20:23], a[248:251], v[88:91]
s_waitcnt vmcnt(13)
ds_read_b64_tr_b16 a[64:65], v8 offset:8192
v_mfma_f32_16x16x32_bf16 v[128:131], a[24:27], a[248:251], v[128:131]
ds_read_b64_tr_b16 a[66:67], v8 offset:10240
v_mfma_f32_16x16x32_bf16 v[168:171], a[28:31], a[248:251], v[168:171]
s_waitcnt lgkmcnt(4)
ds_write_b128 v7, a[188:191] offset:50176
v_mfma_f32_16x16x32_bf16 v[52:55], a[16:19], a[252:255], v[52:55]
ds_read_b128 a[248:251], v1 offset:34816
v_mfma_f32_16x16x32_bf16 v[92:95], a[20:23], a[252:255], v[92:95]
ds_read_b64_tr_b16 a[68:69], v9 offset:8192
v_mfma_f32_16x16x32_bf16 v[132:135], a[24:27], a[252:255], v[132:135]
ds_read_b64_tr_b16 a[70:71], v9 offset:10240
v_mfma_f32_16x16x32_bf16 v[172:175], a[28:31], a[252:255], v[172:175]
s_waitcnt lgkmcnt(7)
v_mfma_f32_16x16x32_bf16 v[56:59], a[16:19], a[240:243], v[56:59]
ds_read_b128 a[252:255], v1 offset:35840
v_mfma_f32_16x16x32_bf16 v[96:99], a[20:23], a[240:243], v[96:99]
ds_read_b64_tr_b16 a[72:73], v10 offset:8192
v_mfma_f32_16x16x32_bf16 v[136:139], a[24:27], a[240:243], v[136:139]
ds_read_b64_tr_b16 a[74:75], v10 offset:10240
v_mfma_f32_16x16x32_bf16 v[176:179], a[28:31], a[240:243], v[176:179]
s_waitcnt lgkmcnt(9)
v_mfma_f32_16x16x32_bf16 v[60:63], a[16:19], a[244:247], v[60:63]
ds_read_b128 a[240:243], v1 offset:36864
v_mfma_f32_16x16x32_bf16 v[100:103], a[20:23], a[244:247], v[100:103]
ds_read_b64_tr_b16 a[76:77], v11 offset:8192
v_mfma_f32_16x16x32_bf16 v[140:143], a[24:27], a[244:247], v[140:143]
ds_read_b64_tr_b16 a[78:79], v11 offset:10240
v_mfma_f32_16x16x32_bf16 v[180:183], a[28:31], a[244:247], v[180:183]
s_waitcnt lgkmcnt(8)
v_mfma_f32_16x16x32_bf16 v[64:67], a[16:19], a[248:251], v[64:67]
ds_read_b128 a[244:247], v1 offset:37888
v_mfma_f32_16x16x32_bf16 v[104:107], a[20:23], a[248:251], v[104:107]
v_mfma_f32_16x16x32_bf16 v[144:147], a[24:27], a[248:251], v[144:147]
v_mfma_f32_16x16x32_bf16 v[184:187], a[28:31], a[248:251], v[184:187]
s_waitcnt lgkmcnt(6)
v_mfma_f32_16x16x32_bf16 v[68:71], a[16:19], a[252:255], v[68:71]
ds_read_b128 a[248:251], v1 offset:38912
v_mfma_f32_16x16x32_bf16 v[108:111], a[20:23], a[252:255], v[108:111]
s_add_u32 m0, s33, 0x2000
s_mov_b32 s35, 0x1c000
v_mfma_f32_16x16x32_bf16 v[148:151], a[24:27], a[252:255], v[148:151]
s_waitcnt lgkmcnt(2)
buffer_load_dwordx4 v12, s[8:11], s35 offen nt lds
v_mfma_f32_16x16x32_bf16 v[188:191], a[28:31], a[252:255], v[188:191]
v_mfma_f32_16x16x32_bf16 v[72:75], a[16:19], a[240:243], v[72:75]
ds_read_b128 a[252:255], v1 offset:39936
v_mfma_f32_16x16x32_bf16 v[112:115], a[20:23], a[240:243], v[112:115]
buffer_load_dwordx4 v13, s[8:11], s35 offen offset:1024 nt lds
v_mfma_f32_16x16x32_bf16 v[152:155], a[24:27], a[240:243], v[152:155]
v_mfma_f32_16x16x32_bf16 v[192:195], a[28:31], a[240:243], v[192:195]
s_waitcnt lgkmcnt(2)
v_mfma_f32_16x16x32_bf16 v[76:79], a[16:19], a[244:247], v[76:79]
s_waitcnt lgkmcnt(0)
s_barrier
ds_read_b128 a[240:243], v2
v_mfma_f32_16x16x32_bf16 v[116:119], a[20:23], a[244:247], v[116:119]
buffer_load_dwordx4 v14, s[8:11], s35 offen offset:2048 nt lds
v_mfma_f32_16x16x32_bf16 v[156:159], a[24:27], a[244:247], v[156:159]
v_mfma_f32_16x16x32_bf16 v[196:199], a[28:31], a[244:247], v[196:199]
v_mfma_f32_16x16x32_bf16 v[80:83], a[16:19], a[248:251], v[80:83]
ds_read_b128 a[244:247], v2 offset:1024
v_mfma_f32_16x16x32_bf16 v[120:123], a[20:23], a[248:251], v[120:123]
buffer_load_dwordx4 v15, s[8:11], s35 offen offset:3072 nt lds
v_mfma_f32_16x16x32_bf16 v[160:163], a[24:27], a[248:251], v[160:163]
ds_write_b128 v7, a[112:115]
v_mfma_f32_16x16x32_bf16 v[200:203], a[28:31], a[248:251], v[200:203]
v_mfma_f32_16x16x32_bf16 v[84:87], a[16:19], a[252:255], v[84:87]
ds_read_b128 a[248:251], v2 offset:2048
v_mfma_f32_16x16x32_bf16 v[124:127], a[20:23], a[252:255], v[124:127]
v_mfma_f32_16x16x32_bf16 v[164:167], a[24:27], a[252:255], v[164:167]
v_mfma_f32_16x16x32_bf16 v[204:207], a[28:31], a[252:255], v[204:207]
s_waitcnt lgkmcnt(3)
v_mfma_f32_16x16x32_bf16 v[48:51], a[32:35], a[240:243], v[48:51]
ds_read_b128 a[252:255], v2 offset:3072
v_mfma_f32_16x16x32_bf16 v[88:91], a[36:39], a[240:243], v[88:91]
s_waitcnt vmcnt(13)
ds_read_b64_tr_b16 a[80:81], v8 offset:12288
v_mfma_f32_16x16x32_bf16 v[128:131], a[40:43], a[240:243], v[128:131]
ds_read_b64_tr_b16 a[82:83], v8 offset:14336
v_mfma_f32_16x16x32_bf16 v[168:171], a[44:47], a[240:243], v[168:171]
s_waitcnt lgkmcnt(5)
ds_read_b64_tr_b16 a[84:85], v9 offset:12288
v_mfma_f32_16x16x32_bf16 v[52:55], a[32:35], a[244:247], v[52:55]
ds_read_b128 a[240:243], v2 offset:4096
v_mfma_f32_16x16x32_bf16 v[92:95], a[36:39], a[244:247], v[92:95]
ds_read_b64_tr_b16 a[86:87], v9 offset:14336
v_mfma_f32_16x16x32_bf16 v[132:135], a[40:43], a[244:247], v[132:135]
ds_read_b64_tr_b16 a[88:89], v10 offset:12288
v_mfma_f32_16x16x32_bf16 v[172:175], a[44:47], a[244:247], v[172:175]
s_waitcnt lgkmcnt(7)
ds_read_b64_tr_b16 a[90:91], v10 offset:14336
v_mfma_f32_16x16x32_bf16 v[56:59], a[32:35], a[248:251], v[56:59]
ds_read_b128 a[244:247], v2 offset:5120
v_mfma_f32_16x16x32_bf16 v[96:99], a[36:39], a[248:251], v[96:99]
ds_read_b64_tr_b16 a[92:93], v11 offset:12288
v_mfma_f32_16x16x32_bf16 v[136:139], a[40:43], a[248:251], v[136:139]
ds_read_b64_tr_b16 a[94:95], v11 offset:14336
v_mfma_f32_16x16x32_bf16 v[176:179], a[44:47], a[248:251], v[176:179]
s_waitcnt lgkmcnt(10)
ds_write_b128 v7, a[116:119] offset:1024
v_mfma_f32_16x16x32_bf16 v[60:63], a[32:35], a[252:255], v[60:63]
ds_read_b128 a[248:251], v2 offset:6144
v_mfma_f32_16x16x32_bf16 v[100:103], a[36:39], a[252:255], v[100:103]
v_mfma_f32_16x16x32_bf16 v[140:143], a[40:43], a[252:255], v[140:143]
s_add_u32 m0, s33, 0x3000
s_mov_b32 s35, 0x2a000
v_mfma_f32_16x16x32_bf16 v[180:183], a[44:47], a[252:255], v[180:183]
s_waitcnt lgkmcnt(8)
s_waitcnt lgkmcnt(2)
buffer_load_dwordx4 v12, s[8:11], s35 offen nt lds
v_mfma_f32_16x16x32_bf16 v[64:67], a[32:35], a[240:243], v[64:67]
ds_read_b128 a[252:255], v2 offset:7168
v_mfma_f32_16x16x32_bf16 v[104:107], a[36:39], a[240:243], v[104:107]
buffer_load_dwordx4 v13, s[8:11], s35 offen offset:1024 nt lds
v_mfma_f32_16x16x32_bf16 v[144:147], a[40:43], a[240:243], v[144:147]
buffer_load_dwordx4 v14, s[8:11], s35 offen offset:2048 nt lds
v_mfma_f32_16x16x32_bf16 v[184:187], a[44:47], a[240:243], v[184:187]
buffer_load_dwordx4 v15, s[8:11], s35 offen offset:3072 nt lds
v_mfma_f32_16x16x32_bf16 v[68:71], a[32:35], a[244:247], v[68:71]
ds_read_b128 a[240:243], v2 offset:8192
v_mfma_f32_16x16x32_bf16 v[108:111], a[36:39], a[244:247], v[108:111]
s_waitcnt vmcnt(12)
ds_read_b64_tr_b16 a[216:217], v8
v_mfma_f32_16x16x32_bf16 v[148:151], a[40:43], a[244:247], v[148:151]
ds_read_b64_tr_b16 a[218:219], v8 offset:2048
v_mfma_f32_16x16x32_bf16 v[188:191], a[44:47], a[244:247], v[188:191]
s_waitcnt lgkmcnt(4)
ds_read_b64_tr_b16 a[220:221], v9
buffer_load_dword v5, v3, s[24:27], s74 offen sc1
v_mfma_f32_16x16x32_bf16 v[72:75], a[32:35], a[248:251], v[72:75]
ds_read_b128 a[244:247], v2 offset:9216
v_mfma_f32_16x16x32_bf16 v[112:115], a[36:39], a[248:251], v[112:115]
ds_read_b64_tr_b16 a[222:223], v9 offset:2048
v_mfma_f32_16x16x32_bf16 v[152:155], a[40:43], a[248:251], v[152:155]
ds_read_b64_tr_b16 a[192:193], v10
v_mfma_f32_16x16x32_bf16 v[192:195], a[44:47], a[248:251], v[192:195]
s_waitcnt lgkmcnt(7)
ds_read_b64_tr_b16 a[194:195], v10 offset:2048
v_mfma_f32_16x16x32_bf16 v[76:79], a[32:35], a[252:255], v[76:79]
ds_read_b128 a[248:251], v2 offset:10240
v_mfma_f32_16x16x32_bf16 v[116:119], a[36:39], a[252:255], v[116:119]
ds_read_b64_tr_b16 a[196:197], v11
v_mfma_f32_16x16x32_bf16 v[156:159], a[40:43], a[252:255], v[156:159]
ds_read_b64_tr_b16 a[198:199], v11 offset:2048
v_mfma_f32_16x16x32_bf16 v[196:199], a[44:47], a[252:255], v[196:199]
s_waitcnt lgkmcnt(10)
ds_write_b128 v7, a[120:123] offset:2048
v_mfma_f32_16x16x32_bf16 v[80:83], a[32:35], a[240:243], v[80:83]
ds_read_b128 a[252:255], v2 offset:11264
v_mfma_f32_16x16x32_bf16 v[120:123], a[36:39], a[240:243], v[120:123]
v_mfma_f32_16x16x32_bf16 v[160:163], a[40:43], a[240:243], v[160:163]
v_mfma_f32_16x16x32_bf16 v[200:203], a[44:47], a[240:243], v[200:203]
s_waitcnt lgkmcnt(8)
v_mfma_f32_16x16x32_bf16 v[84:87], a[32:35], a[244:247], v[84:87]
ds_read_b128 a[240:243], v2 offset:12288
v_mfma_f32_16x16x32_bf16 v[124:127], a[36:39], a[244:247], v[124:127]
v_mfma_f32_16x16x32_bf16 v[164:167], a[40:43], a[244:247], v[164:167]
v_mfma_f32_16x16x32_bf16 v[204:207], a[44:47], a[244:247], v[204:207]
s_waitcnt lgkmcnt(5)
v_mfma_f32_16x16x32_bf16 v[48:51], a[48:51], a[248:251], v[48:51]
ds_read_b128 a[244:247], v2 offset:13312
v_mfma_f32_16x16x32_bf16 v[88:91], a[52:55], a[248:251], v[88:91]
s_waitcnt vmcnt(9)
ds_read_b64_tr_b16 a[208:209], v8 offset:4096
v_mfma_f32_16x16x32_bf16 v[128:131], a[56:59], a[248:251], v[128:131]
ds_read_b64_tr_b16 a[210:211], v8 offset:6144
v_mfma_f32_16x16x32_bf16 v[168:171], a[60:63], a[248:251], v[168:171]
s_waitcnt lgkmcnt(4)
ds_write_b128 v7, a[124:127] offset:3072
v_mfma_f32_16x16x32_bf16 v[52:55], a[48:51], a[252:255], v[52:55]
ds_read_b128 a[248:251], v2 offset:14336
v_mfma_f32_16x16x32_bf16 v[92:95], a[52:55], a[252:255], v[92:95]
ds_read_b64_tr_b16 a[212:213], v9 offset:4096
v_mfma_f32_16x16x32_bf16 v[132:135], a[56:59], a[252:255], v[132:135]
ds_read_b64_tr_b16 a[214:215], v9 offset:6144
v_mfma_f32_16x16x32_bf16 v[172:175], a[60:63], a[252:255], v[172:175]
s_waitcnt lgkmcnt(7)
v_mfma_f32_16x16x32_bf16 v[56:59], a[48:51], a[240:243], v[56:59]
ds_read_b128 a[252:255], v2 offset:15360
v_mfma_f32_16x16x32_bf16 v[96:99], a[52:55], a[240:243], v[96:99]
ds_read_b64_tr_b16 a[224:225], v10 offset:4096
v_mfma_f32_16x16x32_bf16 v[136:139], a[56:59], a[240:243], v[136:139]
ds_read_b64_tr_b16 a[226:227], v10 offset:6144
v_mfma_f32_16x16x32_bf16 v[176:179], a[60:63], a[240:243], v[176:179]
s_waitcnt lgkmcnt(9)
v_mfma_f32_16x16x32_bf16 v[60:63], a[48:51], a[244:247], v[60:63]
ds_read_b128 a[240:243], v2 offset:16384
v_mfma_f32_16x16x32_bf16 v[100:103], a[52:55], a[244:247], v[100:103]
ds_read_b64_tr_b16 a[228:229], v11 offset:4096
v_mfma_f32_16x16x32_bf16 v[140:143], a[56:59], a[244:247], v[140:143]
ds_read_b64_tr_b16 a[230:231], v11 offset:6144
v_mfma_f32_16x16x32_bf16 v[180:183], a[60:63], a[244:247], v[180:183]
s_waitcnt lgkmcnt(8)
v_mfma_f32_16x16x32_bf16 v[64:67], a[48:51], a[248:251], v[64:67]
ds_read_b128 a[244:247], v2 offset:17408
v_mfma_f32_16x16x32_bf16 v[104:107], a[52:55], a[248:251], v[104:107]
ds_write_b128 v7, a[128:131] offset:4096
v_mfma_f32_16x16x32_bf16 v[144:147], a[56:59], a[248:251], v[144:147]
v_mfma_f32_16x16x32_bf16 v[184:187], a[60:63], a[248:251], v[184:187]
s_waitcnt lgkmcnt(7)
v_mfma_f32_16x16x32_bf16 v[68:71], a[48:51], a[252:255], v[68:71]
ds_read_b128 a[248:251], v2 offset:18432
v_mfma_f32_16x16x32_bf16 v[108:111], a[52:55], a[252:255], v[108:111]
v_mfma_f32_16x16x32_bf16 v[148:151], a[56:59], a[252:255], v[148:151]
v_mfma_f32_16x16x32_bf16 v[188:191], a[60:63], a[252:255], v[188:191]
s_waitcnt lgkmcnt(5)
v_mfma_f32_16x16x32_bf16 v[72:75], a[48:51], a[240:243], v[72:75]
ds_read_b128 a[252:255], v2 offset:19456
v_mfma_f32_16x16x32_bf16 v[112:115], a[52:55], a[240:243], v[112:115]
v_mfma_f32_16x16x32_bf16 v[152:155], a[56:59], a[240:243], v[152:155]
v_mfma_f32_16x16x32_bf16 v[192:195], a[60:63], a[240:243], v[192:195]
s_waitcnt lgkmcnt(3)
v_mfma_f32_16x16x32_bf16 v[76:79], a[48:51], a[244:247], v[76:79]
ds_read_b128 a[240:243], v2 offset:20480
v_mfma_f32_16x16x32_bf16 v[116:119], a[52:55], a[244:247], v[116:119]
ds_write_b128 v7, a[132:135] offset:5120
v_mfma_f32_16x16x32_bf16 v[156:159], a[56:59], a[244:247], v[156:159]
v_mfma_f32_16x16x32_bf16 v[196:199], a[60:63], a[244:247], v[196:199]
s_waitcnt lgkmcnt(3)
v_mfma_f32_16x16x32_bf16 v[80:83], a[48:51], a[248:251], v[80:83]
ds_read_b128 a[244:247], v2 offset:21504
v_mfma_f32_16x16x32_bf16 v[120:123], a[52:55], a[248:251], v[120:123]
v_mfma_f32_16x16x32_bf16 v[160:163], a[56:59], a[248:251], v[160:163]
v_mfma_f32_16x16x32_bf16 v[200:203], a[60:63], a[248:251], v[200:203]
s_waitcnt lgkmcnt(3)
v_mfma_f32_16x16x32_bf16 v[84:87], a[48:51], a[252:255], v[84:87]
ds_read_b128 a[248:251], v2 offset:22528
v_mfma_f32_16x16x32_bf16 v[124:127], a[52:55], a[252:255], v[124:127]
v_mfma_f32_16x16x32_bf16 v[164:167], a[56:59], a[252:255], v[164:167]
v_mfma_f32_16x16x32_bf16 v[204:207], a[60:63], a[252:255], v[204:207]
s_waitcnt lgkmcnt(3)
v_mfma_f32_16x16x32_bf16 v[48:51], a[64:67], a[240:243], v[48:51]
ds_read_b128 a[252:255], v2 offset:23552
s_waitcnt vmcnt(0)
v_cmp_ne_u32 vcc, s30, v5
v_mfma_f32_16x16x32_bf16 v[88:91], a[68:71], a[240:243], v[88:91]
ds_read_b64_tr_b16 a[152:153], v8 offset:8192
v_mfma_f32_16x16x32_bf16 v[128:131], a[72:75], a[240:243], v[128:131]
s_cmp_eq_u64 vcc, 0
s_cselect_b32 s84, 1, 0
s_cselect_b32 s82, s76, 0x7f000000
s_cselect_b32 s83, s78, 0x7f000000
ds_read_b64_tr_b16 a[154:155], v8 offset:10240
v_mfma_f32_16x16x32_bf16 v[168:171], a[76:79], a[240:243], v[168:171]
s_waitcnt lgkmcnt(4)
ds_write_b128 v7, a[136:139] offset:6144
v_mfma_f32_16x16x32_bf16 v[52:55], a[64:67], a[244:247], v[52:55]
ds_read_b128 a[240:243], v2 offset:24576
v_mfma_f32_16x16x32_bf16 v[92:95], a[68:71], a[244:247], v[92:95]
ds_read_b64_tr_b16 a[156:157], v9 offset:8192
v_mfma_f32_16x16x32_bf16 v[132:135], a[72:75], a[244:247], v[132:135]
ds_read_b64_tr_b16 a[158:159], v9 offset:10240
v_mfma_f32_16x16x32_bf16 v[172:175], a[76:79], a[244:247], v[172:175]
s_waitcnt lgkmcnt(7)
buffer_load_dwordx4 v[208:211], v1, s[24:27], s82 offen sc1
v_mfma_f32_16x16x32_bf16 v[56:59], a[64:67], a[248:251], v[56:59]
ds_read_b128 a[244:247], v2 offset:25600
s_add_u32 s82, s82, 0x23000
v_mfma_f32_16x16x32_bf16 v[96:99], a[68:71], a[248:251], v[96:99]
ds_read_b64_tr_b16 a[160:161], v10 offset:8192
v_mfma_f32_16x16x32_bf16 v[136:139], a[72:75], a[248:251], v[136:139]
ds_read_b64_tr_b16 a[162:163], v10 offset:10240
v_mfma_f32_16x16x32_bf16 v[176:179], a[76:79], a[248:251], v[176:179]
s_waitcnt lgkmcnt(9)
buffer_load_dwordx4 v[212:215], v1, s[24:27], s82 offen sc1
v_mfma_f32_16x16x32_bf16 v[60:63], a[64:67], a[252:255], v[60:63]
ds_read_b128 a[248:251], v2 offset:26624
v_mfma_f32_16x16x32_bf16 v[100:103], a[68:71], a[252:255], v[100:103]
ds_read_b64_tr_b16 a[164:165], v11 offset:8192
v_mfma_f32_16x16x32_bf16 v[140:143], a[72:75], a[252:255], v[140:143]
ds_read_b64_tr_b16 a[166:167], v11 offset:10240
s_add_u32 s82, s82, 0x23000
v_mfma_f32_16x16x32_bf16 v[180:183], a[76:79], a[252:255], v[180:183]
s_waitcnt lgkmcnt(8)
v_mfma_f32_16x16x32_bf16 v[64:67], a[64:67], a[240:243], v[64:67]
ds_read_b128 a[252:255], v2 offset:27648
v_mfma_f32_16x16x32_bf16 v[104:107], a[68:71], a[240:243], v[104:107]
buffer_load_dwordx4 v[216:219], v1, s[24:27], s82 offen sc1
v_mfma_f32_16x16x32_bf16 v[144:147], a[72:75], a[240:243], v[144:147]
ds_write_b128 v7, a[140:143] offset:7168
v_mfma_f32_16x16x32_bf16 v[184:187], a[76:79], a[240:243], v[184:187]
s_waitcnt lgkmcnt(7)
s_add_u32 s82, s82, 0x23000
v_mfma_f32_16x16x32_bf16 v[68:71], a[64:67], a[244:247], v[68:71]
ds_read_b128 a[240:243], v2 offset:28672
v_mfma_f32_16x16x32_bf16 v[108:111], a[68:71], a[244:247], v[108:111]
buffer_load_dwordx4 v[220:223], v1, s[24:27], s82 offen sc1
v_mfma_f32_16x16x32_bf16 v[148:151], a[72:75], a[244:247], v[148:151]
v_mfma_f32_16x16x32_bf16 v[188:191], a[76:79], a[244:247], v[188:191]
s_waitcnt lgkmcnt(5)
s_add_u32 s82, s82, 0x23000
v_mfma_f32_16x16x32_bf16 v[72:75], a[64:67], a[248:251], v[72:75]
ds_read_b128 a[244:247], v2 offset:29696
v_mfma_f32_16x16x32_bf16 v[112:115], a[68:71], a[248:251], v[112:115]
v_mfma_f32_16x16x32_bf16 v[152:155], a[72:75], a[248:251], v[152:155]
buffer_load_dwordx4 v[224:227], v1, s[24:27], s82 offen sc1
v_mfma_f32_16x16x32_bf16 v[192:195], a[76:79], a[248:251], v[192:195]
s_waitcnt lgkmcnt(3)
s_add_u32 s82, s82, 0x23000
v_mfma_f32_16x16x32_bf16 v[76:79], a[64:67], a[252:255], v[76:79]
ds_read_b128 a[248:251], v2 offset:30720
v_mfma_f32_16x16x32_bf16 v[116:119], a[68:71], a[252:255], v[116:119]
ds_write_b128 v7, a[144:147] offset:8192
v_mfma_f32_16x16x32_bf16 v[156:159], a[72:75], a[252:255], v[156:159]
v_mfma_f32_16x16x32_bf16 v[196:199], a[76:79], a[252:255], v[196:199]
s_waitcnt lgkmcnt(3)
buffer_load_dwordx4 v[228:231], v1, s[24:27], s82 offen sc1
v_mfma_f32_16x16x32_bf16 v[80:83], a[64:67], a[240:243], v[80:83]
ds_read_b128 a[252:255], v2 offset:31744
v_mfma_f32_16x16x32_bf16 v[120:123], a[68:71], a[240:243], v[120:123]
s_add_u32 s82, s82, 0x23000
v_mfma_f32_16x16x32_bf16 v[160:163], a[72:75], a[240:243], v[160:163]
v_mfma_f32_16x16x32_bf16 v[200:203], a[76:79], a[240:243], v[200:203]
s_waitcnt lgkmcnt(3)
buffer_load_dwordx4 v[232:235], v1, s[24:27], s82 offen sc1
v_mfma_f32_16x16x32_bf16 v[84:87], a[64:67], a[244:247], v[84:87]
ds_read_b128 a[240:243], v2 offset:32768
v_mfma_f32_16x16x32_bf16 v[124:127], a[68:71], a[244:247], v[124:127]
s_add_u32 s82, s82, 0x23000
v_mfma_f32_16x16x32_bf16 v[164:167], a[72:75], a[244:247], v[164:167]
v_mfma_f32_16x16x32_bf16 v[204:207], a[76:79], a[244:247], v[204:207]
s_waitcnt lgkmcnt(3)
buffer_load_dwordx4 v[236:239], v1, s[24:27], s82 offen sc1
v_mfma_f32_16x16x32_bf16 v[48:51], a[80:83], a[248:251], v[48:51]
ds_read_b128 a[244:247], v2 offset:33792
v_mfma_f32_16x16x32_bf16 v[88:91], a[84:87], a[248:251], v[88:91]
ds_read_b64_tr_b16 a[168:169], v8 offset:12288
v_mfma_f32_16x16x32_bf16 v[128:131], a[88:91], a[248:251], v[128:131]
ds_read_b64_tr_b16 a[170:171], v8 offset:14336
v_mfma_f32_16x16x32_bf16 v[168:171], a[92:95], a[248:251], v[168:171]
s_waitcnt lgkmcnt(4)
ds_write_b128 v7, a[148:151] offset:9216
v_mfma_f32_16x16x32_bf16 v[52:55], a[80:83], a[252:255], v[52:55]
ds_read_b128 a[248:251], v2 offset:34816
v_mfma_f32_16x16x32_bf16 v[92:95], a[84:87], a[252:255], v[92:95]
ds_read_b64_tr_b16 a[172:173], v9 offset:12288
v_mfma_f32_16x16x32_bf16 v[132:135], a[88:91], a[252:255], v[132:135]
ds_read_b64_tr_b16 a[174:175], v9 offset:14336
v_mfma_f32_16x16x32_bf16 v[172:175], a[92:95], a[252:255], v[172:175]
s_waitcnt lgkmcnt(7)
buffer_load_dwordx4 v[240:243], v1, s[24:27], s83 offen sc1
s_add_u32 s83, s83, 0x23000
v_mfma_f32_16x16x32_bf16 v[56:59], a[80:83], a[240:243], v[56:59]
ds_read_b128 a[252:255], v2 offset:35840
v_mfma_f32_16x16x32_bf16 v[96:99], a[84:87], a[240:243], v[96:99]
ds_read_b64_tr_b16 a[176:177], v10 offset:12288
v_mfma_f32_16x16x32_bf16 v[136:139], a[88:91], a[240:243], v[136:139]
ds_read_b64_tr_b16 a[178:179], v10 offset:14336
v_mfma_f32_16x16x32_bf16 v[176:179], a[92:95], a[240:243], v[176:179]
s_waitcnt lgkmcnt(9)
buffer_load_dwordx4 v[244:247], v1, s[24:27], s83 offen sc1
s_add_u32 s83, s83, 0x23000
v_mfma_f32_16x16x32_bf16 v[60:63], a[80:83], a[244:247], v[60:63]
ds_read_b128 a[240:243], v2 offset:36864
v_mfma_f32_16x16x32_bf16 v[100:103], a[84:87], a[244:247], v[100:103]
ds_read_b64_tr_b16 a[180:181], v11 offset:12288
v_mfma_f32_16x16x32_bf16 v[140:143], a[88:91], a[244:247], v[140:143]
ds_read_b64_tr_b16 a[182:183], v11 offset:14336
v_mfma_f32_16x16x32_bf16 v[180:183], a[92:95], a[244:247], v[180:183]
s_waitcnt lgkmcnt(8)
buffer_load_dwordx4 v[248:251], v1, s[24:27], s83 offen sc1
v_mfma_f32_16x16x32_bf16 v[64:67], a[80:83], a[248:251], v[64:67]
ds_read_b128 a[244:247], v2 offset:37888
v_mfma_f32_16x16x32_bf16 v[104:107], a[84:87], a[248:251], v[104:107]
s_add_u32 s83, s83, 0x23000
v_mfma_f32_16x16x32_bf16 v[144:147], a[88:91], a[248:251], v[144:147]
buffer_load_dwordx4 v[252:255], v1, s[24:27], s83 offen sc1
v_mfma_f32_16x16x32_bf16 v[184:187], a[92:95], a[248:251], v[184:187]
s_waitcnt lgkmcnt(6)
v_mfma_f32_16x16x32_bf16 v[68:71], a[80:83], a[252:255], v[68:71]
ds_read_b128 a[248:251], v2 offset:38912
v_mfma_f32_16x16x32_bf16 v[108:111], a[84:87], a[252:255], v[108:111]
s_add_u32 s83, s83, 0x23000
v_mfma_f32_16x16x32_bf16 v[148:151], a[88:91], a[252:255], v[148:151]
v_mfma_f32_16x16x32_bf16 v[188:191], a[92:95], a[252:255], v[188:191]
s_waitcnt lgkmcnt(4)
buffer_load_dwordx4 v[24:27], v1, s[24:27], s83 offen sc1
v_mfma_f32_16x16x32_bf16 v[72:75], a[80:83], a[240:243], v[72:75]
ds_read_b128 a[252:255], v2 offset:39936
v_mfma_f32_16x16x32_bf16 v[112:115], a[84:87], a[240:243], v[112:115]
s_add_u32 s83, s83, 0x23000
v_mfma_f32_16x16x32_bf16 v[152:155], a[88:91], a[240:243], v[152:155]
v_mfma_f32_16x16x32_bf16 v[192:195], a[92:95], a[240:243], v[192:195]
s_waitcnt lgkmcnt(2)
buffer_load_dwordx4 v[28:31], v1, s[24:27], s83 offen sc1
v_mfma_f32_16x16x32_bf16 v[76:79], a[80:83], a[244:247], v[76:79]
s_waitcnt lgkmcnt(0)
s_barrier
ds_read_b128 a[240:243], v1
v_mfma_f32_16x16x32_bf16 v[116:119], a[84:87], a[244:247], v[116:119]
s_add_u32 s83, s83, 0x23000
v_mfma_f32_16x16x32_bf16 v[156:159], a[88:91], a[244:247], v[156:159]
v_mfma_f32_16x16x32_bf16 v[196:199], a[92:95], a[244:247], v[196:199]
buffer_load_dwordx4 v[36:39], v1, s[24:27], s83 offen sc1
v_mfma_f32_16x16x32_bf16 v[80:83], a[80:83], a[248:251], v[80:83]
ds_read_b128 a[244:247], v1 offset:10240
v_mfma_f32_16x16x32_bf16 v[120:123], a[84:87], a[248:251], v[120:123]
s_add_u32 s83, s83, 0x23000
v_mfma_f32_16x16x32_bf16 v[160:163], a[88:91], a[248:251], v[160:163]
v_mfma_f32_16x16x32_bf16 v[200:203], a[92:95], a[248:251], v[200:203]
buffer_load_dwordx4 v[40:43], v1, s[24:27], s83 offen sc1
v_mfma_f32_16x16x32_bf16 v[84:87], a[80:83], a[252:255], v[84:87]
ds_read_b128 a[248:251], v1 offset:20480
v_mfma_f32_16x16x32_bf16 v[124:127], a[84:87], a[252:255], v[124:127]
v_mfma_f32_16x16x32_bf16 v[164:167], a[88:91], a[252:255], v[164:167]
v_mfma_f32_16x16x32_bf16 v[204:207], a[92:95], a[252:255], v[204:207]
s_waitcnt lgkmcnt(2)
v_mfma_f32_16x16x32_bf16 v[48:51], a[216:219], a[240:243], v[48:51]
ds_read_b128 a[252:255], v1 offset:30720
v_mfma_f32_16x16x32_bf16 v[88:91], a[220:223], a[240:243], v[88:91]
v_mfma_f32_16x16x32_bf16 v[128:131], a[192:195], a[240:243], v[128:131]
v_mfma_f32_16x16x32_bf16 v[168:171], a[196:199], a[240:243], v[168:171]
s_waitcnt lgkmcnt(2)
v_mfma_f32_16x16x32_bf16 v[48:51], a[208:211], a[244:247], v[48:51]
ds_read_b128 a[240:243], v1 offset:1024
v_mfma_f32_16x16x32_bf16 v[88:91], a[212:215], a[244:247], v[88:91]
v_mfma_f32_16x16x32_bf16 v[128:131], a[224:227], a[244:247], v[128:131]
v_mfma_f32_16x16x32_bf16 v[168:171], a[228:231], a[244:247], v[168:171]
s_waitcnt lgkmcnt(2)
v_mfma_f32_16x16x32_bf16 v[48:51], a[152:155], a[248:251], v[48:51]
ds_read_b128 a[244:247], v1 offset:11264
v_mfma_f32_16x16x32_bf16 v[88:91], a[156:159], a[248:251], v[88:91]
v_mfma_f32_16x16x32_bf16 v[128:131], a[160:163], a[248:251], v[128:131]
v_mfma_f32_16x16x32_bf16 v[168:171], a[164:167], a[248:251], v[168:171]
s_waitcnt lgkmcnt(2)
v_mfma_f32_16x16x32_bf16 v[48:51], a[168:171], a[252:255], v[48:51]
ds_read_b128 a[248:251], v1 offset:21504
v_mfma_f32_16x16x32_bf16 v[88:91], a[172:175], a[252:255], v[88:91]
v_mfma_f32_16x16x32_bf16 v[128:131], a[176:179], a[252:255], v[128:131]
v_mfma_f32_16x16x32_bf16 v[168:171], a[180:183], a[252:255], v[168:171]
s_waitcnt lgkmcnt(2)
v_mfma_f32_16x16x32_bf16 v[52:55], a[216:219], a[240:243], v[52:55]
ds_read_b128 a[252:255], v1 offset:31744
v_mfma_f32_16x16x32_bf16 v[92:95], a[220:223], a[240:243], v[92:95]
v_mfma_f32_16x16x32_bf16 v[132:135], a[192:195], a[240:243], v[132:135]
v_mfma_f32_16x16x32_bf16 v[172:175], a[196:199], a[240:243], v[172:175]
s_waitcnt lgkmcnt(2)
v_mfma_f32_16x16x32_bf16 v[52:55], a[208:211], a[244:247], v[52:55]
ds_read_b128 a[240:243], v1 offset:2048
v_mfma_f32_16x16x32_bf16 v[92:95], a[212:215], a[244:247], v[92:95]
v_mfma_f32_16x16x32_bf16 v[132:135], a[224:227], a[244:247], v[132:135]
v_mfma_f32_16x16x32_bf16 v[172:175], a[228:231], a[244:247], v[172:175]
s_waitcnt lgkmcnt(2)
v_mfma_f32_16x16x32_bf16 v[52:55], a[152:155], a[248:251], v[52:55]
ds_read_b128 a[244:247], v1 offset:12288
v_mfma_f32_16x16x32_bf16 v[92:95], a[156:159], a[248:251], v[92:95]
v_mfma_f32_16x16x32_bf16 v[132:135], a[160:163], a[248:251], v[132:135]
v_mfma_f32_16x16x32_bf16 v[172:175], a[164:167], a[248:251], v[172:175]
s_waitcnt lgkmcnt(2)
v_mfma_f32_16x16x32_bf16 v[52:55], a[168:171], a[252:255], v[52:55]
ds_read_b128 a[248:251], v1 offset:22528
v_mfma_f32_16x16x32_bf16 v[92:95], a[172:175], a[252:255], v[92:95]
v_mfma_f32_16x16x32_bf16 v[132:135], a[176:179], a[252:255], v[132:135]
v_mfma_f32_16x16x32_bf16 v[172:175], a[180:183], a[252:255], v[172:175]
s_waitcnt lgkmcnt(2)
v_mfma_f32_16x16x32_bf16 v[56:59], a[216:219], a[240:243], v[56:59]
ds_read_b128 a[252:255], v1 offset:32768
v_mfma_f32_16x16x32_bf16 v[96:99], a[220:223], a[240:243], v[96:99]
v_cvt_pk_bf16_f32 v48, v48, v49
v_mfma_f32_16x16x32_bf16 v[136:139], a[192:195], a[240:243], v[136:139]
v_cvt_pk_bf16_f32 v49, v50, v51
v_cvt_pk_bf16_f32 v50, v52, v53
v_mfma_f32_16x16x32_bf16 v[176:179], a[196:199], a[240:243], v[176:179]
s_waitcnt lgkmcnt(2)
v_cvt_pk_bf16_f32 v51, v54, v55
v_mfma_f32_16x16x32_bf16 v[56:59], a[208:211], a[244:247], v[56:59]
ds_read_b128 a[240:243], v1 offset:3072
s_add_u32 s94, s93, 0
v_mfma_f32_16x16x32_bf16 v[96:99], a[212:215], a[244:247], v[96:99]
v_mfma_f32_16x16x32_bf16 v[136:139], a[224:227], a[244:247], v[136:139]
buffer_store_dwordx4 v[48:51], v1, s[24:27], s94 offen sc1
v_mfma_f32_16x16x32_bf16 v[176:179], a[228:231], a[244:247], v[176:179]
s_waitcnt lgkmcnt(2)
v_mfma_f32_16x16x32_bf16 v[56:59], a[152:155], a[248:251], v[56:59]
ds_read_b128 a[244:247], v1 offset:13312
v_mfma_f32_16x16x32_bf16 v[96:99], a[156:159], a[248:251], v[96:99]
v_cvt_pk_bf16_f32 v88, v88, v89
v_mfma_f32_16x16x32_bf16 v[136:139], a[160:163], a[248:251], v[136:139]
v_cvt_pk_bf16_f32 v89, v90, v91
v_cvt_pk_bf16_f32 v90, v92, v93
v_mfma_f32_16x16x32_bf16 v[176:179], a[164:167], a[248:251], v[176:179]
s_waitcnt lgkmcnt(2)
v_cvt_pk_bf16_f32 v91, v94, v95
v_mfma_f32_16x16x32_bf16 v[56:59], a[168:171], a[252:255], v[56:59]
ds_read_b128 a[248:251], v1 offset:23552
s_add_u32 s94, s93, 0x1400
v_mfma_f32_16x16x32_bf16 v[96:99], a[172:175], a[252:255], v[96:99]
v_mfma_f32_16x16x32_bf16 v[136:139], a[176:179], a[252:255], v[136:139]
buffer_store_dwordx4 v[88:91], v1, s[24:27], s94 offen sc1
v_mfma_f32_16x16x32_bf16 v[176:179], a[180:183], a[252:255], v[176:179]
s_waitcnt lgkmcnt(2)
v_mfma_f32_16x16x32_bf16 v[60:63], a[216:219], a[240:243], v[60:63]
ds_read_b128 a[252:255], v1 offset:33792
v_mfma_f32_16x16x32_bf16 v[100:103], a[220:223], a[240:243], v[100:103]
v_cvt_pk_bf16_f32 v128, v128, v129
v_cvt_pk_bf16_f32 v129, v130, v131
v_mfma_f32_16x16x32_bf16 v[140:143], a[192:195], a[240:243], v[140:143]
v_cvt_pk_bf16_f32 v130, v132, v133
v_mfma_f32_16x16x32_bf16 v[180:183], a[196:199], a[240:243], v[180:183]
s_waitcnt lgkmcnt(2)
v_cvt_pk_bf16_f32 v131, v134, v135
v_mfma_f32_16x16x32_bf16 v[60:63], a[208:211], a[244:247], v[60:63]
ds_read_b128 a[240:243], v1 offset:4096
s_add_u32 s94, s93, 0x2800
v_mfma_f32_16x16x32_bf16 v[100:103], a[212:215], a[244:247], v[100:103]
v_mfma_f32_16x16x32_bf16 v[140:143], a[224:227], a[244:247], v[140:143]
buffer_store_dwordx4 v[128:131], v1, s[24:27], s94 offen sc1
v_mfma_f32_16x16x32_bf16 v[180:183], a[228:231], a[244:247], v[180:183]
s_waitcnt lgkmcnt(2)
v_mfma_f32_16x16x32_bf16 v[60:63], a[152:155], a[248:251], v[60:63]
ds_read_b128 a[244:247], v1 offset:14336
v_mfma_f32_16x16x32_bf16 v[100:103], a[156:159], a[248:251], v[100:103]
v_cvt_pk_bf16_f32 v168, v168, v169
v_cvt_pk_bf16_f32 v169, v170, v171
v_mfma_f32_16x16x32_bf16 v[140:143], a[160:163], a[248:251], v[140:143]
v_cvt_pk_bf16_f32 v170, v172, v173
v_mfma_f32_16x16x32_bf16 v[180:183], a[164:167], a[248:251], v[180:183]
s_waitcnt lgkmcnt(2)
v_cvt_pk_bf16_f32 v171, v174, v175
v_mfma_f32_16x16x32_bf16 v[60:63], a[168:171], a[252:255], v[60:63]
ds_read_b128 a[248:251], v1 offset:24576
s_add_u32 s94, s93, 0x3c00
v_mfma_f32_16x16x32_bf16 v[100:103], a[172:175], a[252:255], v[100:103]
v_mfma_f32_16x16x32_bf16 v[140:143], a[176:179], a[252:255], v[140:143]
buffer_store_dwordx4 v[168:171], v1, s[24:27], s94 offen sc1
v_mfma_f32_16x16x32_bf16 v[180:183], a[180:183], a[252:255], v[180:183]
s_waitcnt lgkmcnt(2)
v_mfma_f32_16x16x32_bf16 v[64:67], a[216:219], a[240:243], v[64:67]
ds_read_b128 a[252:255], v1 offset:34816
v_mfma_f32_16x16x32_bf16 v[104:107], a[220:223], a[240:243], v[104:107]
v_cvt_pk_bf16_f32 v56, v56, v57
v_mfma_f32_16x16x32_bf16 v[144:147], a[192:195], a[240:243], v[144:147]
v_cvt_pk_bf16_f32 v57, v58, v59
v_cvt_pk_bf16_f32 v58, v60, v61
v_mfma_f32_16x16x32_bf16 v[184:187], a[196:199], a[240:243], v[184:187]
s_waitcnt lgkmcnt(2)
v_cvt_pk_bf16_f32 v59, v62, v63
v_mfma_f32_16x16x32_bf16 v[64:67], a[208:211], a[244:247], v[64:67]
ds_read_b128 a[240:243], v1 offset:5120
s_add_u32 s94, s93, 0x400
v_mfma_f32_16x16x32_bf16 v[104:107], a[212:215], a[244:247], v[104:107]
v_mfma_f32_16x16x32_bf16 v[144:147], a[224:227], a[244:247], v[144:147]
buffer_store_dwordx4 v[56:59], v1, s[24:27], s94 offen sc1
v_mfma_f32_16x16x32_bf16 v[184:187], a[228:231], a[244:247], v[184:187]
s_waitcnt lgkmcnt(2)
v_mfma_f32_16x16x32_bf16 v[64:67], a[152:155], a[248:251], v[64:67]
ds_read_b128 a[244:247], v1 offset:15360
v_mfma_f32_16x16x32_bf16 v[104:107], a[156:159], a[248:251], v[104:107]
v_cvt_pk_bf16_f32 v96, v96, v97
v_mfma_f32_16x16x32_bf16 v[144:147], a[160:163], a[248:251], v[144:147]
v_cvt_pk_bf16_f32 v97, v98, v99
v_cvt_pk_bf16_f32 v98, v100, v101
v_mfma_f32_16x16x32_bf16 v[184:187], a[164:167], a[248:251], v[184:187]
s_waitcnt lgkmcnt(2)
v_cvt_pk_bf16_f32 v99, v102, v103
v_mfma_f32_16x16x32_bf16 v[64:67], a[168:171], a[252:255], v[64:67]
ds_read_b128 a[248:251], v1 offset:25600
s_add_u32 s94, s93, 0x1800
v_mfma_f32_16x16x32_bf16 v[104:107], a[172:175], a[252:255], v[104:107]
v_mfma_f32_16x16x32_bf16 v[144:147], a[176:179], a[252:255], v[144:147]
buffer_store_dwordx4 v[96:99], v1, s[24:27], s94 offen sc1
v_mfma_f32_16x16x32_bf16 v[184:187], a[180:183], a[252:255], v[184:187]
s_waitcnt lgkmcnt(2)
v_mfma_f32_16x16x32_bf16 v[68:71], a[216:219], a[240:243], v[68:71]
ds_read_b128 a[252:255], v1 offset:35840
v_mfma_f32_16x16x32_bf16 v[108:111], a[220:223], a[240:243], v[108:111]
v_cvt_pk_bf16_f32 v136, v136, v137
v_cvt_pk_bf16_f32 v137, v138, v139
v_mfma_f32_16x16x32_bf16 v[148:151], a[192:195], a[240:243], v[148:151]
v_cvt_pk_bf16_f32 v138, v140, v141
v_mfma_f32_16x16x32_bf16 v[188:191], a[196:199], a[240:243], v[188:191]
s_waitcnt lgkmcnt(2)
v_cvt_pk_bf16_f32 v139, v142, v143
v_mfma_f32_16x16x32_bf16 v[68:71], a[208:211], a[244:247], v[68:71]
ds_read_b128 a[240:243], v1 offset:6144
s_add_u32 s94, s93, 0x2c00
v_mfma_f32_16x16x32_bf16 v[108:111], a[212:215], a[244:247], v[108:111]
v_mfma_f32_16x16x32_bf16 v[148:151], a[224:227], a[244:247], v[148:151]
buffer_store_dwordx4 v[136:139], v1, s[24:27], s94 offen sc1
v_mfma_f32_16x16x32_bf16 v[188:191], a[228:231], a[244:247], v[188:191]
s_waitcnt lgkmcnt(2)
v_mfma_f32_16x16x32_bf16 v[68:71], a[152:155], a[248:251], v[68:71]
ds_read_b128 a[244:247], v1 offset:16384
v_mfma_f32_16x16x32_bf16 v[108:111], a[156:159], a[248:251], v[108:111]
v_cvt_pk_bf16_f32 v176, v176, v177
v_cvt_pk_bf16_f32 v177, v178, v179
v_mfma_f32_16x16x32_bf16 v[148:151], a[160:163], a[248:251], v[148:151]
v_cvt_pk_bf16_f32 v178, v180, v181
v_mfma_f32_16x16x32_bf16 v[188:191], a[164:167], a[248:251], v[188:191]
s_waitcnt lgkmcnt(2)
v_cvt_pk_bf16_f32 v179, v182, v183
v_mfma_f32_16x16x32_bf16 v[68:71], a[168:171], a[252:255], v[68:71]
ds_read_b128 a[248:251], v1 offset:26624
s_add_u32 s94, s93, 0x4000
v_mfma_f32_16x16x32_bf16 v[108:111], a[172:175], a[252:255], v[108:111]
v_mfma_f32_16x16x32_bf16 v[148:151], a[176:179], a[252:255], v[148:151]
buffer_store_dwordx4 v[176:179], v1, s[24:27], s94 offen sc1
v_mfma_f32_16x16x32_bf16 v[188:191], a[180:183], a[252:255], v[188:191]
s_waitcnt lgkmcnt(2)
v_mfma_f32_16x16x32_bf16 v[72:75], a[216:219], a[240:243], v[72:75]
ds_read_b128 a[252:255], v1 offset:36864
v_mfma_f32_16x16x32_bf16 v[112:115], a[220:223], a[240:243], v[112:115]
v_cvt_pk_bf16_f32 v64, v64, v65
v_mfma_f32_16x16x32_bf16 v[152:155], a[192:195], a[240:243], v[152:155]
v_cvt_pk_bf16_f32 v65, v66, v67
v_cvt_pk_bf16_f32 v66, v68, v69
v_mfma_f32_16x16x32_bf16 v[192:195], a[196:199], a[240:243], v[192:195]
s_waitcnt lgkmcnt(2)
v_cvt_pk_bf16_f32 v67, v70, v71
v_mfma_f32_16x16x32_bf16 v[72:75], a[208:211], a[244:247], v[72:75]
ds_read_b128 a[240:243], v1 offset:7168
s_add_u32 s94, s93, 0x800
v_mfma_f32_16x16x32_bf16 v[112:115], a[212:215], a[244:247], v[112:115]
v_mfma_f32_16x16x32_bf16 v[152:155], a[224:227], a[244:247], v[152:155]
buffer_store_dwordx4 v[64:67], v1, s[24:27], s94 offen sc1
v_mfma_f32_16x16x32_bf16 v[192:195], a[228:231], a[244:247], v[192:195]
s_waitcnt lgkmcnt(2)
v_mfma_f32_16x16x32_bf16 v[72:75], a[152:155], a[248:251], v[72:75]
ds_read_b128 a[244:247], v1 offset:17408
v_mfma_f32_16x16x32_bf16 v[112:115], a[156:159], a[248:251], v[112:115]
v_cvt_pk_bf16_f32 v104, v104, v105
v_mfma_f32_16x16x32_bf16 v[152:155], a[160:163], a[248:251], v[152:155]
v_cvt_pk_bf16_f32 v105, v106, v107
v_cvt_pk_bf16_f32 v106, v108, v109
v_mfma_f32_16x16x32_bf16 v[192:195], a[164:167], a[248:251], v[192:195]
s_waitcnt lgkmcnt(2)
v_cvt_pk_bf16_f32 v107, v110, v111
v_mfma_f32_16x16x32_bf16 v[72:75], a[168:171], a[252:255], v[72:75]
ds_read_b128 a[248:251], v1 offset:27648
s_add_u32 s94, s93, 0x1c00
v_mfma_f32_16x16x32_bf16 v[112:115], a[172:175], a[252:255], v[112:115]
v_mfma_f32_16x16x32_bf16 v[152:155], a[176:179], a[252:255], v[152:155]
buffer_store_dwordx4 v[104:107], v1, s[24:27], s94 offen sc1
v_mfma_f32_16x16x32_bf16 v[192:195], a[180:183], a[252:255], v[192:195]
s_waitcnt lgkmcnt(2)
v_mfma_f32_16x16x32_bf16 v[76:79], a[216:219], a[240:243], v[76:79]
ds_read_b128 a[252:255], v1 offset:37888
v_mfma_f32_16x16x32_bf16 v[116:119], a[220:223], a[240:243], v[116:119]
v_cvt_pk_bf16_f32 v144, v144, v145
v_cvt_pk_bf16_f32 v145, v146, v147
v_mfma_f32_16x16x32_bf16 v[156:159], a[192:195], a[240:243], v[156:159]
v_cvt_pk_bf16_f32 v146, v148, v149
v_mfma_f32_16x16x32_bf16 v[196:199], a[196:199], a[240:243], v[196:199]
s_waitcnt lgkmcnt(2)
v_cvt_pk_bf16_f32 v147, v150, v151
v_mfma_f32_16x16x32_bf16 v[76:79], a[208:211], a[244:247], v[76:79]
ds_read_b128 a[240:243], v1 offset:8192
s_add_u32 s94, s93, 0x3000
v_mfma_f32_16x16x32_bf16 v[116:119], a[212:215], a[244:247], v[116:119]
v_mfma_f32_16x16x32_bf16 v[156:159], a[224:227], a[244:247], v[156:159]
buffer_store_dwordx4 v[144:147], v1, s[24:27], s94 offen sc1
v_mfma_f32_16x16x32_bf16 v[196:199], a[228:231], a[244:247], v[196:199]
s_waitcnt lgkmcnt(2)
v_mfma_f32_16x16x32_bf16 v[76:79], a[152:155], a[248:251], v[76:79]
ds_read_b128 a[244:247], v1 offset:18432
v_mfma_f32_16x16x32_bf16 v[116:119], a[156:159], a[248:251], v[116:119]
v_cvt_pk_bf16_f32 v184, v184, v185
v_cvt_pk_bf16_f32 v185, v186, v187
v_mfma_f32_16x16x32_bf16 v[156:159], a[160:163], a[248:251], v[156:159]
v_cvt_pk_bf16_f32 v186, v188, v189
v_mfma_f32_16x16x32_bf16 v[196:199], a[164:167], a[248:251], v[196:199]
s_waitcnt lgkmcnt(2)
v_cvt_pk_bf16_f32 v187, v190, v191
v_mfma_f32_16x16x32_bf16 v[76:79], a[168:171], a[252:255], v[76:79]
ds_read_b128 a[248:251], v1 offset:28672
s_add_u32 s94, s93, 0x4400
v_mfma_f32_16x16x32_bf16 v[116:119], a[172:175], a[252:255], v[116:119]
v_mfma_f32_16x16x32_bf16 v[156:159], a[176:179], a[252:255], v[156:159]
buffer_store_dwordx4 v[184:187], v1, s[24:27], s94 offen sc1
v_mfma_f32_16x16x32_bf16 v[196:199], a[180:183], a[252:255], v[196:199]
s_waitcnt lgkmcnt(2)
v_mfma_f32_16x16x32_bf16 v[80:83], a[216:219], a[240:243], v[80:83]
ds_read_b128 a[252:255], v1 offset:38912
v_mfma_f32_16x16x32_bf16 v[120:123], a[220:223], a[240:243], v[120:123]
v_cvt_pk_bf16_f32 v72, v72, v73
v_mfma_f32_16x16x32_bf16 v[160:163], a[192:195], a[240:243], v[160:163]
v_cvt_pk_bf16_f32 v73, v74, v75
v_mfma_f32_16x16x32_bf16 v[200:203], a[196:199], a[240:243], v[200:203]
s_waitcnt lgkmcnt(2)
v_cvt_pk_bf16_f32 v74, v76, v77
v_cvt_pk_bf16_f32 v75, v78, v79
v_mfma_f32_16x16x32_bf16 v[80:83], a[208:211], a[244:247], v[80:83]
ds_read_b128 a[240:243], v1 offset:9216
v_mfma_f32_16x16x32_bf16 v[120:123], a[212:215], a[244:247], v[120:123]
s_add_u32 s94, s93, 0xc00
v_mfma_f32_16x16x32_bf16 v[160:163], a[224:227], a[244:247], v[160:163]
buffer_store_dwordx4 v[72:75], v1, s[24:27], s94 offen sc1
v_mfma_f32_16x16x32_bf16 v[200:203], a[228:231], a[244:247], v[200:203]
s_waitcnt lgkmcnt(2)
v_mfma_f32_16x16x32_bf16 v[80:83], a[152:155], a[248:251], v[80:83]
ds_read_b128 a[244:247], v1 offset:19456
v_mfma_f32_16x16x32_bf16 v[120:123], a[156:159], a[248:251], v[120:123]
v_cvt_pk_bf16_f32 v112, v112, v113
v_mfma_f32_16x16x32_bf16 v[160:163], a[160:163], a[248:251], v[160:163]
v_cvt_pk_bf16_f32 v113, v114, v115
v_mfma_f32_16x16x32_bf16 v[200:203], a[164:167], a[248:251], v[200:203]
s_waitcnt lgkmcnt(2)
v_cvt_pk_bf16_f32 v114, v116, v117
v_mfma_f32_16x16x32_bf16 v[80:83], a[168:171], a[252:255], v[80:83]
ds_read_b128 a[248:251], v1 offset:29696
v_cvt_pk_bf16_f32 v115, v118, v119
v_mfma_f32_16x16x32_bf16 v[120:123], a[172:175], a[252:255], v[120:123]
s_add_u32 s94, s93, 0x2000
v_mfma_f32_16x16x32_bf16 v[160:163], a[176:179], a[252:255], v[160:163]
buffer_store_dwordx4 v[112:115], v1, s[24:27], s94 offen sc1
v_mfma_f32_16x16x32_bf16 v[200:203], a[180:183], a[252:255], v[200:203]
s_waitcnt lgkmcnt(2)
v_mfma_f32_16x16x32_bf16 v[84:87], a[216:219], a[240:243], v[84:87]
ds_read_b128 a[252:255], v1 offset:39936
v_mfma_f32_16x16x32_bf16 v[124:127], a[220:223], a[240:243], v[124:127]
v_cvt_pk_bf16_f32 v152, v152, v153
v_mfma_f32_16x16x32_bf16 v[164:167], a[192:195], a[240:243], v[164:167]
v_cvt_pk_bf16_f32 v153, v154, v155
v_mfma_f32_16x16x32_bf16 v[204:207], a[196:199], a[240:243], v[204:207]
s_waitcnt lgkmcnt(2)
v_cvt_pk_bf16_f32 v154, v156, v157
v_mfma_f32_16x16x32_bf16 v[84:87], a[208:211], a[244:247], v[84:87]
v_cvt_pk_bf16_f32 v155, v158, v159
v_mfma_f32_16x16x32_bf16 v[124:127], a[212:215], a[244:247], v[124:127]
s_add_u32 s94, s93, 0x3400
v_mfma_f32_16x16x32_bf16 v[164:167], a[224:227], a[244:247], v[164:167]
buffer_store_dwordx4 v[152:155], v1, s[24:27], s94 offen sc1
v_mfma_f32_16x16x32_bf16 v[204:207], a[228:231], a[244:247], v[204:207]
s_waitcnt lgkmcnt(1)
v_mfma_f32_16x16x32_bf16 v[84:87], a[152:155], a[248:251], v[84:87]
v_mfma_f32_16x16x32_bf16 v[124:127], a[156:159], a[248:251], v[124:127]
v_cvt_pk_bf16_f32 v192, v192, v193
v_cvt_pk_bf16_f32 v193, v194, v195
v_mfma_f32_16x16x32_bf16 v[164:167], a[160:163], a[248:251], v[164:167]
v_cvt_pk_bf16_f32 v194, v196, v197
v_mfma_f32_16x16x32_bf16 v[204:207], a[164:167], a[248:251], v[204:207]
s_waitcnt lgkmcnt(0)
v_cvt_pk_bf16_f32 v195, v198, v199
v_mfma_f32_16x16x32_bf16 v[84:87], a[168:171], a[252:255], v[84:87]
s_add_u32 s94, s93, 0x4800
v_mfma_f32_16x16x32_bf16 v[124:127], a[172:175], a[252:255], v[124:127]
buffer_store_dwordx4 v[192:195], v1, s[24:27], s94 offen sc1
v_mfma_f32_16x16x32_bf16 v[164:167], a[176:179], a[252:255], v[164:167]
v_mfma_f32_16x16x32_bf16 v[204:207], a[180:183], a[252:255], v[204:207]
v_cvt_pk_bf16_f32 v80, v80, v81
v_cvt_pk_bf16_f32 v81, v82, v83
s_nop 0
v_cvt_pk_bf16_f32 v82, v84, v85
v_cvt_pk_bf16_f32 v83, v86, v87
s_add_u32 s94, s93, 0x1000
buffer_store_dwordx4 v[80:83], v1, s[24:27], s94 offen sc1
v_cvt_pk_bf16_f32 v120, v120, v121
v_cvt_pk_bf16_f32 v121, v122, v123
v_cvt_pk_bf16_f32 v122, v124, v125
v_cvt_pk_bf16_f32 v123, v126, v127
s_add_u32 s94, s93, 0x2400
buffer_store_dwordx4 v[120:123], v1, s[24:27], s94 offen sc1
v_cvt_pk_bf16_f32 v160, v160, v161
v_cvt_pk_bf16_f32 v161, v162, v163
v_cvt_pk_bf16_f32 v162, v164, v165
v_cvt_pk_bf16_f32 v163, v166, v167
s_add_u32 s94, s93, 0x3800
buffer_store_dwordx4 v[160:163], v1, s[24:27], s94 offen sc1
v_cvt_pk_bf16_f32 v200, v200, v201
v_cvt_pk_bf16_f32 v201, v202, v203
v_cvt_pk_bf16_f32 v202, v204, v205
v_cvt_pk_bf16_f32 v203, v206, v207
s_add_u32 s94, s93, 0x4c00
buffer_store_dwordx4 v[200:203], v1, s[24:27], s94 offen sc1
s_waitcnt vmcnt(0)
s_barrier
buffer_store_dword v22, v4, s[24:27], s74 offen offset:128 sc1
s_cmp_eq_u32 s84, 1
s_cbranch_scc1 L_r1_done
s_mov_b32 s92, 0x10000
L_p1:
buffer_load_dword v5, v3, s[24:27], s74 offen offset:0 sc1
L_p1_chk:
s_waitcnt vmcnt(0)
v_cmp_ne_u32 vcc, s30, v5
s_sub_u32 s92, s92, 1
s_nop 3
s_cbranch_vccz L_p1_ok
s_sleep 2
s_cmp_lg_u32 s92, 0
s_cbranch_scc1 L_p1
L_p1_ok:
buffer_load_dwordx4 v[208:211], v1, s[24:27], s76 offen sc1
s_add_u32 s76, s76, 0x23000
buffer_load_dwordx4 v[212:215], v1, s[24:27], s76 offen sc1
s_add_u32 s76, s76, 0x23000
buffer_load_dwordx4 v[216:219], v1, s[24:27], s76 offen sc1
s_add_u32 s76, s76, 0x23000
buffer_load_dwordx4 v[220:223], v1, s[24:27], s76 offen sc1
s_add_u32 s76, s76, 0x23000
buffer_load_dwordx4 v[224:227], v1, s[24:27], s76 offen sc1
s_add_u32 s76, s76, 0x23000
buffer_load_dwordx4 v[228:231], v1, s[24:27], s76 offen sc1
s_add_u32 s76, s76, 0x23000
buffer_load_dwordx4 v[232:235], v1, s[24:27], s76 offen sc1
s_add_u32 s76, s76, 0x23000
buffer_load_dwordx4 v[236:239], v1, s[24:27], s76 offen sc1
buffer_load_dwordx4 v[240:243], v1, s[24:27], s78 offen sc1
s_add_u32 s78, s78, 0x23000
buffer_load_dwordx4 v[244:247], v1, s[24:27], s78 offen sc1
s_add_u32 s78, s78, 0x23000
buffer_load_dwordx4 v[248:251], v1, s[24:27], s78 offen sc1
s_add_u32 s78, s78, 0x23000
buffer_load_dwordx4 v[252:255], v1, s[24:27], s78 offen sc1
s_add_u32 s78, s78, 0x23000
buffer_load_dwordx4 v[24:27], v1, s[24:27], s78 offen sc1
s_add_u32 s78, s78, 0x23000
buffer_load_dwordx4 v[28:31], v1, s[24:27], s78 offen sc1
s_add_u32 s78, s78, 0x23000
buffer_load_dwordx4 v[36:39], v1, s[24:27], s78 offen sc1
s_add_u32 s78, s78, 0x23000
buffer_load_dwordx4 v[40:43], v1, s[24:27], s78 offen sc1
s_waitcnt vmcnt(0)
L_r1_done:
v_lshlrev_b32 v160, 16, v208
v_and_b32 v161, 0xffff0000, v208
v_lshlrev_b32 v162, 16, v209
v_and_b32 v163, 0xffff0000, v209
v_lshlrev_b32 v164, 16, v210
v_and_b32 v165, 0xffff0000, v210
v_lshlrev_b32 v166, 16, v211
v_and_b32 v167, 0xffff0000, v211
v_lshlrev_b32 v8, 16, v212
v_and_b32 v9, 0xffff0000, v212
v_pk_add_f32 v[160:161], v[160:161], v[8:9]
v_lshlrev_b32 v10, 16, v213
v_and_b32 v11, 0xffff0000, v213
v_pk_add_f32 v[162:163], v[162:163], v[10:11]
v_lshlrev_b32 v8, 16, v214
v_and_b32 v9, 0xffff0000, v214
v_pk_add_f32 v[164:165], v[164:165], v[8:9]
v_lshlrev_b32 v10, 16, v215
v_and_b32 v11, 0xffff0000, v215
v_pk_add_f32 v[166:167], v[166:167], v[10:11]
v_lshlrev_b32 v8, 16, v216
v_and_b32 v9, 0xffff0000, v216
v_pk_add_f32 v[160:161], v[160:161], v[8:9]
v_lshlrev_b32 v10, 16, v217
v_and_b32 v11, 0xffff0000, v217
v_pk_add_f32 v[162:163], v[162:163], v[10:11]
v_lshlrev_b32 v8, 16, v218
v_and_b32 v9, 0xffff0000, v218
v_pk_add_f32 v[164:165], v[164:165], v[8:9]
v_lshlrev_b32 v10, 16, v219
v_and_b32 v11, 0xffff0000, v219
v_pk_add_f32 v[166:167], v[166:167], v[10:11]
v_lshlrev_b32 v8, 16, v220
v_and_b32 v9, 0xffff0000, v220
v_pk_add_f32 v[160:161], v[160:161], v[8:9]
v_lshlrev_b32 v10, 16, v221
v_and_b32 v11, 0xffff0000, v221
v_pk_add_f32 v[162:163], v[162:163], v[10:11]
v_lshlrev_b32 v8, 16, v222
v_and_b32 v9, 0xffff0000, v222
v_pk_add_f32 v[164:165], v[164:165], v[8:9]
v_lshlrev_b32 v10, 16, v223
v_and_b32 v11, 0xffff0000, v223
v_pk_add_f32 v[166:167], v[166:167], v[10:11]
v_lshlrev_b32 v8, 16, v224
v_and_b32 v9, 0xffff0000, v224
v_pk_add_f32 v[160:161], v[160:161], v[8:9]
v_lshlrev_b32 v10, 16, v225
v_and_b32 v11, 0xffff0000, v225
v_pk_add_f32 v[162:163], v[162:163], v[10:11]
v_lshlrev_b32 v8, 16, v226
v_and_b32 v9, 0xffff0000, v226
v_pk_add_f32 v[164:165], v[164:165], v[8:9]
v_lshlrev_b32 v10, 16, v227
v_and_b32 v11, 0xffff0000, v227
v_pk_add_f32 v[166:167], v[166:167], v[10:11]
v_lshlrev_b32 v8, 16, v228
v_and_b32 v9, 0xffff0000, v228
v_pk_add_f32 v[160:161], v[160:161], v[8:9]
v_lshlrev_b32 v10, 16, v229
v_and_b32 v11, 0xffff0000, v229
v_pk_add_f32 v[162:163], v[162:163], v[10:11]
v_lshlrev_b32 v8, 16, v230
v_and_b32 v9, 0xffff0000, v230
v_pk_add_f32 v[164:165], v[164:165], v[8:9]
v_lshlrev_b32 v10, 16, v231
v_and_b32 v11, 0xffff0000, v231
v_pk_add_f32 v[166:167], v[166:167], v[10:11]
v_lshlrev_b32 v8, 16, v232
v_and_b32 v9, 0xffff0000, v232
v_pk_add_f32 v[160:161], v[160:161], v[8:9]
v_lshlrev_b32 v10, 16, v233
v_and_b32 v11, 0xffff0000, v233
v_pk_add_f32 v[162:163], v[162:163], v[10:11]
v_lshlrev_b32 v8, 16, v234
v_and_b32 v9, 0xffff0000, v234
v_pk_add_f32 v[164:165], v[164:165], v[8:9]
v_lshlrev_b32 v10, 16, v235
v_and_b32 v11, 0xffff0000, v235
v_pk_add_f32 v[166:167], v[166:167], v[10:11]
v_lshlrev_b32 v8, 16, v236
v_and_b32 v9, 0xffff0000, v236
v_pk_add_f32 v[160:161], v[160:161], v[8:9]
v_lshlrev_b32 v10, 16, v237
v_and_b32 v11, 0xffff0000, v237
v_pk_add_f32 v[162:163], v[162:163], v[10:11]
v_lshlrev_b32 v8, 16, v238
v_and_b32 v9, 0xffff0000, v238
v_pk_add_f32 v[164:165], v[164:165], v[8:9]
v_lshlrev_b32 v10, 16, v239
v_and_b32 v11, 0xffff0000, v239
v_pk_add_f32 v[166:167], v[166:167], v[10:11]
v_cvt_pk_bf16_f32 v160, v160, v161
v_cvt_pk_bf16_f32 v161, v162, v163
v_cvt_pk_bf16_f32 v162, v164, v165
v_cvt_pk_bf16_f32 v163, v166, v167
buffer_store_dwordx2 v[160:161], v6, s[64:67], s77 offen
s_add_u32 s77, s77, 0x7000
buffer_store_dwordx2 v[162:163], v6, s[64:67], s77 offen
v_lshlrev_b32 v168, 16, v240
v_and_b32 v169, 0xffff0000, v240
v_lshlrev_b32 v170, 16, v241
v_and_b32 v171, 0xffff0000, v241
v_lshlrev_b32 v172, 16, v242
v_and_b32 v173, 0xffff0000, v242
v_lshlrev_b32 v174, 16, v243
v_and_b32 v175, 0xffff0000, v243
v_lshlrev_b32 v8, 16, v244
v_and_b32 v9, 0xffff0000, v244
v_pk_add_f32 v[168:169], v[168:169], v[8:9]
v_lshlrev_b32 v10, 16, v245
v_and_b32 v11, 0xffff0000, v245
v_pk_add_f32 v[170:171], v[170:171], v[10:11]
v_lshlrev_b32 v8, 16, v246
v_and_b32 v9, 0xffff0000, v246
v_pk_add_f32 v[172:173], v[172:173], v[8:9]
v_lshlrev_b32 v10, 16, v247
v_and_b32 v11, 0xffff0000, v247
v_pk_add_f32 v[174:175], v[174:175], v[10:11]
v_lshlrev_b32 v8, 16, v248
v_and_b32 v9, 0xffff0000, v248
v_pk_add_f32 v[168:169], v[168:169], v[8:9]
v_lshlrev_b32 v10, 16, v249
v_and_b32 v11, 0xffff0000, v249
v_pk_add_f32 v[170:171], v[170:171], v[10:11]
v_lshlrev_b32 v8, 16, v250
v_and_b32 v9, 0xffff0000, v250
v_pk_add_f32 v[172:173], v[172:173], v[8:9]
v_lshlrev_b32 v10, 16, v251
v_and_b32 v11, 0xffff0000, v251
v_pk_add_f32 v[174:175], v[174:175], v[10:11]
v_lshlrev_b32 v8, 16, v252
v_and_b32 v9, 0xffff0000, v252
v_pk_add_f32 v[168:169], v[168:169], v[8:9]
v_lshlrev_b32 v10, 16, v253
v_and_b32 v11, 0xffff0000, v253
v_pk_add_f32 v[170:171], v[170:171], v[10:11]
v_lshlrev_b32 v8, 16, v254
v_and_b32 v9, 0xffff0000, v254
v_pk_add_f32 v[172:173], v[172:173], v[8:9]
v_lshlrev_b32 v10, 16, v255
v_and_b32 v11, 0xffff0000, v255
v_pk_add_f32 v[174:175], v[174:175], v[10:11]
v_lshlrev_b32 v8, 16, v24
v_and_b32 v9, 0xffff0000, v24
v_pk_add_f32 v[168:169], v[168:169], v[8:9]
v_lshlrev_b32 v10, 16, v25
v_and_b32 v11, 0xffff0000, v25
v_pk_add_f32 v[170:171], v[170:171], v[10:11]
v_lshlrev_b32 v8, 16, v26
v_and_b32 v9, 0xffff0000, v26
v_pk_add_f32 v[172:173], v[172:173], v[8:9]
v_lshlrev_b32 v10, 16, v27
v_and_b32 v11, 0xffff0000, v27
v_pk_add_f32 v[174:175], v[174:175], v[10:11]
v_lshlrev_b32 v8, 16, v28
v_and_b32 v9, 0xffff0000, v28
v_pk_add_f32 v[168:169], v[168:169], v[8:9]
v_lshlrev_b32 v10, 16, v29
v_and_b32 v11, 0xffff0000, v29
v_pk_add_f32 v[170:171], v[170:171], v[10:11]
v_lshlrev_b32 v8, 16, v30
v_and_b32 v9, 0xffff0000, v30
v_pk_add_f32 v[172:173], v[172:173], v[8:9]
v_lshlrev_b32 v10, 16, v31
v_and_b32 v11, 0xffff0000, v31
v_pk_add_f32 v[174:175], v[174:175], v[10:11]
v_lshlrev_b32 v8, 16, v36
v_and_b32 v9, 0xffff0000, v36
v_pk_add_f32 v[168:169], v[168:169], v[8:9]
v_lshlrev_b32 v10, 16, v37
v_and_b32 v11, 0xffff0000, v37
v_pk_add_f32 v[170:171], v[170:171], v[10:11]
v_lshlrev_b32 v8, 16, v38
v_and_b32 v9, 0xffff0000, v38
v_pk_add_f32 v[172:173], v[172:173], v[8:9]
v_lshlrev_b32 v10, 16, v39
v_and_b32 v11, 0xffff0000, v39
v_pk_add_f32 v[174:175], v[174:175], v[10:11]
v_lshlrev_b32 v8, 16, v40
v_and_b32 v9, 0xffff0000, v40
v_pk_add_f32 v[168:169], v[168:169], v[8:9]
v_lshlrev_b32 v10, 16, v41
v_and_b32 v11, 0xffff0000, v41
v_pk_add_f32 v[170:171], v[170:171], v[10:11]
v_lshlrev_b32 v8, 16, v42
v_and_b32 v9, 0xffff0000, v42
v_pk_add_f32 v[172:173], v[172:173], v[8:9]
v_lshlrev_b32 v10, 16, v43
v_and_b32 v11, 0xffff0000, v43
v_pk_add_f32 v[174:175], v[174:175], v[10:11]
v_cvt_pk_bf16_f32 v168, v168, v169
v_cvt_pk_bf16_f32 v169, v170, v171
v_cvt_pk_bf16_f32 v170, v172, v173
v_cvt_pk_bf16_f32 v171, v174, v175
buffer_store_dwordx2 v[168:169], v6, s[64:67], s79 offen
s_add_u32 s79, s79, 0x7000
buffer_store_dwordx2 v[170:171], v6, s[64:67], s79 offen
s_lshr_b32 s90, s73, 2
s_add_u32 s90, s90, 0
s_mul_i32 s91, s90, 0xcd
s_lshr_b32 s91, s91, 10
s_mul_i32 s76, s91, 5
s_sub_u32 s76, s90, s76
s_mul_i32 s77, s76, 0xe000
s_add_u32 s77, s77, s75
s_lshl_b32 s91, s91, 2
s_add_u32 s91, s91, s32
s_mul_i32 s97, s91, 5
s_add_u32 s76, s76, s97
s_lshl_b32 s76, s76, 10
s_add_u32 s76, s76, s72
s_lshl_b32 s91, s91, 5
s_add_u32 s77, s77, s91
s_cmp_lt_u32 s90, 20
s_cselect_b32 s76, s76, 0x7f000000
s_cselect_b32 s77, s77, 0x7f000000
s_lshr_b32 s90, s73, 2
s_add_u32 s90, s90, 8
s_mul_i32 s91, s90, 0xcd
s_lshr_b32 s91, s91, 10
s_mul_i32 s78, s91, 5
s_sub_u32 s78, s90, s78
s_mul_i32 s79, s78, 0xe000
s_add_u32 s79, s79, s75
s_lshl_b32 s91, s91, 2
s_add_u32 s91, s91, s32
s_mul_i32 s97, s91, 5
s_add_u32 s78, s78, s97
s_lshl_b32 s78, s78, 10
s_add_u32 s78, s78, s72
s_lshl_b32 s91, s91, 5
s_add_u32 s79, s79, s91
s_cmp_lt_u32 s90, 20
s_cselect_b32 s78, s78, 0x7f000000
s_cselect_b32 s79, s79, 0x7f000000
s_lshr_b32 s90, s73, 2
s_add_u32 s90, s90, 16
s_mul_i32 s91, s90, 0xcd
s_lshr_b32 s91, s91, 10
s_mul_i32 s80, s91, 5
s_sub_u32 s80, s90, s80
s_mul_i32 s81, s80, 0xe000
s_add_u32 s81, s81, s75
s_lshl_b32 s91, s91, 2
s_add_u32 s91, s91, s32
s_mul_i32 s97, s91, 5
s_add_u32 s80, s80, s97
s_lshl_b32 s80, s80, 10
s_add_u32 s80, s80, s72
s_lshl_b32 s91, s91, 5
s_add_u32 s81, s81, s91
s_cmp_lt_u32 s90, 20
s_cselect_b32 s80, s80, 0x7f000000
s_cselect_b32 s81, s81, 0x7f000000
s_mov_b32 s92, 0x10000
L_p2:
buffer_load_dword v5, v3, s[24:27], s74 offen offset:128 sc1
L_p2_chk:
s_waitcnt vmcnt(0)
v_cmp_ne_u32 vcc, s30, v5
s_sub_u32 s92, s92, 1
s_nop 3
s_cbranch_vccz L_p2_ok
s_sleep 2
s_cmp_lg_u32 s92, 0
s_cbranch_scc1 L_p2
L_p2_ok:
buffer_load_dwordx4 v[48:51], v1, s[24:27], s76 offen sc1
s_add_u32 s76, s76, 0x23000
buffer_load_dwordx4 v[52:55], v1, s[24:27], s76 offen sc1
s_add_u32 s76, s76, 0x23000
buffer_load_dwordx4 v[56:59], v1, s[24:27], s76 offen sc1
s_add_u32 s76, s76, 0x23000
buffer_load_dwordx4 v[60:63], v1, s[24:27], s76 offen sc1
s_add_u32 s76, s76, 0x23000
buffer_load_dwordx4 v[64:67], v1, s[24:27], s76 offen sc1
s_add_u32 s76, s76, 0x23000
buffer_load_dwordx4 v[68:71], v1, s[24:27], s76 offen sc1
s_add_u32 s76, s76, 0x23000
buffer_load_dwordx4 v[72:75], v1, s[24:27], s76 offen sc1
s_add_u32 s76, s76, 0x23000
buffer_load_dwordx4 v[76:79], v1, s[24:27], s76 offen sc1
buffer_load_dwordx4 v[80:83], v1, s[24:27], s78 offen sc1
s_add_u32 s78, s78, 0x23000
buffer_load_dwordx4 v[84:87], v1, s[24:27], s78 offen sc1
s_add_u32 s78, s78, 0x23000
buffer_load_dwordx4 v[88:91], v1, s[24:27], s78 offen sc1
s_add_u32 s78, s78, 0x23000
buffer_load_dwordx4 v[92:95], v1, s[24:27], s78 offen sc1
s_add_u32 s78, s78, 0x23000
buffer_load_dwordx4 v[96:99], v1, s[24:27], s78 offen sc1
s_add_u32 s78, s78, 0x23000
buffer_load_dwordx4 v[100:103], v1, s[24:27], s78 offen sc1
s_add_u32 s78, s78, 0x23000
buffer_load_dwordx4 v[104:107], v1, s[24:27], s78 offen sc1
s_add_u32 s78, s78, 0x23000
buffer_load_dwordx4 v[108:111], v1, s[24:27], s78 offen sc1
buffer_load_dwordx4 v[112:115], v1, s[24:27], s80 offen sc1
s_add_u32 s80, s80, 0x23000
buffer_load_dwordx4 v[116:119], v1, s[24:27], s80 offen sc1
s_add_u32 s80, s80, 0x23000
buffer_load_dwordx4 v[120:123], v1, s[24:27], s80 offen sc1
s_add_u32 s80, s80, 0x23000
buffer_load_dwordx4 v[124:127], v1, s[24:27], s80 offen sc1
s_add_u32 s80, s80, 0x23000
buffer_load_dwordx4 v[128:131], v1, s[24:27], s80 offen sc1
s_add_u32 s80, s80, 0x23000
buffer_load_dwordx4 v[132:135], v1, s[24:27], s80 offen sc1
s_add_u32 s80, s80, 0x23000
buffer_load_dwordx4 v[136:139], v1, s[24:27], s80 offen sc1
s_add_u32 s80, s80, 0x23000
buffer_load_dwordx4 v[140:143], v1, s[24:27], s80 offen sc1
s_waitcnt vmcnt(23)
v_lshlrev_b32 v176, 16, v48
v_and_b32 v177, 0xffff0000, v48
v_lshlrev_b32 v178, 16, v49
v_and_b32 v179, 0xffff0000, v49
v_lshlrev_b32 v180, 16, v50
v_and_b32 v181, 0xffff0000, v50
v_lshlrev_b32 v182, 16, v51
v_and_b32 v183, 0xffff0000, v51
s_waitcnt vmcnt(22)
v_lshlrev_b32 v8, 16, v52
v_and_b32 v9, 0xffff0000, v52
v_pk_add_f32 v[176:177], v[176:177], v[8:9]
v_lshlrev_b32 v10, 16, v53
v_and_b32 v11, 0xffff0000, v53
v_pk_add_f32 v[178:179], v[178:179], v[10:11]
v_lshlrev_b32 v8, 16, v54
v_and_b32 v9, 0xffff0000, v54
v_pk_add_f32 v[180:181], v[180:181], v[8:9]
v_lshlrev_b32 v10, 16, v55
v_and_b32 v11, 0xffff0000, v55
v_pk_add_f32 v[182:183], v[182:183], v[10:11]
s_waitcnt vmcnt(21)
v_lshlrev_b32 v8, 16, v56
v_and_b32 v9, 0xffff0000, v56
v_pk_add_f32 v[176:177], v[176:177], v[8:9]
v_lshlrev_b32 v10, 16, v57
v_and_b32 v11, 0xffff0000, v57
v_pk_add_f32 v[178:179], v[178:179], v[10:11]
v_lshlrev_b32 v8, 16, v58
v_and_b32 v9, 0xffff0000, v58
v_pk_add_f32 v[180:181], v[180:181], v[8:9]
v_lshlrev_b32 v10, 16, v59
v_and_b32 v11, 0xffff0000, v59
v_pk_add_f32 v[182:183], v[182:183], v[10:11]
s_waitcnt vmcnt(20)
v_lshlrev_b32 v8, 16, v60
v_and_b32 v9, 0xffff0000, v60
v_pk_add_f32 v[176:177], v[176:177], v[8:9]
v_lshlrev_b32 v10, 16, v61
v_and_b32 v11, 0xffff0000, v61
v_pk_add_f32 v[178:179], v[178:179], v[10:11]
v_lshlrev_b32 v8, 16, v62
v_and_b32 v9, 0xffff0000, v62
v_pk_add_f32 v[180:181], v[180:181], v[8:9]
v_lshlrev_b32 v10, 16, v63
v_and_b32 v11, 0xffff0000, v63
v_pk_add_f32 v[182:183], v[182:183], v[10:11]
s_waitcnt vmcnt(19)
v_lshlrev_b32 v8, 16, v64
v_and_b32 v9, 0xffff0000, v64
v_pk_add_f32 v[176:177], v[176:177], v[8:9]
v_lshlrev_b32 v10, 16, v65
v_and_b32 v11, 0xffff0000, v65
v_pk_add_f32 v[178:179], v[178:179], v[10:11]
v_lshlrev_b32 v8, 16, v66
v_and_b32 v9, 0xffff0000, v66
v_pk_add_f32 v[180:181], v[180:181], v[8:9]
v_lshlrev_b32 v10, 16, v67
v_and_b32 v11, 0xffff0000, v67
v_pk_add_f32 v[182:183], v[182:183], v[10:11]
s_waitcnt vmcnt(18)
v_lshlrev_b32 v8, 16, v68
v_and_b32 v9, 0xffff0000, v68
v_pk_add_f32 v[176:177], v[176:177], v[8:9]
v_lshlrev_b32 v10, 16, v69
v_and_b32 v11, 0xffff0000, v69
v_pk_add_f32 v[178:179], v[178:179], v[10:11]
v_lshlrev_b32 v8, 16, v70
v_and_b32 v9, 0xffff0000, v70
v_pk_add_f32 v[180:181], v[180:181], v[8:9]
v_lshlrev_b32 v10, 16, v71
v_and_b32 v11, 0xffff0000, v71
v_pk_add_f32 v[182:183], v[182:183], v[10:11]
s_waitcnt vmcnt(17)
v_lshlrev_b32 v8, 16, v72
v_and_b32 v9, 0xffff0000, v72
v_pk_add_f32 v[176:177], v[176:177], v[8:9]
v_lshlrev_b32 v10, 16, v73
v_and_b32 v11, 0xffff0000, v73
v_pk_add_f32 v[178:179], v[178:179], v[10:11]
v_lshlrev_b32 v8, 16, v74
v_and_b32 v9, 0xffff0000, v74
v_pk_add_f32 v[180:181], v[180:181], v[8:9]
v_lshlrev_b32 v10, 16, v75
v_and_b32 v11, 0xffff0000, v75
v_pk_add_f32 v[182:183], v[182:183], v[10:11]
s_waitcnt vmcnt(16)
v_lshlrev_b32 v8, 16, v76
v_and_b32 v9, 0xffff0000, v76
v_pk_add_f32 v[176:177], v[176:177], v[8:9]
v_lshlrev_b32 v10, 16, v77
v_and_b32 v11, 0xffff0000, v77
v_pk_add_f32 v[178:179], v[178:179], v[10:11]
v_lshlrev_b32 v8, 16, v78
v_and_b32 v9, 0xffff0000, v78
v_pk_add_f32 v[180:181], v[180:181], v[8:9]
v_lshlrev_b32 v10, 16, v79
v_and_b32 v11, 0xffff0000, v79
v_pk_add_f32 v[182:183], v[182:183], v[10:11]
v_cvt_pk_bf16_f32 v176, v176, v177
v_cvt_pk_bf16_f32 v177, v178, v179
v_cvt_pk_bf16_f32 v178, v180, v181
v_cvt_pk_bf16_f32 v179, v182, v183
buffer_store_dwordx2 v[176:177], v6, s[64:67], s77 offen
s_add_u32 s77, s77, 0x7000
buffer_store_dwordx2 v[178:179], v6, s[64:67], s77 offen
s_waitcnt vmcnt(17)
v_lshlrev_b32 v184, 16, v80
v_and_b32 v185, 0xffff0000, v80
v_lshlrev_b32 v186, 16, v81
v_and_b32 v187, 0xffff0000, v81
v_lshlrev_b32 v188, 16, v82
v_and_b32 v189, 0xffff0000, v82
v_lshlrev_b32 v190, 16, v83
v_and_b32 v191, 0xffff0000, v83
s_waitcnt vmcnt(16)
v_lshlrev_b32 v8, 16, v84
v_and_b32 v9, 0xffff0000, v84
v_pk_add_f32 v[184:185], v[184:185], v[8:9]
v_lshlrev_b32 v10, 16, v85
v_and_b32 v11, 0xffff0000, v85
v_pk_add_f32 v[186:187], v[186:187], v[10:11]
v_lshlrev_b32 v8, 16, v86
v_and_b32 v9, 0xffff0000, v86
v_pk_add_f32 v[188:189], v[188:189], v[8:9]
v_lshlrev_b32 v10, 16, v87
v_and_b32 v11, 0xffff0000, v87
v_pk_add_f32 v[190:191], v[190:191], v[10:11]
s_waitcnt vmcnt(15)
v_lshlrev_b32 v8, 16, v88
v_and_b32 v9, 0xffff0000, v88
v_pk_add_f32 v[184:185], v[184:185], v[8:9]
v_lshlrev_b32 v10, 16, v89
v_and_b32 v11, 0xffff0000, v89
v_pk_add_f32 v[186:187], v[186:187], v[10:11]
v_lshlrev_b32 v8, 16, v90
v_and_b32 v9, 0xffff0000, v90
v_pk_add_f32 v[188:189], v[188:189], v[8:9]
v_lshlrev_b32 v10, 16, v91
v_and_b32 v11, 0xffff0000, v91
v_pk_add_f32 v[190:191], v[190:191], v[10:11]
s_waitcnt vmcnt(14)
v_lshlrev_b32 v8, 16, v92
v_and_b32 v9, 0xffff0000, v92
v_pk_add_f32 v[184:185], v[184:185], v[8:9]
v_lshlrev_b32 v10, 16, v93
v_and_b32 v11, 0xffff0000, v93
v_pk_add_f32 v[186:187], v[186:187], v[10:11]
v_lshlrev_b32 v8, 16, v94
v_and_b32 v9, 0xffff0000, v94
v_pk_add_f32 v[188:189], v[188:189], v[8:9]
v_lshlrev_b32 v10, 16, v95
v_and_b32 v11, 0xffff0000, v95
v_pk_add_f32 v[190:191], v[190:191], v[10:11]
s_waitcnt vmcnt(13)
v_lshlrev_b32 v8, 16, v96
v_and_b32 v9, 0xffff0000, v96
v_pk_add_f32 v[184:185], v[184:185], v[8:9]
v_lshlrev_b32 v10, 16, v97
v_and_b32 v11, 0xffff0000, v97
v_pk_add_f32 v[186:187], v[186:187], v[10:11]
v_lshlrev_b32 v8, 16, v98
v_and_b32 v9, 0xffff0000, v98
v_pk_add_f32 v[188:189], v[188:189], v[8:9]
v_lshlrev_b32 v10, 16, v99
v_and_b32 v11, 0xffff0000, v99
v_pk_add_f32 v[190:191], v[190:191], v[10:11]
s_waitcnt vmcnt(12)
v_lshlrev_b32 v8, 16, v100
v_and_b32 v9, 0xffff0000, v100
v_pk_add_f32 v[184:185], v[184:185], v[8:9]
v_lshlrev_b32 v10, 16, v101
v_and_b32 v11, 0xffff0000, v101
v_pk_add_f32 v[186:187], v[186:187], v[10:11]
v_lshlrev_b32 v8, 16, v102
v_and_b32 v9, 0xffff0000, v102
v_pk_add_f32 v[188:189], v[188:189], v[8:9]
v_lshlrev_b32 v10, 16, v103
v_and_b32 v11, 0xffff0000, v103
v_pk_add_f32 v[190:191], v[190:191], v[10:11]
s_waitcnt vmcnt(11)
v_lshlrev_b32 v8, 16, v104
v_and_b32 v9, 0xffff0000, v104
v_pk_add_f32 v[184:185], v[184:185], v[8:9]
v_lshlrev_b32 v10, 16, v105
v_and_b32 v11, 0xffff0000, v105
v_pk_add_f32 v[186:187], v[186:187], v[10:11]
v_lshlrev_b32 v8, 16, v106
v_and_b32 v9, 0xffff0000, v106
v_pk_add_f32 v[188:189], v[188:189], v[8:9]
v_lshlrev_b32 v10, 16, v107
v_and_b32 v11, 0xffff0000, v107
v_pk_add_f32 v[190:191], v[190:191], v[10:11]
s_waitcnt vmcnt(10)
v_lshlrev_b32 v8, 16, v108
v_and_b32 v9, 0xffff0000, v108
v_pk_add_f32 v[184:185], v[184:185], v[8:9]
v_lshlrev_b32 v10, 16, v109
v_and_b32 v11, 0xffff0000, v109
v_pk_add_f32 v[186:187], v[186:187], v[10:11]
v_lshlrev_b32 v8, 16, v110
v_and_b32 v9, 0xffff0000, v110
v_pk_add_f32 v[188:189], v[188:189], v[8:9]
v_lshlrev_b32 v10, 16, v111
v_and_b32 v11, 0xffff0000, v111
v_pk_add_f32 v[190:191], v[190:191], v[10:11]
v_cvt_pk_bf16_f32 v184, v184, v185
v_cvt_pk_bf16_f32 v185, v186, v187
v_cvt_pk_bf16_f32 v186, v188, v189
v_cvt_pk_bf16_f32 v187, v190, v191
buffer_store_dwordx2 v[184:185], v6, s[64:67], s79 offen
s_add_u32 s79, s79, 0x7000
buffer_store_dwordx2 v[186:187], v6, s[64:67], s79 offen
s_waitcnt vmcnt(11)
v_lshlrev_b32 v192, 16, v112
v_and_b32 v193, 0xffff0000, v112
v_lshlrev_b32 v194, 16, v113
v_and_b32 v195, 0xffff0000, v113
v_lshlrev_b32 v196, 16, v114
v_and_b32 v197, 0xffff0000, v114
v_lshlrev_b32 v198, 16, v115
v_and_b32 v199, 0xffff0000, v115
s_waitcnt vmcnt(10)
v_lshlrev_b32 v8, 16, v116
v_and_b32 v9, 0xffff0000, v116
v_pk_add_f32 v[192:193], v[192:193], v[8:9]
v_lshlrev_b32 v10, 16, v117
v_and_b32 v11, 0xffff0000, v117
v_pk_add_f32 v[194:195], v[194:195], v[10:11]
v_lshlrev_b32 v8, 16, v118
v_and_b32 v9, 0xffff0000, v118
v_pk_add_f32 v[196:197], v[196:197], v[8:9]
v_lshlrev_b32 v10, 16, v119
v_and_b32 v11, 0xffff0000, v119
v_pk_add_f32 v[198:199], v[198:199], v[10:11]
s_waitcnt vmcnt(9)
v_lshlrev_b32 v8, 16, v120
v_and_b32 v9, 0xffff0000, v120
v_pk_add_f32 v[192:193], v[192:193], v[8:9]
v_lshlrev_b32 v10, 16, v121
v_and_b32 v11, 0xffff0000, v121
v_pk_add_f32 v[194:195], v[194:195], v[10:11]
v_lshlrev_b32 v8, 16, v122
v_and_b32 v9, 0xffff0000, v122
v_pk_add_f32 v[196:197], v[196:197], v[8:9]
v_lshlrev_b32 v10, 16, v123
v_and_b32 v11, 0xffff0000, v123
v_pk_add_f32 v[198:199], v[198:199], v[10:11]
s_waitcnt vmcnt(8)
v_lshlrev_b32 v8, 16, v124
v_and_b32 v9, 0xffff0000, v124
v_pk_add_f32 v[192:193], v[192:193], v[8:9]
v_lshlrev_b32 v10, 16, v125
v_and_b32 v11, 0xffff0000, v125
v_pk_add_f32 v[194:195], v[194:195], v[10:11]
v_lshlrev_b32 v8, 16, v126
v_and_b32 v9, 0xffff0000, v126
v_pk_add_f32 v[196:197], v[196:197], v[8:9]
v_lshlrev_b32 v10, 16, v127
v_and_b32 v11, 0xffff0000, v127
v_pk_add_f32 v[198:199], v[198:199], v[10:11]
s_waitcnt vmcnt(7)
v_lshlrev_b32 v8, 16, v128
v_and_b32 v9, 0xffff0000, v128
v_pk_add_f32 v[192:193], v[192:193], v[8:9]
v_lshlrev_b32 v10, 16, v129
v_and_b32 v11, 0xffff0000, v129
v_pk_add_f32 v[194:195], v[194:195], v[10:11]
v_lshlrev_b32 v8, 16, v130
v_and_b32 v9, 0xffff0000, v130
v_pk_add_f32 v[196:197], v[196:197], v[8:9]
v_lshlrev_b32 v10, 16, v131
v_and_b32 v11, 0xffff0000, v131
v_pk_add_f32 v[198:199], v[198:199], v[10:11]
s_waitcnt vmcnt(6)
v_lshlrev_b32 v8, 16, v132
v_and_b32 v9, 0xffff0000, v132
v_pk_add_f32 v[192:193], v[192:193], v[8:9]
v_lshlrev_b32 v10, 16, v133
v_and_b32 v11, 0xffff0000, v133
v_pk_add_f32 v[194:195], v[194:195], v[10:11]
v_lshlrev_b32 v8, 16, v134
v_and_b32 v9, 0xffff0000, v134
v_pk_add_f32 v[196:197], v[196:197], v[8:9]
v_lshlrev_b32 v10, 16, v135
v_and_b32 v11, 0xffff0000, v135
v_pk_add_f32 v[198:199], v[198:199], v[10:11]
s_waitcnt vmcnt(5)
v_lshlrev_b32 v8, 16, v136
v_and_b32 v9, 0xffff0000, v136
v_pk_add_f32 v[192:193], v[192:193], v[8:9]
v_lshlrev_b32 v10, 16, v137
v_and_b32 v11, 0xffff0000, v137
v_pk_add_f32 v[194:195], v[194:195], v[10:11]
v_lshlrev_b32 v8, 16, v138
v_and_b32 v9, 0xffff0000, v138
v_pk_add_f32 v[196:197], v[196:197], v[8:9]
v_lshlrev_b32 v10, 16, v139
v_and_b32 v11, 0xffff0000, v139
v_pk_add_f32 v[198:199], v[198:199], v[10:11]
s_waitcnt vmcnt(4)
v_lshlrev_b32 v8, 16, v140
v_and_b32 v9, 0xffff0000, v140
v_pk_add_f32 v[192:193], v[192:193], v[8:9]
v_lshlrev_b32 v10, 16, v141
v_and_b32 v11, 0xffff0000, v141
v_pk_add_f32 v[194:195], v[194:195], v[10:11]
v_lshlrev_b32 v8, 16, v142
v_and_b32 v9, 0xffff0000, v142
v_pk_add_f32 v[196:197], v[196:197], v[8:9]
v_lshlrev_b32 v10, 16, v143
v_and_b32 v11, 0xffff0000, v143
v_pk_add_f32 v[198:199], v[198:199], v[10:11]
v_cvt_pk_bf16_f32 v192, v192, v193
v_cvt_pk_bf16_f32 v193, v194, v195
v_cvt_pk_bf16_f32 v194, v196, v197
v_cvt_pk_bf16_f32 v195, v198, v199
buffer_store_dwordx2 v[192:193], v6, s[64:67], s81 offen
s_add_u32 s81, s81, 0x7000
buffer_store_dwordx2 v[194:195], v6, s[64:67], s81 offen
s_endpgm
L_code_end:
.section .rodata,"a"
.p2align 6
.amdhsa_kernel concat_heads__mha_block_cached__mha_block_cached__near_ridge_kernel
  .amdhsa_next_free_vgpr 512
  .amdhsa_next_free_sgpr 102
  .amdhsa_accum_offset 256
  .amdhsa_group_segment_fixed_size 0
  .amdhsa_kernarg_size 104
  .amdhsa_user_sgpr_count 2
  .amdhsa_user_sgpr_kernarg_segment_ptr 1
  .amdhsa_system_sgpr_workgroup_id_x 1
.end_amdhsa_kernel
```
